```python
import torch

def _softmax(x, axis=-1):
    return torch.softmax(x, dim=axis)
def _gelu(x):
    return torch.nn.functional.gelu(x, approximate="tanh")
def _silu(x):
    return torch.nn.functional.silu(x)
def _sigmoid(x):
    return torch.sigmoid(x)
def _layernorm(x, axis=-1, eps=1e-5):
    m = x.mean(dim=axis, keepdim=True)
    v = x.var(dim=axis, keepdim=True, unbiased=False)
    return (x - m) / torch.sqrt(v + eps)
def _scatter_add(tgt, idx, src, axis=0):
    return tgt.clone().index_add_(axis, idx, src)
def _segment_sum(src, seg, n):
    out = torch.zeros((n,) + src.shape[1:], dtype=src.dtype)
    return out.index_add_(0, seg, src)
def _pad(x, pw):
    flat = tuple(v for pair in reversed(pw) for v in pair)
    return torch.nn.functional.pad(x, flat)

kernel_name = 'gated_mix__grouped_kv_mqa__dense_activation_relu__prompt'

def setup_inputs():

    _w = (lambda a: (lambda t: t.to(torch.bfloat16) if t.is_floating_point() else t)(torch.as_tensor(a)))
    def _A_setup():
        B, S, D, H = 1, 2048, 576, 32
        Dh = D // H
        return {
            "x": _w((lambda *s: torch.randn(*s, dtype=torch.bfloat16) * 0.05)(B, S, D)),
            "wq": _w((lambda *s: torch.randn(*s, dtype=torch.bfloat16) * 1.6)(D, H * Dh)),
            "wk": _w((lambda *s: torch.randn(*s, dtype=torch.bfloat16) * 1.6)(D, Dh)),
            "wv": _w((lambda *s: torch.randn(*s, dtype=torch.bfloat16) * 0.2)(D, Dh)),
            "wo": _w((lambda *s: torch.randn(*s, dtype=torch.bfloat16) * 0.2)(H * Dh, D)),
        }
    _A_in = _A_setup()

    def _B_setup():
        B, S, D, Dff = 1, 2048, 576, 4608
        return {
            "x": _w((lambda *s: torch.randn(*s, dtype=torch.bfloat16) * 0.05)(B, S, D)),
            "w1": _w((lambda *s: torch.randn(*s, dtype=torch.bfloat16) * 0.05)(D, Dff)),
            "w2": _w((lambda *s: torch.randn(*s, dtype=torch.bfloat16) * 0.05)(Dff, D)),
        }
    _B_in = _B_setup()

    return {
        "A_x": _A_in["x"],
        "A_wq": _A_in["wq"],
        "A_wk": _A_in["wk"],
        "A_wv": _A_in["wv"],
        "A_wo": _A_in["wo"],
        "B_x": _B_in["x"],
        "B_w1": _B_in["w1"],
        "B_w2": _B_in["w2"],
        "gate_w": _w((lambda *s: torch.randn(*s, dtype=torch.bfloat16) * 0.05)(576) * 16.0),
    }

def reference(A_x, A_wq, A_wk, A_wv, A_wo, B_x, B_w1, B_w2, gate_w):
    def _A_ref(x, wq, wk, wv, wo):
        B, S, D = x.shape
        H = 32
        Dh = D // H
        q = (lambda x, *d: x.permute(*d))((x @ wq).reshape(B, S, H, Dh), 0, 2, 1, 3)
        k = x @ wk
        v = x @ wv
        scores = torch.einsum("bhqd,bkd->bhqk", q, k) * (Dh ** -0.5)
        p = _softmax(scores, axis=-1)
        o = torch.einsum("bhqk,bkd->bhqd", p, v)
        return (lambda x, *d: x.permute(*d))(o, 0, 2, 1, 3).reshape(B, S, H * Dh) @ wo

    def _B_ref(x, w1, w2):
        h = torch.einsum("bsd,df->bsf", x, w1)
        zero = torch.zeros_like(h)
        h = torch.maximum(h, zero)
        return torch.einsum("bsf,fd->bsd", h, w2)

    x = A_x
    g = _sigmoid((x * gate_w).sum(-1, keepdims=True))
    a = _A_ref(x, A_wq, A_wk, A_wv, A_wo)
    b = _B_ref(x, B_w1, B_w2)
    return g * a + (1 - g) * b
```

```asm
; @launch grid=(256,1,1) block=(512,1,1) lds=163840
.amdgcn_target "amdgcn-amd-amdhsa--gfx950"
.text
.globl gated_mix__grouped_kv_mqa__dense_activation_relu__prompt_kernel
.p2align 8
.type gated_mix__grouped_kv_mqa__dense_activation_relu__prompt_kernel,@function
gated_mix__grouped_kv_mqa__dense_activation_relu__prompt_kernel:
  s_cmp_ge_u32 s2, 256
  s_cbranch_scc1 L_END
  s_load_dwordx16 s[48:63], s[0:1], 0
  s_load_dwordx8 s[64:71], s[0:1], 64
  v_lshrrev_b32 v1, 6, v0
  v_and_b32 v0, 63, v0
  v_readfirstlane_b32 s3, v1
  s_and_b32 s5, s2, 7
  s_lshr_b32 s4, s2, 3
  s_mov_b32 s91, s4
  v_lshlrev_b32 v6, 2, v0
  v_add_u32 v6, 163584, v6
  v_mov_b32 v7, 0
  ds_write_b32 v6, v7
  s_waitcnt lgkmcnt(0)
  s_barrier
  s_mov_b32 s44, s70
  s_and_b32 s45, s71, 0xffff
  s_mov_b32 s46, 33554432
  s_mov_b32 s47, 0x20000
  s_min_u32 s59, s5, 2
  s_cmp_ge_u32 s3, 4
  s_cbranch_scc1 L_AWAVE
  s_mov_b32 s24, s60
  s_and_b32 s25, s61, 0xffff
  s_mov_b32 s26, 5308416
  s_mov_b32 s27, 0x20000
  s_and_b32 s80, s3, 1
  s_lshr_b32 s81, s3, 1
  s_mul_i32 s73, s3, 16384
  s_add_u32 s73, s73, 73728
  s_mul_i32 s75, s5, 1152
  s_mul_i32 s76, s5, 663552
  s_mul_i32 s77, s5, 82944
  s_lshl_b32 s78, s3, 8
  s_lshl_b32 s79, s81, 6
  s_add_u32 s79, s79, 768
  s_add_u32 s79, s79, 256
  s_mul_i32 s82, s80, 294912
  s_mul_i32 s83, s80, 36864
  s_mul_i32 s84, s80, 41472
  s_setprio 3
  s_cmp_lg_u32 s3, 0
  s_cbranch_scc1 L_NOEARLY
  s_mul_i32 s6, s4, 14
  v_add_u32 v3, s6, v0
  v_mul_u32_u24 v4, 7282, v3
  v_lshrrev_b32 v4, 16, v4
  v_mul_u32_u24 v5, 9, v4
  v_sub_u32 v5, v3, v5
  v_lshlrev_b32 v5, 7, v5
  v_mul_u32_u24 v4, 9216, v4
  v_add_u32 v4, v4, v5
  v_mov_b32 v5, 268435456
  v_cmp_gt_u32 vcc, 14, v0
  s_nop 1
  v_cndmask_b32 v4, v5, v4, vcc
  buffer_load_dword v9, v4, s[24:27], s75 offen
L_NOEARLY:
  s_setprio 0
  s_mov_b32 s28, s62
  s_and_b32 s29, s63, 0xffff
  s_mov_b32 s30, 5308416
  s_mov_b32 s31, 0x20000
  s_mov_b32 s20, s56
  s_and_b32 s21, s57, 0xffff
  s_mov_b32 s22, 663552
  s_mov_b32 s23, 0x20000
  s_mov_b32 s40, s68
  s_and_b32 s41, s69, 0xffff
  s_mov_b32 s42, 256
  s_mov_b32 s43, 0x20000
  v_lshrrev_b32 v3, 3, v0
  v_mul_u32_u24 v3, 9216, v3
  v_and_b32 v4, 7, v0
  v_lshrrev_b32 v5, 4, v0
  v_and_b32 v5, 1, v5
  v_lshlrev_b32 v6, 1, v5
  v_xor_b32 v6, v6, v4
  v_lshlrev_b32 v6, 4, v6
  v_add_u32 v74, v3, v6
  v_or_b32 v5, 2, v5
  v_lshlrev_b32 v6, 1, v5
  v_xor_b32 v6, v6, v4
  v_lshlrev_b32 v6, 4, v6
  v_add_u32 v75, v3, v6
  v_lshrrev_b32 v3, 2, v0
  v_mul_u32_u24 v3, 9216, v3
  v_and_b32 v4, 3, v0
  v_lshrrev_b32 v5, 5, v0
  v_and_b32 v5, 1, v5
  v_lshlrev_b32 v5, 1, v5
  v_xor_b32 v4, v4, v5
  v_lshlrev_b32 v4, 4, v4
  v_add_u32 v87, v3, v4
  s_cmp_lg_u32 s3, 3
  s_cbranch_scc1 L_F_NOCLR
  s_lshl_b32 s6, s4, 13
  s_lshl_b32 s7, s5, 7
  s_add_u32 s6, s6, s7
  s_add_u32 s6, s6, 262144
  v_lshrrev_b32 v3, 3, v0
  v_lshlrev_b32 v3, 10, v3
  v_and_b32 v5, 7, v0
  v_lshlrev_b32 v5, 4, v5
  v_add_u32 v3, v3, v5
  v_mov_b32 v4, 0
  v_mov_b32 v5, 0
  v_mov_b32 v6, 0
  v_mov_b32 v7, 0
  buffer_store_dwordx4 v[4:7], v3, s[44:47], s6 offen sc1
  s_cmp_lt_u32 s59, 2
  s_cbranch_scc0 L_F_NOCLR
  s_lshl_b32 s6, s4, 3
  s_lshl_b32 s7, s59, 2
  s_add_u32 s6, s6, s7
  s_add_u32 s6, s6, 229376
  v_lshlrev_b32 v3, 8, v0
  s_mov_b64 exec, 0xffff
  buffer_store_dword v4, v3, s[44:47], s6 offen sc1
  s_mov_b64 exec, -1
L_F_NOCLR:
  v_and_b32 v3, 15, v0
  v_lshrrev_b32 v4, 4, v0
  v_lshrrev_b32 v5, 2, v3
  v_and_b32 v3, 3, v3
  v_lshlrev_b32 v3, 3, v3
  v_add_u32 v3, s73, v3
  v_lshlrev_b32 v6, 3, v4
  v_add_u32 v6, v6, v5
  v_lshrrev_b32 v5, 1, v5
  v_and_b32 v7, 1, v4
  v_lshlrev_b32 v7, 1, v7
  v_or_b32 v5, v5, v7
  v_lshlrev_b32 v7, 7, v6
  v_add_u32 v7, v7, v3
  v_xor_b32 v8, 0, v5
  v_lshlrev_b32 v8, 5, v8
  v_add_u32 v76, v7, v8
  v_xor_b32 v8, 1, v5
  v_lshlrev_b32 v8, 5, v8
  v_add_u32 v77, v7, v8
  v_xor_b32 v8, 2, v5
  v_lshlrev_b32 v8, 5, v8
  v_add_u32 v78, v7, v8
  v_xor_b32 v8, 3, v5
  v_lshlrev_b32 v8, 5, v8
  v_add_u32 v79, v7, v8
  v_lshlrev_b32 v7, 6, v6
  v_add_u32 v7, v7, v3
  v_and_b32 v4, 1, v4
  v_xor_b32 v8, 0, v4
  v_lshlrev_b32 v8, 5, v8
  v_add_u32 v80, v7, v8
  v_xor_b32 v8, 1, v4
  v_lshlrev_b32 v8, 5, v8
  v_add_u32 v81, v7, v8
  v_and_b32 v3, 15, v0
  v_lshrrev_b32 v4, 4, v0
  v_lshrrev_b32 v5, 3, v3
  v_mul_u32_u24 v5, 9216, v5
  v_and_b32 v6, 7, v3
  v_lshlrev_b32 v6, 7, v6
  v_add_u32 v5, v5, v6
  v_lshrrev_b32 v6, 1, v3
  s_lshl_b32 s6, s80, 2
  v_add_u32 v7, s6, v4
  v_xor_b32 v7, v7, v6
  v_lshlrev_b32 v7, 4, v7
  v_add_u32 v82, v5, v7
  s_sub_u32 s6, 4, s6
  v_add_u32 v7, s6, v4
  v_xor_b32 v7, v7, v6
  v_lshlrev_b32 v7, 4, v7
  v_add_u32 v83, v5, v7
  v_mov_b32 v84, 163584
  v_mov_b32 v85, 1
  s_setprio 2
  s_add_u32 s72, s75, s78
  s_add_u32 s72, s72, 0
  s_add_u32 s72, s72, s82
  s_add_u32 m0, s73, 0
  s_nop 0
  buffer_load_dwordx4 v74, s[24:27], s72 offen lds
  s_add_u32 s72, s72, 73728
  s_add_u32 m0, s73, 1024
  s_nop 0
  buffer_load_dwordx4 v75, s[24:27], s72 offen lds
  s_add_u32 s72, s72, 73728
  s_add_u32 m0, s73, 2048
  s_nop 0
  buffer_load_dwordx4 v74, s[24:27], s72 offen lds
  s_add_u32 s72, s72, 73728
  s_add_u32 m0, s73, 3072
  s_nop 0
  buffer_load_dwordx4 v75, s[24:27], s72 offen lds
  s_setprio 0
  s_add_u32 s72, s75, s78
  s_add_u32 s72, s72, 128
  s_add_u32 s72, s72, s82
  s_add_u32 m0, s73, 4096
  s_nop 0
  buffer_load_dwordx4 v74, s[24:27], s72 offen lds
  s_add_u32 s72, s72, 73728
  s_add_u32 m0, s73, 5120
  s_nop 0
  buffer_load_dwordx4 v75, s[24:27], s72 offen lds
  s_add_u32 s72, s72, 73728
  s_add_u32 m0, s73, 6144
  s_nop 0
  buffer_load_dwordx4 v74, s[24:27], s72 offen lds
  s_add_u32 s72, s72, 73728
  s_add_u32 m0, s73, 7168
  s_nop 0
  buffer_load_dwordx4 v75, s[24:27], s72 offen lds
  s_add_u32 s72, s75, s79
  s_add_u32 s72, s72, 0
  s_add_u32 s72, s72, s82
  s_add_u32 m0, s73, 8192
  s_nop 0
  buffer_load_dwordx4 v87, s[24:27], s72 offen lds
  s_add_u32 s72, s72, 147456
  s_add_u32 m0, s73, 9216
  s_nop 0
  buffer_load_dwordx4 v87, s[24:27], s72 offen lds
  s_add_u32 s72, s75, s78
  s_add_u32 s72, s72, 294912
  s_sub_u32 s72, s72, s82
  s_add_u32 m0, s73, 12288
  s_nop 0
  buffer_load_dwordx4 v74, s[24:27], s72 offen lds
  s_add_u32 s72, s72, 73728
  s_add_u32 m0, s73, 13312
  s_nop 0
  buffer_load_dwordx4 v75, s[24:27], s72 offen lds
  s_add_u32 s72, s72, 73728
  s_add_u32 m0, s73, 14336
  s_nop 0
  buffer_load_dwordx4 v74, s[24:27], s72 offen lds
  s_add_u32 s72, s72, 73728
  s_add_u32 m0, s73, 15360
  s_nop 0
  buffer_load_dwordx4 v75, s[24:27], s72 offen lds
  s_mov_b32 s95, 400000
W_1:
  ds_read_b32 v3, v84 offset:64
  s_waitcnt lgkmcnt(0)
  v_readfirstlane_b32 s6, v3
  s_nop 3
  s_cmp_ge_u32 s6, 4
  s_cbranch_scc1 WD_2
  s_sleep 1
  s_sub_u32 s95, s95, 1
  s_cmp_lg_u32 s95, 0
  s_cbranch_scc1 W_1
WD_2:
  v_mul_u32_u24 v3, 7282, v0
  v_lshrrev_b32 v3, 16, v3
  v_mul_u32_u24 v4, 9, v3
  v_sub_u32 v4, v0, v4
  v_lshlrev_b32 v4, 7, v4
  v_mov_b32 v6, 268435456
  s_mul_i32 s6, s4, 18
  s_mul_i32 s7, s3, 5
  s_add_u32 s6, s6, s7
  v_add_u32 v5, s6, v3
  v_mul_u32_u24 v5, 9216, v5
  v_cmp_gt_u32 vcc, 45, v0
  v_add_u32 v5, v5, v4
  s_nop 0
  v_cndmask_b32 v5, v6, v5, vcc
  buffer_load_dword v9, v5, s[24:27], s75 offen
  s_waitcnt vmcnt(11)
  s_cmp_lg_u32 s3, 3
  s_cbranch_scc1 L_F_NOC1
  s_cmp_lt_u32 s59, 2
  s_cbranch_scc0 L_F_NOC1
  v_mov_b32 v3, 0
  s_mov_b64 exec, 1
  buffer_atomic_add v85, v3, s[40:43], 0 offen sc1
  ds_add_u32 v84, v85 offset:100
  s_mov_b64 exec, -1
L_F_NOC1:
  ds_read_b128 v[42:45], v82 offset:0
  ds_read_b128 v[46:49], v82 offset:18432
  ds_read_b128 v[50:53], v82 offset:36864
  ds_read_b128 v[54:57], v82 offset:55296
  ds_read_b64_tr_b16 v[10:11], v76 offset:0
  ds_read_b64_tr_b16 v[12:13], v76 offset:512
  ds_read_b64_tr_b16 v[14:15], v77 offset:0
  ds_read_b64_tr_b16 v[16:17], v77 offset:512
  ds_read_b64_tr_b16 v[18:19], v78 offset:0
  ds_read_b64_tr_b16 v[20:21], v78 offset:512
  ds_read_b64_tr_b16 v[22:23], v79 offset:0
  ds_read_b64_tr_b16 v[24:25], v79 offset:512
  s_mul_i32 s6, s2, 2341
  s_lshr_b32 s6, s6, 16
  s_mul_i32 s6, s6, 28
  s_sub_u32 s89, s2, s6
  s_add_u32 s89, s89, 4
  s_cmp_eq_u32 s3, 3
  s_cselect_b32 s89, s89, 99
  s_mov_b32 s88, 0
  s_waitcnt lgkmcnt(0)
  s_waitcnt vmcnt(7)
  v_mfma_f32_16x16x32_bf16 v[96:99], v[10:13], v[42:45], 0
  ds_read_b64_tr_b16 v[26:27], v76 offset:4096
  v_mfma_f32_16x16x32_bf16 v[100:103], v[10:13], v[46:49], 0
  ds_read_b64_tr_b16 v[28:29], v76 offset:4608
  v_mfma_f32_16x16x32_bf16 v[104:107], v[10:13], v[50:53], 0
  ds_read_b64_tr_b16 v[30:31], v77 offset:4096
  v_mfma_f32_16x16x32_bf16 v[108:111], v[10:13], v[54:57], 0
  ds_read_b64_tr_b16 v[32:33], v77 offset:4608
  v_mfma_f32_16x16x32_bf16 v[112:115], v[14:17], v[42:45], 0
  ds_read_b64_tr_b16 v[34:35], v78 offset:4096
  v_mfma_f32_16x16x32_bf16 v[116:119], v[14:17], v[46:49], 0
  ds_read_b64_tr_b16 v[36:37], v78 offset:4608
  v_mfma_f32_16x16x32_bf16 v[120:123], v[14:17], v[50:53], 0
  ds_read_b64_tr_b16 v[38:39], v79 offset:4096
  v_mfma_f32_16x16x32_bf16 v[124:127], v[14:17], v[54:57], 0
  ds_read_b64_tr_b16 v[40:41], v79 offset:4608
  v_mfma_f32_16x16x32_bf16 v[128:131], v[18:21], v[42:45], 0
  s_add_u32 s72, s75, s78
  s_add_u32 s72, s72, 295040
  s_sub_u32 s72, s72, s82
  s_add_u32 m0, s73, 0
  s_nop 0
  buffer_load_dwordx4 v74, s[24:27], s72 offen lds
  v_mfma_f32_16x16x32_bf16 v[132:135], v[18:21], v[46:49], 0
  v_mfma_f32_16x16x32_bf16 v[136:139], v[18:21], v[50:53], 0
  s_add_u32 s72, s72, 73728
  s_add_u32 m0, s73, 1024
  s_nop 0
  buffer_load_dwordx4 v75, s[24:27], s72 offen lds
  v_mfma_f32_16x16x32_bf16 v[140:143], v[18:21], v[54:57], 0
  v_mfma_f32_16x16x32_bf16 v[144:147], v[22:25], v[42:45], 0
  s_add_u32 s72, s72, 73728
  s_add_u32 m0, s73, 2048
  s_nop 0
  buffer_load_dwordx4 v74, s[24:27], s72 offen lds
  v_mfma_f32_16x16x32_bf16 v[148:151], v[22:25], v[46:49], 0
  v_mfma_f32_16x16x32_bf16 v[152:155], v[22:25], v[50:53], 0
  s_add_u32 s72, s72, 73728
  s_add_u32 m0, s73, 3072
  s_nop 0
  buffer_load_dwordx4 v75, s[24:27], s72 offen lds
  v_mfma_f32_16x16x32_bf16 v[156:159], v[22:25], v[54:57], 0
  s_waitcnt lgkmcnt(0)
  s_waitcnt vmcnt(9)
  v_mfma_f32_16x16x32_bf16 v[160:163], v[26:29], v[42:45], 0
  ds_read_b64_tr_b16 v[10:11], v80 offset:8192
  v_mfma_f32_16x16x32_bf16 v[164:167], v[26:29], v[46:49], 0
  ds_read_b64_tr_b16 v[12:13], v80 offset:8448
  v_mfma_f32_16x16x32_bf16 v[168:171], v[26:29], v[50:53], 0
  ds_read_b64_tr_b16 v[14:15], v81 offset:8192
  v_mfma_f32_16x16x32_bf16 v[172:175], v[26:29], v[54:57], 0
  ds_read_b64_tr_b16 v[16:17], v81 offset:8448
  v_mfma_f32_16x16x32_bf16 v[176:179], v[30:33], v[42:45], 0
  v_mfma_f32_16x16x32_bf16 v[180:183], v[30:33], v[46:49], 0
  v_mfma_f32_16x16x32_bf16 v[184:187], v[30:33], v[50:53], 0
  v_mfma_f32_16x16x32_bf16 v[188:191], v[30:33], v[54:57], 0
  v_mfma_f32_16x16x32_bf16 v[192:195], v[34:37], v[42:45], 0
  s_add_u32 s72, s75, s78
  s_add_u32 s72, s72, 589824
  s_add_u32 s72, s72, s82
  s_add_u32 m0, s73, 4096
  s_nop 0
  buffer_load_dwordx4 v74, s[24:27], s72 offen lds
  v_mfma_f32_16x16x32_bf16 v[196:199], v[34:37], v[46:49], 0
  v_mfma_f32_16x16x32_bf16 v[200:203], v[34:37], v[50:53], 0
  s_add_u32 s72, s72, 73728
  s_add_u32 m0, s73, 5120
  s_nop 0
  buffer_load_dwordx4 v75, s[24:27], s72 offen lds
  v_mfma_f32_16x16x32_bf16 v[204:207], v[34:37], v[54:57], 0
  v_mfma_f32_16x16x32_bf16 v[208:211], v[38:41], v[42:45], 0
  s_add_u32 s72, s72, 73728
  s_add_u32 m0, s73, 6144
  s_nop 0
  buffer_load_dwordx4 v74, s[24:27], s72 offen lds
  v_mfma_f32_16x16x32_bf16 v[212:215], v[38:41], v[46:49], 0
  v_mfma_f32_16x16x32_bf16 v[216:219], v[38:41], v[50:53], 0
  s_add_u32 s72, s72, 73728
  s_add_u32 m0, s73, 7168
  s_nop 0
  buffer_load_dwordx4 v75, s[24:27], s72 offen lds
  v_mfma_f32_16x16x32_bf16 v[220:223], v[38:41], v[54:57], 0
  s_waitcnt lgkmcnt(0)
  s_waitcnt vmcnt(9)
  v_mfma_f32_16x16x32_bf16 v[224:227], v[10:13], v[42:45], 0
  s_add_u32 s72, s75, s78
  s_add_u32 s72, s72, 589952
  s_add_u32 s72, s72, s82
  s_add_u32 m0, s73, 8192
  s_nop 0
  buffer_load_dwordx4 v74, s[24:27], s72 offen lds
  ds_read_b128 v[58:61], v83 offset:0
  ds_read_b128 v[62:65], v83 offset:18432
  ds_read_b128 v[66:69], v83 offset:36864
  v_mfma_f32_16x16x32_bf16 v[228:231], v[10:13], v[46:49], 0
  ds_read_b128 v[70:73], v83 offset:55296
  ds_read_b64_tr_b16 v[26:27], v76 offset:12288
  ds_read_b64_tr_b16 v[28:29], v76 offset:12800
  v_mfma_f32_16x16x32_bf16 v[232:235], v[10:13], v[50:53], 0
  s_add_u32 s72, s72, 73728
  s_add_u32 m0, s73, 9216
  s_nop 0
  buffer_load_dwordx4 v75, s[24:27], s72 offen lds
  ds_read_b64_tr_b16 v[30:31], v77 offset:12288
  ds_read_b64_tr_b16 v[32:33], v77 offset:12800
  ds_read_b64_tr_b16 v[34:35], v78 offset:12288
  v_mfma_f32_16x16x32_bf16 v[236:239], v[10:13], v[54:57], 0
  ds_read_b64_tr_b16 v[36:37], v78 offset:12800
  ds_read_b64_tr_b16 v[38:39], v79 offset:12288
  ds_read_b64_tr_b16 v[40:41], v79 offset:12800
  v_mfma_f32_16x16x32_bf16 v[240:243], v[14:17], v[42:45], 0
  s_add_u32 s72, s72, 73728
  s_add_u32 m0, s73, 10240
  s_nop 0
  buffer_load_dwordx4 v74, s[24:27], s72 offen lds
  v_mfma_f32_16x16x32_bf16 v[244:247], v[14:17], v[46:49], 0
  v_mfma_f32_16x16x32_bf16 v[248:251], v[14:17], v[50:53], 0
  s_add_u32 s72, s72, 73728
  s_add_u32 m0, s73, 11264
  s_nop 0
  buffer_load_dwordx4 v75, s[24:27], s72 offen lds
  v_mfma_f32_16x16x32_bf16 v[252:255], v[14:17], v[54:57], 0
  s_waitcnt lgkmcnt(0)
  s_waitcnt vmcnt(8)
  v_mfma_f32_16x16x32_bf16 v[96:99], v[26:29], v[58:61], v[96:99]
  ds_read_b64_tr_b16 v[10:11], v76 offset:0
  v_mfma_f32_16x16x32_bf16 v[100:103], v[26:29], v[62:65], v[100:103]
  ds_read_b64_tr_b16 v[12:13], v76 offset:512
  v_mfma_f32_16x16x32_bf16 v[104:107], v[26:29], v[66:69], v[104:107]
  ds_read_b64_tr_b16 v[14:15], v77 offset:0
  v_mfma_f32_16x16x32_bf16 v[108:111], v[26:29], v[70:73], v[108:111]
  ds_read_b64_tr_b16 v[16:17], v77 offset:512
  v_mfma_f32_16x16x32_bf16 v[112:115], v[30:33], v[58:61], v[112:115]
  ds_read_b64_tr_b16 v[18:19], v78 offset:0
  v_mfma_f32_16x16x32_bf16 v[116:119], v[30:33], v[62:65], v[116:119]
  ds_read_b64_tr_b16 v[20:21], v78 offset:512
  v_mfma_f32_16x16x32_bf16 v[120:123], v[30:33], v[66:69], v[120:123]
  ds_read_b64_tr_b16 v[22:23], v79 offset:0
  v_mfma_f32_16x16x32_bf16 v[124:127], v[30:33], v[70:73], v[124:127]
  ds_read_b64_tr_b16 v[24:25], v79 offset:512
  v_mfma_f32_16x16x32_bf16 v[128:131], v[34:37], v[58:61], v[128:131]
  ds_read_b32 v86, v84 offset:68
  v_mfma_f32_16x16x32_bf16 v[132:135], v[34:37], v[62:65], v[132:135]
  v_mfma_f32_16x16x32_bf16 v[136:139], v[34:37], v[66:69], v[136:139]
  v_mfma_f32_16x16x32_bf16 v[140:143], v[34:37], v[70:73], v[140:143]
  v_mfma_f32_16x16x32_bf16 v[144:147], v[38:41], v[58:61], v[144:147]
  s_add_u32 s72, s75, s79
  s_add_u32 s72, s72, 589824
  s_add_u32 s72, s72, s82
  s_add_u32 m0, s73, 12288
  s_nop 0
  buffer_load_dwordx4 v87, s[24:27], s72 offen lds
  v_mfma_f32_16x16x32_bf16 v[148:151], v[38:41], v[62:65], v[148:151]
  v_mfma_f32_16x16x32_bf16 v[152:155], v[38:41], v[66:69], v[152:155]
  s_add_u32 s72, s72, 147456
  s_add_u32 m0, s73, 13312
  s_nop 0
  buffer_load_dwordx4 v87, s[24:27], s72 offen lds
  v_mfma_f32_16x16x32_bf16 v[156:159], v[38:41], v[70:73], v[156:159]
  s_cmp_eq_u32 s89, 4
  s_cbranch_scc1 GA_3
GR_4:
  s_waitcnt lgkmcnt(0)
  s_waitcnt vmcnt(6)
  v_readfirstlane_b32 s6, v86
  v_mfma_f32_16x16x32_bf16 v[160:163], v[10:13], v[58:61], v[160:163]
  s_nop 1
  s_cmp_ge_u32 s6, 4
  s_cbranch_scc1 XOK_5
  s_mov_b32 s95, 400000
W_6:
  ds_read_b32 v3, v84 offset:68
  s_waitcnt lgkmcnt(0)
  v_readfirstlane_b32 s6, v3
  s_nop 3
  s_cmp_ge_u32 s6, 4
  s_cbranch_scc1 WD_7
  s_sleep 1
  s_sub_u32 s95, s95, 1
  s_cmp_lg_u32 s95, 0
  s_cbranch_scc1 W_6
WD_7:
XOK_5:
  ds_read_b128 v[42:45], v82 offset:1024
  v_mfma_f32_16x16x32_bf16 v[164:167], v[10:13], v[62:65], v[164:167]
  ds_read_b128 v[46:49], v82 offset:19456
  v_mfma_f32_16x16x32_bf16 v[168:171], v[10:13], v[66:69], v[168:171]
  ds_read_b128 v[50:53], v82 offset:37888
  v_mfma_f32_16x16x32_bf16 v[172:175], v[10:13], v[70:73], v[172:175]
  ds_read_b128 v[54:57], v82 offset:56320
  v_mfma_f32_16x16x32_bf16 v[176:179], v[14:17], v[58:61], v[176:179]
  ds_read_b64_tr_b16 v[26:27], v76 offset:4096
  v_mfma_f32_16x16x32_bf16 v[180:183], v[14:17], v[62:65], v[180:183]
  ds_read_b64_tr_b16 v[28:29], v76 offset:4608
  v_mfma_f32_16x16x32_bf16 v[184:187], v[14:17], v[66:69], v[184:187]
  ds_read_b64_tr_b16 v[30:31], v77 offset:4096
  v_mfma_f32_16x16x32_bf16 v[188:191], v[14:17], v[70:73], v[188:191]
  ds_read_b64_tr_b16 v[32:33], v77 offset:4608
  v_mfma_f32_16x16x32_bf16 v[192:195], v[18:21], v[58:61], v[192:195]
  s_add_u32 s72, s75, s78
  s_add_u32 s72, s72, 884736
  s_sub_u32 s72, s72, s82
  s_add_u32 m0, s73, 0
  s_nop 0
  buffer_load_dwordx4 v74, s[24:27], s72 offen lds
  ds_read_b64_tr_b16 v[34:35], v78 offset:4096
  v_mfma_f32_16x16x32_bf16 v[196:199], v[18:21], v[62:65], v[196:199]
  ds_read_b64_tr_b16 v[36:37], v78 offset:4608
  v_mfma_f32_16x16x32_bf16 v[200:203], v[18:21], v[66:69], v[200:203]
  s_add_u32 s72, s72, 73728
  s_add_u32 m0, s73, 1024
  s_nop 0
  buffer_load_dwordx4 v75, s[24:27], s72 offen lds
  ds_read_b64_tr_b16 v[38:39], v79 offset:4096
  v_mfma_f32_16x16x32_bf16 v[204:207], v[18:21], v[70:73], v[204:207]
  ds_read_b64_tr_b16 v[40:41], v79 offset:4608
  v_mfma_f32_16x16x32_bf16 v[208:211], v[22:25], v[58:61], v[208:211]
  s_add_u32 s72, s72, 73728
  s_add_u32 m0, s73, 2048
  s_nop 0
  buffer_load_dwordx4 v74, s[24:27], s72 offen lds
  v_mfma_f32_16x16x32_bf16 v[212:215], v[22:25], v[62:65], v[212:215]
  v_mfma_f32_16x16x32_bf16 v[216:219], v[22:25], v[66:69], v[216:219]
  s_add_u32 s72, s72, 73728
  s_add_u32 m0, s73, 3072
  s_nop 0
  buffer_load_dwordx4 v75, s[24:27], s72 offen lds
  v_mfma_f32_16x16x32_bf16 v[220:223], v[22:25], v[70:73], v[220:223]
  s_cmp_eq_u32 s89, 5
  s_cbranch_scc1 GA_8
GR_9:
  s_waitcnt lgkmcnt(0)
  s_waitcnt vmcnt(6)
  v_mfma_f32_16x16x32_bf16 v[96:99], v[26:29], v[42:45], v[96:99]
  ds_read_b64_tr_b16 v[10:11], v76 offset:8192
  v_mfma_f32_16x16x32_bf16 v[100:103], v[26:29], v[46:49], v[100:103]
  ds_read_b64_tr_b16 v[12:13], v76 offset:8704
  v_mfma_f32_16x16x32_bf16 v[104:107], v[26:29], v[50:53], v[104:107]
  ds_read_b64_tr_b16 v[14:15], v77 offset:8192
  v_mfma_f32_16x16x32_bf16 v[108:111], v[26:29], v[54:57], v[108:111]
  ds_read_b64_tr_b16 v[16:17], v77 offset:8704
  v_mfma_f32_16x16x32_bf16 v[112:115], v[30:33], v[42:45], v[112:115]
  ds_read_b64_tr_b16 v[18:19], v78 offset:8192
  v_mfma_f32_16x16x32_bf16 v[116:119], v[30:33], v[46:49], v[116:119]
  ds_read_b64_tr_b16 v[20:21], v78 offset:8704
  v_mfma_f32_16x16x32_bf16 v[120:123], v[30:33], v[50:53], v[120:123]
  ds_read_b64_tr_b16 v[22:23], v79 offset:8192
  v_mfma_f32_16x16x32_bf16 v[124:127], v[30:33], v[54:57], v[124:127]
  ds_read_b64_tr_b16 v[24:25], v79 offset:8704
  v_mfma_f32_16x16x32_bf16 v[128:131], v[34:37], v[42:45], v[128:131]
  s_add_u32 s72, s75, s78
  s_add_u32 s72, s72, 884864
  s_sub_u32 s72, s72, s82
  s_add_u32 m0, s73, 4096
  s_nop 0
  buffer_load_dwordx4 v74, s[24:27], s72 offen lds
  v_mfma_f32_16x16x32_bf16 v[132:135], v[34:37], v[46:49], v[132:135]
  v_mfma_f32_16x16x32_bf16 v[136:139], v[34:37], v[50:53], v[136:139]
  s_add_u32 s72, s72, 73728
  s_add_u32 m0, s73, 5120
  s_nop 0
  buffer_load_dwordx4 v75, s[24:27], s72 offen lds
  v_mfma_f32_16x16x32_bf16 v[140:143], v[34:37], v[54:57], v[140:143]
  v_mfma_f32_16x16x32_bf16 v[144:147], v[38:41], v[42:45], v[144:147]
  s_add_u32 s72, s72, 73728
  s_add_u32 m0, s73, 6144
  s_nop 0
  buffer_load_dwordx4 v74, s[24:27], s72 offen lds
  v_mfma_f32_16x16x32_bf16 v[148:151], v[38:41], v[46:49], v[148:151]
  v_mfma_f32_16x16x32_bf16 v[152:155], v[38:41], v[50:53], v[152:155]
  s_add_u32 s72, s72, 73728
  s_add_u32 m0, s73, 7168
  s_nop 0
  buffer_load_dwordx4 v75, s[24:27], s72 offen lds
  v_mfma_f32_16x16x32_bf16 v[156:159], v[38:41], v[54:57], v[156:159]
  s_cmp_eq_u32 s89, 6
  s_cbranch_scc1 GA_10
GR_11:
  s_waitcnt lgkmcnt(0)
  s_waitcnt vmcnt(8)
  v_mfma_f32_16x16x32_bf16 v[160:163], v[10:13], v[42:45], v[160:163]
  ds_read_b64_tr_b16 v[26:27], v80 offset:12288
  v_mfma_f32_16x16x32_bf16 v[164:167], v[10:13], v[46:49], v[164:167]
  ds_read_b64_tr_b16 v[28:29], v80 offset:12544
  v_mfma_f32_16x16x32_bf16 v[168:171], v[10:13], v[50:53], v[168:171]
  ds_read_b64_tr_b16 v[30:31], v81 offset:12288
  v_mfma_f32_16x16x32_bf16 v[172:175], v[10:13], v[54:57], v[172:175]
  ds_read_b64_tr_b16 v[32:33], v81 offset:12544
  v_mfma_f32_16x16x32_bf16 v[176:179], v[14:17], v[42:45], v[176:179]
  v_mfma_f32_16x16x32_bf16 v[180:183], v[14:17], v[46:49], v[180:183]
  v_mfma_f32_16x16x32_bf16 v[184:187], v[14:17], v[50:53], v[184:187]
  v_mfma_f32_16x16x32_bf16 v[188:191], v[14:17], v[54:57], v[188:191]
  v_mfma_f32_16x16x32_bf16 v[192:195], v[18:21], v[42:45], v[192:195]
  s_add_u32 s72, s75, s78
  s_add_u32 s72, s72, 1179648
  s_add_u32 s72, s72, s82
  s_add_u32 m0, s73, 8192
  s_nop 0
  buffer_load_dwordx4 v74, s[24:27], s72 offen lds
  v_mfma_f32_16x16x32_bf16 v[196:199], v[18:21], v[46:49], v[196:199]
  v_mfma_f32_16x16x32_bf16 v[200:203], v[18:21], v[50:53], v[200:203]
  s_add_u32 s72, s72, 73728
  s_add_u32 m0, s73, 9216
  s_nop 0
  buffer_load_dwordx4 v75, s[24:27], s72 offen lds
  v_mfma_f32_16x16x32_bf16 v[204:207], v[18:21], v[54:57], v[204:207]
  v_mfma_f32_16x16x32_bf16 v[208:211], v[22:25], v[42:45], v[208:211]
  s_add_u32 s72, s72, 73728
  s_add_u32 m0, s73, 10240
  s_nop 0
  buffer_load_dwordx4 v74, s[24:27], s72 offen lds
  v_mfma_f32_16x16x32_bf16 v[212:215], v[22:25], v[46:49], v[212:215]
  v_mfma_f32_16x16x32_bf16 v[216:219], v[22:25], v[50:53], v[216:219]
  s_add_u32 s72, s72, 73728
  s_add_u32 m0, s73, 11264
  s_nop 0
  buffer_load_dwordx4 v75, s[24:27], s72 offen lds
  v_mfma_f32_16x16x32_bf16 v[220:223], v[22:25], v[54:57], v[220:223]
  s_cmp_eq_u32 s89, 7
  s_cbranch_scc1 GA_12
GR_13:
  s_waitcnt lgkmcnt(0)
  s_waitcnt vmcnt(8)
  v_mfma_f32_16x16x32_bf16 v[224:227], v[26:29], v[42:45], v[224:227]
  s_add_u32 s72, s75, s78
  s_add_u32 s72, s72, 1179776
  s_add_u32 s72, s72, s82
  s_add_u32 m0, s73, 12288
  s_nop 0
  buffer_load_dwordx4 v74, s[24:27], s72 offen lds
  ds_read_b128 v[58:61], v83 offset:1024
  ds_read_b128 v[62:65], v83 offset:19456
  ds_read_b128 v[66:69], v83 offset:37888
  v_mfma_f32_16x16x32_bf16 v[228:231], v[26:29], v[46:49], v[228:231]
  ds_read_b128 v[70:73], v83 offset:56320
  ds_read_b64_tr_b16 v[10:11], v76 offset:0
  ds_read_b64_tr_b16 v[12:13], v76 offset:512
  v_mfma_f32_16x16x32_bf16 v[232:235], v[26:29], v[50:53], v[232:235]
  s_add_u32 s72, s72, 73728
  s_add_u32 m0, s73, 13312
  s_nop 0
  buffer_load_dwordx4 v75, s[24:27], s72 offen lds
  ds_read_b64_tr_b16 v[14:15], v77 offset:0
  ds_read_b64_tr_b16 v[16:17], v77 offset:512
  ds_read_b64_tr_b16 v[18:19], v78 offset:0
  v_mfma_f32_16x16x32_bf16 v[236:239], v[26:29], v[54:57], v[236:239]
  ds_read_b64_tr_b16 v[20:21], v78 offset:512
  ds_read_b64_tr_b16 v[22:23], v79 offset:0
  ds_read_b64_tr_b16 v[24:25], v79 offset:512
  v_mfma_f32_16x16x32_bf16 v[240:243], v[30:33], v[42:45], v[240:243]
  s_add_u32 s72, s72, 73728
  s_add_u32 m0, s73, 14336
  s_nop 0
  buffer_load_dwordx4 v74, s[24:27], s72 offen lds
  v_mfma_f32_16x16x32_bf16 v[244:247], v[30:33], v[46:49], v[244:247]
  v_mfma_f32_16x16x32_bf16 v[248:251], v[30:33], v[50:53], v[248:251]
  s_add_u32 s72, s72, 73728
  s_add_u32 m0, s73, 15360
  s_nop 0
  buffer_load_dwordx4 v75, s[24:27], s72 offen lds
  v_mfma_f32_16x16x32_bf16 v[252:255], v[30:33], v[54:57], v[252:255]
  s_cmp_eq_u32 s89, 8
  s_cbranch_scc1 GA_14
GR_15:
  s_waitcnt lgkmcnt(0)
  s_waitcnt vmcnt(8)
  v_mfma_f32_16x16x32_bf16 v[96:99], v[10:13], v[58:61], v[96:99]
  ds_read_b64_tr_b16 v[26:27], v76 offset:4096
  v_mfma_f32_16x16x32_bf16 v[100:103], v[10:13], v[62:65], v[100:103]
  ds_read_b64_tr_b16 v[28:29], v76 offset:4608
  v_mfma_f32_16x16x32_bf16 v[104:107], v[10:13], v[66:69], v[104:107]
  ds_read_b64_tr_b16 v[30:31], v77 offset:4096
  v_mfma_f32_16x16x32_bf16 v[108:111], v[10:13], v[70:73], v[108:111]
  ds_read_b64_tr_b16 v[32:33], v77 offset:4608
  v_mfma_f32_16x16x32_bf16 v[112:115], v[14:17], v[58:61], v[112:115]
  ds_read_b64_tr_b16 v[34:35], v78 offset:4096
  v_mfma_f32_16x16x32_bf16 v[116:119], v[14:17], v[62:65], v[116:119]
  ds_read_b64_tr_b16 v[36:37], v78 offset:4608
  v_mfma_f32_16x16x32_bf16 v[120:123], v[14:17], v[66:69], v[120:123]
  ds_read_b64_tr_b16 v[38:39], v79 offset:4096
  v_mfma_f32_16x16x32_bf16 v[124:127], v[14:17], v[70:73], v[124:127]
  ds_read_b64_tr_b16 v[40:41], v79 offset:4608
  v_mfma_f32_16x16x32_bf16 v[128:131], v[18:21], v[58:61], v[128:131]
  ds_read_b32 v86, v84 offset:72
  v_mfma_f32_16x16x32_bf16 v[132:135], v[18:21], v[62:65], v[132:135]
  v_mfma_f32_16x16x32_bf16 v[136:139], v[18:21], v[66:69], v[136:139]
  v_mfma_f32_16x16x32_bf16 v[140:143], v[18:21], v[70:73], v[140:143]
  v_mfma_f32_16x16x32_bf16 v[144:147], v[22:25], v[58:61], v[144:147]
  s_add_u32 s72, s75, s79
  s_add_u32 s72, s72, 1179648
  s_add_u32 s72, s72, s82
  s_add_u32 m0, s73, 0
  s_nop 0
  buffer_load_dwordx4 v87, s[24:27], s72 offen lds
  v_mfma_f32_16x16x32_bf16 v[148:151], v[22:25], v[62:65], v[148:151]
  v_mfma_f32_16x16x32_bf16 v[152:155], v[22:25], v[66:69], v[152:155]
  s_add_u32 s72, s72, 147456
  s_add_u32 m0, s73, 1024
  s_nop 0
  buffer_load_dwordx4 v87, s[24:27], s72 offen lds
  v_mfma_f32_16x16x32_bf16 v[156:159], v[22:25], v[70:73], v[156:159]
  s_cmp_eq_u32 s89, 9
  s_cbranch_scc1 GA_16
GR_17:
  s_waitcnt lgkmcnt(0)
  s_waitcnt vmcnt(6)
  v_readfirstlane_b32 s6, v86
  v_mfma_f32_16x16x32_bf16 v[160:163], v[26:29], v[58:61], v[160:163]
  s_nop 1
  s_cmp_ge_u32 s6, 4
  s_cbranch_scc1 XOK_18
  s_mov_b32 s95, 400000
W_19:
  ds_read_b32 v3, v84 offset:72
  s_waitcnt lgkmcnt(0)
  v_readfirstlane_b32 s6, v3
  s_nop 3
  s_cmp_ge_u32 s6, 4
  s_cbranch_scc1 WD_20
  s_sleep 1
  s_sub_u32 s95, s95, 1
  s_cmp_lg_u32 s95, 0
  s_cbranch_scc1 W_19
WD_20:
XOK_18:
  ds_read_b128 v[42:45], v82 offset:2048
  v_mfma_f32_16x16x32_bf16 v[164:167], v[26:29], v[62:65], v[164:167]
  ds_read_b128 v[46:49], v82 offset:20480
  v_mfma_f32_16x16x32_bf16 v[168:171], v[26:29], v[66:69], v[168:171]
  ds_read_b128 v[50:53], v82 offset:38912
  v_mfma_f32_16x16x32_bf16 v[172:175], v[26:29], v[70:73], v[172:175]
  ds_read_b128 v[54:57], v82 offset:57344
  v_mfma_f32_16x16x32_bf16 v[176:179], v[30:33], v[58:61], v[176:179]
  ds_read_b64_tr_b16 v[10:11], v76 offset:8192
  v_mfma_f32_16x16x32_bf16 v[180:183], v[30:33], v[62:65], v[180:183]
  ds_read_b64_tr_b16 v[12:13], v76 offset:8704
  v_mfma_f32_16x16x32_bf16 v[184:187], v[30:33], v[66:69], v[184:187]
  ds_read_b64_tr_b16 v[14:15], v77 offset:8192
  v_mfma_f32_16x16x32_bf16 v[188:191], v[30:33], v[70:73], v[188:191]
  ds_read_b64_tr_b16 v[16:17], v77 offset:8704
  v_mfma_f32_16x16x32_bf16 v[192:195], v[34:37], v[58:61], v[192:195]
  s_add_u32 s72, s75, s78
  s_add_u32 s72, s72, 1474560
  s_sub_u32 s72, s72, s82
  s_add_u32 m0, s73, 4096
  s_nop 0
  buffer_load_dwordx4 v74, s[24:27], s72 offen lds
  ds_read_b64_tr_b16 v[18:19], v78 offset:8192
  v_mfma_f32_16x16x32_bf16 v[196:199], v[34:37], v[62:65], v[196:199]
  ds_read_b64_tr_b16 v[20:21], v78 offset:8704
  v_mfma_f32_16x16x32_bf16 v[200:203], v[34:37], v[66:69], v[200:203]
  s_add_u32 s72, s72, 73728
  s_add_u32 m0, s73, 5120
  s_nop 0
  buffer_load_dwordx4 v75, s[24:27], s72 offen lds
  ds_read_b64_tr_b16 v[22:23], v79 offset:8192
  v_mfma_f32_16x16x32_bf16 v[204:207], v[34:37], v[70:73], v[204:207]
  ds_read_b64_tr_b16 v[24:25], v79 offset:8704
  v_mfma_f32_16x16x32_bf16 v[208:211], v[38:41], v[58:61], v[208:211]
  s_add_u32 s72, s72, 73728
  s_add_u32 m0, s73, 6144
  s_nop 0
  buffer_load_dwordx4 v74, s[24:27], s72 offen lds
  v_mfma_f32_16x16x32_bf16 v[212:215], v[38:41], v[62:65], v[212:215]
  v_mfma_f32_16x16x32_bf16 v[216:219], v[38:41], v[66:69], v[216:219]
  s_add_u32 s72, s72, 73728
  s_add_u32 m0, s73, 7168
  s_nop 0
  buffer_load_dwordx4 v75, s[24:27], s72 offen lds
  v_mfma_f32_16x16x32_bf16 v[220:223], v[38:41], v[70:73], v[220:223]
  s_cmp_eq_u32 s89, 10
  s_cbranch_scc1 GA_21
GR_22:
  s_waitcnt lgkmcnt(0)
  s_waitcnt vmcnt(6)
  v_mfma_f32_16x16x32_bf16 v[96:99], v[10:13], v[42:45], v[96:99]
  ds_read_b64_tr_b16 v[26:27], v76 offset:12288
  v_mfma_f32_16x16x32_bf16 v[100:103], v[10:13], v[46:49], v[100:103]
  ds_read_b64_tr_b16 v[28:29], v76 offset:12800
  v_mfma_f32_16x16x32_bf16 v[104:107], v[10:13], v[50:53], v[104:107]
  ds_read_b64_tr_b16 v[30:31], v77 offset:12288
  v_mfma_f32_16x16x32_bf16 v[108:111], v[10:13], v[54:57], v[108:111]
  ds_read_b64_tr_b16 v[32:33], v77 offset:12800
  v_mfma_f32_16x16x32_bf16 v[112:115], v[14:17], v[42:45], v[112:115]
  ds_read_b64_tr_b16 v[34:35], v78 offset:12288
  v_mfma_f32_16x16x32_bf16 v[116:119], v[14:17], v[46:49], v[116:119]
  ds_read_b64_tr_b16 v[36:37], v78 offset:12800
  v_mfma_f32_16x16x32_bf16 v[120:123], v[14:17], v[50:53], v[120:123]
  ds_read_b64_tr_b16 v[38:39], v79 offset:12288
  v_mfma_f32_16x16x32_bf16 v[124:127], v[14:17], v[54:57], v[124:127]
  ds_read_b64_tr_b16 v[40:41], v79 offset:12800
  v_mfma_f32_16x16x32_bf16 v[128:131], v[18:21], v[42:45], v[128:131]
  s_add_u32 s72, s75, s78
  s_add_u32 s72, s72, 1474688
  s_sub_u32 s72, s72, s82
  s_add_u32 m0, s73, 8192
  s_nop 0
  buffer_load_dwordx4 v74, s[24:27], s72 offen lds
  v_mfma_f32_16x16x32_bf16 v[132:135], v[18:21], v[46:49], v[132:135]
  v_mfma_f32_16x16x32_bf16 v[136:139], v[18:21], v[50:53], v[136:139]
  s_add_u32 s72, s72, 73728
  s_add_u32 m0, s73, 9216
  s_nop 0
  buffer_load_dwordx4 v75, s[24:27], s72 offen lds
  v_mfma_f32_16x16x32_bf16 v[140:143], v[18:21], v[54:57], v[140:143]
  v_mfma_f32_16x16x32_bf16 v[144:147], v[22:25], v[42:45], v[144:147]
  s_add_u32 s72, s72, 73728
  s_add_u32 m0, s73, 10240
  s_nop 0
  buffer_load_dwordx4 v74, s[24:27], s72 offen lds
  v_mfma_f32_16x16x32_bf16 v[148:151], v[22:25], v[46:49], v[148:151]
  v_mfma_f32_16x16x32_bf16 v[152:155], v[22:25], v[50:53], v[152:155]
  s_add_u32 s72, s72, 73728
  s_add_u32 m0, s73, 11264
  s_nop 0
  buffer_load_dwordx4 v75, s[24:27], s72 offen lds
  v_mfma_f32_16x16x32_bf16 v[156:159], v[22:25], v[54:57], v[156:159]
  s_cmp_eq_u32 s89, 11
  s_cbranch_scc1 GA_23
GR_24:
  s_waitcnt lgkmcnt(0)
  s_waitcnt vmcnt(8)
  v_mfma_f32_16x16x32_bf16 v[160:163], v[26:29], v[42:45], v[160:163]
  ds_read_b64_tr_b16 v[10:11], v80 offset:0
  v_mfma_f32_16x16x32_bf16 v[164:167], v[26:29], v[46:49], v[164:167]
  ds_read_b64_tr_b16 v[12:13], v80 offset:256
  v_mfma_f32_16x16x32_bf16 v[168:171], v[26:29], v[50:53], v[168:171]
  ds_read_b64_tr_b16 v[14:15], v81 offset:0
  v_mfma_f32_16x16x32_bf16 v[172:175], v[26:29], v[54:57], v[172:175]
  ds_read_b64_tr_b16 v[16:17], v81 offset:256
  v_mfma_f32_16x16x32_bf16 v[176:179], v[30:33], v[42:45], v[176:179]
  v_mfma_f32_16x16x32_bf16 v[180:183], v[30:33], v[46:49], v[180:183]
  v_mfma_f32_16x16x32_bf16 v[184:187], v[30:33], v[50:53], v[184:187]
  v_mfma_f32_16x16x32_bf16 v[188:191], v[30:33], v[54:57], v[188:191]
  v_mfma_f32_16x16x32_bf16 v[192:195], v[34:37], v[42:45], v[192:195]
  s_add_u32 s72, s75, s78
  s_add_u32 s72, s72, 1769472
  s_add_u32 s72, s72, s82
  s_add_u32 m0, s73, 12288
  s_nop 0
  buffer_load_dwordx4 v74, s[24:27], s72 offen lds
  v_mfma_f32_16x16x32_bf16 v[196:199], v[34:37], v[46:49], v[196:199]
  v_mfma_f32_16x16x32_bf16 v[200:203], v[34:37], v[50:53], v[200:203]
  s_add_u32 s72, s72, 73728
  s_add_u32 m0, s73, 13312
  s_nop 0
  buffer_load_dwordx4 v75, s[24:27], s72 offen lds
  v_mfma_f32_16x16x32_bf16 v[204:207], v[34:37], v[54:57], v[204:207]
  v_mfma_f32_16x16x32_bf16 v[208:211], v[38:41], v[42:45], v[208:211]
  s_add_u32 s72, s72, 73728
  s_add_u32 m0, s73, 14336
  s_nop 0
  buffer_load_dwordx4 v74, s[24:27], s72 offen lds
  v_mfma_f32_16x16x32_bf16 v[212:215], v[38:41], v[46:49], v[212:215]
  v_mfma_f32_16x16x32_bf16 v[216:219], v[38:41], v[50:53], v[216:219]
  s_add_u32 s72, s72, 73728
  s_add_u32 m0, s73, 15360
  s_nop 0
  buffer_load_dwordx4 v75, s[24:27], s72 offen lds
  v_mfma_f32_16x16x32_bf16 v[220:223], v[38:41], v[54:57], v[220:223]
  s_cmp_eq_u32 s89, 12
  s_cbranch_scc1 GA_25
GR_26:
  s_waitcnt lgkmcnt(0)
  s_waitcnt vmcnt(8)
  v_mfma_f32_16x16x32_bf16 v[224:227], v[10:13], v[42:45], v[224:227]
  s_add_u32 s72, s75, s78
  s_add_u32 s72, s72, 1769600
  s_add_u32 s72, s72, s82
  s_add_u32 m0, s73, 0
  s_nop 0
  buffer_load_dwordx4 v74, s[24:27], s72 offen lds
  ds_read_b128 v[58:61], v83 offset:2048
  ds_read_b128 v[62:65], v83 offset:20480
  ds_read_b128 v[66:69], v83 offset:38912
  v_mfma_f32_16x16x32_bf16 v[228:231], v[10:13], v[46:49], v[228:231]
  ds_read_b128 v[70:73], v83 offset:57344
  ds_read_b64_tr_b16 v[26:27], v76 offset:4096
  ds_read_b64_tr_b16 v[28:29], v76 offset:4608
  v_mfma_f32_16x16x32_bf16 v[232:235], v[10:13], v[50:53], v[232:235]
  s_add_u32 s72, s72, 73728
  s_add_u32 m0, s73, 1024
  s_nop 0
  buffer_load_dwordx4 v75, s[24:27], s72 offen lds
  ds_read_b64_tr_b16 v[30:31], v77 offset:4096
  ds_read_b64_tr_b16 v[32:33], v77 offset:4608
  ds_read_b64_tr_b16 v[34:35], v78 offset:4096
  v_mfma_f32_16x16x32_bf16 v[236:239], v[10:13], v[54:57], v[236:239]
  ds_read_b64_tr_b16 v[36:37], v78 offset:4608
  ds_read_b64_tr_b16 v[38:39], v79 offset:4096
  ds_read_b64_tr_b16 v[40:41], v79 offset:4608
  v_mfma_f32_16x16x32_bf16 v[240:243], v[14:17], v[42:45], v[240:243]
  s_add_u32 s72, s72, 73728
  s_add_u32 m0, s73, 2048
  s_nop 0
  buffer_load_dwordx4 v74, s[24:27], s72 offen lds
  v_mfma_f32_16x16x32_bf16 v[244:247], v[14:17], v[46:49], v[244:247]
  v_mfma_f32_16x16x32_bf16 v[248:251], v[14:17], v[50:53], v[248:251]
  s_add_u32 s72, s72, 73728
  s_add_u32 m0, s73, 3072
  s_nop 0
  buffer_load_dwordx4 v75, s[24:27], s72 offen lds
  v_mfma_f32_16x16x32_bf16 v[252:255], v[14:17], v[54:57], v[252:255]
  s_cmp_eq_u32 s89, 13
  s_cbranch_scc1 GA_27
GR_28:
  s_waitcnt lgkmcnt(0)
  s_waitcnt vmcnt(8)
  v_mfma_f32_16x16x32_bf16 v[96:99], v[26:29], v[58:61], v[96:99]
  ds_read_b64_tr_b16 v[10:11], v76 offset:8192
  v_mfma_f32_16x16x32_bf16 v[100:103], v[26:29], v[62:65], v[100:103]
  ds_read_b64_tr_b16 v[12:13], v76 offset:8704
  v_mfma_f32_16x16x32_bf16 v[104:107], v[26:29], v[66:69], v[104:107]
  ds_read_b64_tr_b16 v[14:15], v77 offset:8192
  v_mfma_f32_16x16x32_bf16 v[108:111], v[26:29], v[70:73], v[108:111]
  ds_read_b64_tr_b16 v[16:17], v77 offset:8704
  v_mfma_f32_16x16x32_bf16 v[112:115], v[30:33], v[58:61], v[112:115]
  ds_read_b64_tr_b16 v[18:19], v78 offset:8192
  v_mfma_f32_16x16x32_bf16 v[116:119], v[30:33], v[62:65], v[116:119]
  ds_read_b64_tr_b16 v[20:21], v78 offset:8704
  v_mfma_f32_16x16x32_bf16 v[120:123], v[30:33], v[66:69], v[120:123]
  ds_read_b64_tr_b16 v[22:23], v79 offset:8192
  v_mfma_f32_16x16x32_bf16 v[124:127], v[30:33], v[70:73], v[124:127]
  ds_read_b64_tr_b16 v[24:25], v79 offset:8704
  v_mfma_f32_16x16x32_bf16 v[128:131], v[34:37], v[58:61], v[128:131]
  ds_read_b32 v86, v84 offset:76
  v_mfma_f32_16x16x32_bf16 v[132:135], v[34:37], v[62:65], v[132:135]
  v_mfma_f32_16x16x32_bf16 v[136:139], v[34:37], v[66:69], v[136:139]
  v_mfma_f32_16x16x32_bf16 v[140:143], v[34:37], v[70:73], v[140:143]
  v_mfma_f32_16x16x32_bf16 v[144:147], v[38:41], v[58:61], v[144:147]
  s_add_u32 s72, s75, s79
  s_add_u32 s72, s72, 1769472
  s_add_u32 s72, s72, s82
  s_add_u32 m0, s73, 4096
  s_nop 0
  buffer_load_dwordx4 v87, s[24:27], s72 offen lds
  v_mfma_f32_16x16x32_bf16 v[148:151], v[38:41], v[62:65], v[148:151]
  v_mfma_f32_16x16x32_bf16 v[152:155], v[38:41], v[66:69], v[152:155]
  s_add_u32 s72, s72, 147456
  s_add_u32 m0, s73, 5120
  s_nop 0
  buffer_load_dwordx4 v87, s[24:27], s72 offen lds
  v_mfma_f32_16x16x32_bf16 v[156:159], v[38:41], v[70:73], v[156:159]
  s_cmp_eq_u32 s89, 14
  s_cbranch_scc1 GA_29
GR_30:
  s_waitcnt lgkmcnt(0)
  s_waitcnt vmcnt(6)
  v_readfirstlane_b32 s6, v86
  v_mfma_f32_16x16x32_bf16 v[160:163], v[10:13], v[58:61], v[160:163]
  s_nop 1
  s_cmp_ge_u32 s6, 4
  s_cbranch_scc1 XOK_31
  s_mov_b32 s95, 400000
W_32:
  ds_read_b32 v3, v84 offset:76
  s_waitcnt lgkmcnt(0)
  v_readfirstlane_b32 s6, v3
  s_nop 3
  s_cmp_ge_u32 s6, 4
  s_cbranch_scc1 WD_33
  s_sleep 1
  s_sub_u32 s95, s95, 1
  s_cmp_lg_u32 s95, 0
  s_cbranch_scc1 W_32
WD_33:
XOK_31:
  ds_read_b128 v[42:45], v82 offset:3072
  v_mfma_f32_16x16x32_bf16 v[164:167], v[10:13], v[62:65], v[164:167]
  ds_read_b128 v[46:49], v82 offset:21504
  v_mfma_f32_16x16x32_bf16 v[168:171], v[10:13], v[66:69], v[168:171]
  ds_read_b128 v[50:53], v82 offset:39936
  v_mfma_f32_16x16x32_bf16 v[172:175], v[10:13], v[70:73], v[172:175]
  ds_read_b128 v[54:57], v82 offset:58368
  v_mfma_f32_16x16x32_bf16 v[176:179], v[14:17], v[58:61], v[176:179]
  ds_read_b64_tr_b16 v[26:27], v76 offset:12288
  v_mfma_f32_16x16x32_bf16 v[180:183], v[14:17], v[62:65], v[180:183]
  ds_read_b64_tr_b16 v[28:29], v76 offset:12800
  v_mfma_f32_16x16x32_bf16 v[184:187], v[14:17], v[66:69], v[184:187]
  ds_read_b64_tr_b16 v[30:31], v77 offset:12288
  v_mfma_f32_16x16x32_bf16 v[188:191], v[14:17], v[70:73], v[188:191]
  ds_read_b64_tr_b16 v[32:33], v77 offset:12800
  v_mfma_f32_16x16x32_bf16 v[192:195], v[18:21], v[58:61], v[192:195]
  s_add_u32 s72, s75, s78
  s_add_u32 s72, s72, 2064384
  s_sub_u32 s72, s72, s82
  s_add_u32 m0, s73, 8192
  s_nop 0
  buffer_load_dwordx4 v74, s[24:27], s72 offen lds
  ds_read_b64_tr_b16 v[34:35], v78 offset:12288
  v_mfma_f32_16x16x32_bf16 v[196:199], v[18:21], v[62:65], v[196:199]
  ds_read_b64_tr_b16 v[36:37], v78 offset:12800
  v_mfma_f32_16x16x32_bf16 v[200:203], v[18:21], v[66:69], v[200:203]
  s_add_u32 s72, s72, 73728
  s_add_u32 m0, s73, 9216
  s_nop 0
  buffer_load_dwordx4 v75, s[24:27], s72 offen lds
  ds_read_b64_tr_b16 v[38:39], v79 offset:12288
  v_mfma_f32_16x16x32_bf16 v[204:207], v[18:21], v[70:73], v[204:207]
  ds_read_b64_tr_b16 v[40:41], v79 offset:12800
  v_mfma_f32_16x16x32_bf16 v[208:211], v[22:25], v[58:61], v[208:211]
  s_add_u32 s72, s72, 73728
  s_add_u32 m0, s73, 10240
  s_nop 0
  buffer_load_dwordx4 v74, s[24:27], s72 offen lds
  v_mfma_f32_16x16x32_bf16 v[212:215], v[22:25], v[62:65], v[212:215]
  v_mfma_f32_16x16x32_bf16 v[216:219], v[22:25], v[66:69], v[216:219]
  s_add_u32 s72, s72, 73728
  s_add_u32 m0, s73, 11264
  s_nop 0
  buffer_load_dwordx4 v75, s[24:27], s72 offen lds
  v_mfma_f32_16x16x32_bf16 v[220:223], v[22:25], v[70:73], v[220:223]
  s_cmp_eq_u32 s89, 15
  s_cbranch_scc1 GA_34
GR_35:
  s_waitcnt lgkmcnt(0)
  s_waitcnt vmcnt(6)
  v_mfma_f32_16x16x32_bf16 v[96:99], v[26:29], v[42:45], v[96:99]
  ds_read_b64_tr_b16 v[10:11], v76 offset:0
  v_mfma_f32_16x16x32_bf16 v[100:103], v[26:29], v[46:49], v[100:103]
  ds_read_b64_tr_b16 v[12:13], v76 offset:512
  v_mfma_f32_16x16x32_bf16 v[104:107], v[26:29], v[50:53], v[104:107]
  ds_read_b64_tr_b16 v[14:15], v77 offset:0
  v_mfma_f32_16x16x32_bf16 v[108:111], v[26:29], v[54:57], v[108:111]
  ds_read_b64_tr_b16 v[16:17], v77 offset:512
  v_mfma_f32_16x16x32_bf16 v[112:115], v[30:33], v[42:45], v[112:115]
  ds_read_b64_tr_b16 v[18:19], v78 offset:0
  v_mfma_f32_16x16x32_bf16 v[116:119], v[30:33], v[46:49], v[116:119]
  ds_read_b64_tr_b16 v[20:21], v78 offset:512
  v_mfma_f32_16x16x32_bf16 v[120:123], v[30:33], v[50:53], v[120:123]
  ds_read_b64_tr_b16 v[22:23], v79 offset:0
  v_mfma_f32_16x16x32_bf16 v[124:127], v[30:33], v[54:57], v[124:127]
  ds_read_b64_tr_b16 v[24:25], v79 offset:512
  v_mfma_f32_16x16x32_bf16 v[128:131], v[34:37], v[42:45], v[128:131]
  s_add_u32 s72, s75, s78
  s_add_u32 s72, s72, 2064512
  s_sub_u32 s72, s72, s82
  s_add_u32 m0, s73, 12288
  s_nop 0
  buffer_load_dwordx4 v74, s[24:27], s72 offen lds
  v_mfma_f32_16x16x32_bf16 v[132:135], v[34:37], v[46:49], v[132:135]
  v_mfma_f32_16x16x32_bf16 v[136:139], v[34:37], v[50:53], v[136:139]
  s_add_u32 s72, s72, 73728
  s_add_u32 m0, s73, 13312
  s_nop 0
  buffer_load_dwordx4 v75, s[24:27], s72 offen lds
  v_mfma_f32_16x16x32_bf16 v[140:143], v[34:37], v[54:57], v[140:143]
  v_mfma_f32_16x16x32_bf16 v[144:147], v[38:41], v[42:45], v[144:147]
  s_add_u32 s72, s72, 73728
  s_add_u32 m0, s73, 14336
  s_nop 0
  buffer_load_dwordx4 v74, s[24:27], s72 offen lds
  v_mfma_f32_16x16x32_bf16 v[148:151], v[38:41], v[46:49], v[148:151]
  v_mfma_f32_16x16x32_bf16 v[152:155], v[38:41], v[50:53], v[152:155]
  s_add_u32 s72, s72, 73728
  s_add_u32 m0, s73, 15360
  s_nop 0
  buffer_load_dwordx4 v75, s[24:27], s72 offen lds
  v_mfma_f32_16x16x32_bf16 v[156:159], v[38:41], v[54:57], v[156:159]
  s_cmp_eq_u32 s89, 16
  s_cbranch_scc1 GA_36
GR_37:
  s_waitcnt lgkmcnt(0)
  s_waitcnt vmcnt(8)
  v_mfma_f32_16x16x32_bf16 v[160:163], v[10:13], v[42:45], v[160:163]
  ds_read_b64_tr_b16 v[26:27], v80 offset:4096
  v_mfma_f32_16x16x32_bf16 v[164:167], v[10:13], v[46:49], v[164:167]
  ds_read_b64_tr_b16 v[28:29], v80 offset:4352
  v_mfma_f32_16x16x32_bf16 v[168:171], v[10:13], v[50:53], v[168:171]
  ds_read_b64_tr_b16 v[30:31], v81 offset:4096
  v_mfma_f32_16x16x32_bf16 v[172:175], v[10:13], v[54:57], v[172:175]
  ds_read_b64_tr_b16 v[32:33], v81 offset:4352
  v_mfma_f32_16x16x32_bf16 v[176:179], v[14:17], v[42:45], v[176:179]
  v_mfma_f32_16x16x32_bf16 v[180:183], v[14:17], v[46:49], v[180:183]
  v_mfma_f32_16x16x32_bf16 v[184:187], v[14:17], v[50:53], v[184:187]
  v_mfma_f32_16x16x32_bf16 v[188:191], v[14:17], v[54:57], v[188:191]
  v_mfma_f32_16x16x32_bf16 v[192:195], v[18:21], v[42:45], v[192:195]
  s_add_u32 s72, s75, s78
  s_add_u32 s72, s72, 2359296
  s_add_u32 s72, s72, s82
  s_add_u32 m0, s73, 0
  s_nop 0
  buffer_load_dwordx4 v74, s[24:27], s72 offen lds
  v_mfma_f32_16x16x32_bf16 v[196:199], v[18:21], v[46:49], v[196:199]
  v_mfma_f32_16x16x32_bf16 v[200:203], v[18:21], v[50:53], v[200:203]
  s_add_u32 s72, s72, 73728
  s_add_u32 m0, s73, 1024
  s_nop 0
  buffer_load_dwordx4 v75, s[24:27], s72 offen lds
  v_mfma_f32_16x16x32_bf16 v[204:207], v[18:21], v[54:57], v[204:207]
  v_mfma_f32_16x16x32_bf16 v[208:211], v[22:25], v[42:45], v[208:211]
  s_add_u32 s72, s72, 73728
  s_add_u32 m0, s73, 2048
  s_nop 0
  buffer_load_dwordx4 v74, s[24:27], s72 offen lds
  v_mfma_f32_16x16x32_bf16 v[212:215], v[22:25], v[46:49], v[212:215]
  v_mfma_f32_16x16x32_bf16 v[216:219], v[22:25], v[50:53], v[216:219]
  s_add_u32 s72, s72, 73728
  s_add_u32 m0, s73, 3072
  s_nop 0
  buffer_load_dwordx4 v75, s[24:27], s72 offen lds
  v_mfma_f32_16x16x32_bf16 v[220:223], v[22:25], v[54:57], v[220:223]
  s_cmp_eq_u32 s89, 17
  s_cbranch_scc1 GA_38
GR_39:
  s_waitcnt lgkmcnt(0)
  s_waitcnt vmcnt(8)
  v_mfma_f32_16x16x32_bf16 v[224:227], v[26:29], v[42:45], v[224:227]
  s_add_u32 s72, s75, s78
  s_add_u32 s72, s72, 2359424
  s_add_u32 s72, s72, s82
  s_add_u32 m0, s73, 4096
  s_nop 0
  buffer_load_dwordx4 v74, s[24:27], s72 offen lds
  ds_read_b128 v[58:61], v83 offset:3072
  ds_read_b128 v[62:65], v83 offset:21504
  ds_read_b128 v[66:69], v83 offset:39936
  v_mfma_f32_16x16x32_bf16 v[228:231], v[26:29], v[46:49], v[228:231]
  ds_read_b128 v[70:73], v83 offset:58368
  ds_read_b64_tr_b16 v[10:11], v76 offset:8192
  ds_read_b64_tr_b16 v[12:13], v76 offset:8704
  v_mfma_f32_16x16x32_bf16 v[232:235], v[26:29], v[50:53], v[232:235]
  s_add_u32 s72, s72, 73728
  s_add_u32 m0, s73, 5120
  s_nop 0
  buffer_load_dwordx4 v75, s[24:27], s72 offen lds
  ds_read_b64_tr_b16 v[14:15], v77 offset:8192
  ds_read_b64_tr_b16 v[16:17], v77 offset:8704
  ds_read_b64_tr_b16 v[18:19], v78 offset:8192
  v_mfma_f32_16x16x32_bf16 v[236:239], v[26:29], v[54:57], v[236:239]
  ds_read_b64_tr_b16 v[20:21], v78 offset:8704
  ds_read_b64_tr_b16 v[22:23], v79 offset:8192
  ds_read_b64_tr_b16 v[24:25], v79 offset:8704
  v_mfma_f32_16x16x32_bf16 v[240:243], v[30:33], v[42:45], v[240:243]
  s_add_u32 s72, s72, 73728
  s_add_u32 m0, s73, 6144
  s_nop 0
  buffer_load_dwordx4 v74, s[24:27], s72 offen lds
  v_mfma_f32_16x16x32_bf16 v[244:247], v[30:33], v[46:49], v[244:247]
  v_mfma_f32_16x16x32_bf16 v[248:251], v[30:33], v[50:53], v[248:251]
  s_add_u32 s72, s72, 73728
  s_add_u32 m0, s73, 7168
  s_nop 0
  buffer_load_dwordx4 v75, s[24:27], s72 offen lds
  v_mfma_f32_16x16x32_bf16 v[252:255], v[30:33], v[54:57], v[252:255]
  s_cmp_eq_u32 s89, 18
  s_cbranch_scc1 GA_40
GR_41:
  s_waitcnt lgkmcnt(0)
  s_waitcnt vmcnt(8)
  v_mfma_f32_16x16x32_bf16 v[96:99], v[10:13], v[58:61], v[96:99]
  ds_read_b64_tr_b16 v[26:27], v76 offset:12288
  v_mfma_f32_16x16x32_bf16 v[100:103], v[10:13], v[62:65], v[100:103]
  ds_read_b64_tr_b16 v[28:29], v76 offset:12800
  v_mfma_f32_16x16x32_bf16 v[104:107], v[10:13], v[66:69], v[104:107]
  ds_read_b64_tr_b16 v[30:31], v77 offset:12288
  v_mfma_f32_16x16x32_bf16 v[108:111], v[10:13], v[70:73], v[108:111]
  ds_read_b64_tr_b16 v[32:33], v77 offset:12800
  v_mfma_f32_16x16x32_bf16 v[112:115], v[14:17], v[58:61], v[112:115]
  ds_read_b64_tr_b16 v[34:35], v78 offset:12288
  v_mfma_f32_16x16x32_bf16 v[116:119], v[14:17], v[62:65], v[116:119]
  ds_read_b64_tr_b16 v[36:37], v78 offset:12800
  v_mfma_f32_16x16x32_bf16 v[120:123], v[14:17], v[66:69], v[120:123]
  ds_read_b64_tr_b16 v[38:39], v79 offset:12288
  v_mfma_f32_16x16x32_bf16 v[124:127], v[14:17], v[70:73], v[124:127]
  ds_read_b64_tr_b16 v[40:41], v79 offset:12800
  v_mfma_f32_16x16x32_bf16 v[128:131], v[18:21], v[58:61], v[128:131]
  ds_read_b32 v86, v84 offset:80
  v_mfma_f32_16x16x32_bf16 v[132:135], v[18:21], v[62:65], v[132:135]
  v_mfma_f32_16x16x32_bf16 v[136:139], v[18:21], v[66:69], v[136:139]
  v_mfma_f32_16x16x32_bf16 v[140:143], v[18:21], v[70:73], v[140:143]
  v_mfma_f32_16x16x32_bf16 v[144:147], v[22:25], v[58:61], v[144:147]
  s_add_u32 s72, s75, s79
  s_add_u32 s72, s72, 2359296
  s_add_u32 s72, s72, s82
  s_add_u32 m0, s73, 8192
  s_nop 0
  buffer_load_dwordx4 v87, s[24:27], s72 offen lds
  v_mfma_f32_16x16x32_bf16 v[148:151], v[22:25], v[62:65], v[148:151]
  v_mfma_f32_16x16x32_bf16 v[152:155], v[22:25], v[66:69], v[152:155]
  s_add_u32 s72, s72, 147456
  s_add_u32 m0, s73, 9216
  s_nop 0
  buffer_load_dwordx4 v87, s[24:27], s72 offen lds
  v_mfma_f32_16x16x32_bf16 v[156:159], v[22:25], v[70:73], v[156:159]
  s_cmp_eq_u32 s89, 19
  s_cbranch_scc1 GA_42
GR_43:
  s_waitcnt lgkmcnt(0)
  s_waitcnt vmcnt(6)
  v_readfirstlane_b32 s6, v86
  v_mfma_f32_16x16x32_bf16 v[160:163], v[26:29], v[58:61], v[160:163]
  s_nop 1
  s_cmp_ge_u32 s6, 4
  s_cbranch_scc1 XOK_44
  s_mov_b32 s95, 400000
W_45:
  ds_read_b32 v3, v84 offset:80
  s_waitcnt lgkmcnt(0)
  v_readfirstlane_b32 s6, v3
  s_nop 3
  s_cmp_ge_u32 s6, 4
  s_cbranch_scc1 WD_46
  s_sleep 1
  s_sub_u32 s95, s95, 1
  s_cmp_lg_u32 s95, 0
  s_cbranch_scc1 W_45
WD_46:
XOK_44:
  ds_read_b128 v[42:45], v82 offset:4096
  v_mfma_f32_16x16x32_bf16 v[164:167], v[26:29], v[62:65], v[164:167]
  ds_read_b128 v[46:49], v82 offset:22528
  v_mfma_f32_16x16x32_bf16 v[168:171], v[26:29], v[66:69], v[168:171]
  ds_read_b128 v[50:53], v82 offset:40960
  v_mfma_f32_16x16x32_bf16 v[172:175], v[26:29], v[70:73], v[172:175]
  ds_read_b128 v[54:57], v82 offset:59392
  v_mfma_f32_16x16x32_bf16 v[176:179], v[30:33], v[58:61], v[176:179]
  ds_read_b64_tr_b16 v[10:11], v76 offset:0
  v_mfma_f32_16x16x32_bf16 v[180:183], v[30:33], v[62:65], v[180:183]
  ds_read_b64_tr_b16 v[12:13], v76 offset:512
  v_mfma_f32_16x16x32_bf16 v[184:187], v[30:33], v[66:69], v[184:187]
  ds_read_b64_tr_b16 v[14:15], v77 offset:0
  v_mfma_f32_16x16x32_bf16 v[188:191], v[30:33], v[70:73], v[188:191]
  ds_read_b64_tr_b16 v[16:17], v77 offset:512
  v_mfma_f32_16x16x32_bf16 v[192:195], v[34:37], v[58:61], v[192:195]
  s_add_u32 s72, s75, s78
  s_add_u32 s72, s72, 2654208
  s_sub_u32 s72, s72, s82
  s_add_u32 m0, s73, 12288
  s_nop 0
  buffer_load_dwordx4 v74, s[24:27], s72 offen lds
  ds_read_b64_tr_b16 v[18:19], v78 offset:0
  v_mfma_f32_16x16x32_bf16 v[196:199], v[34:37], v[62:65], v[196:199]
  ds_read_b64_tr_b16 v[20:21], v78 offset:512
  v_mfma_f32_16x16x32_bf16 v[200:203], v[34:37], v[66:69], v[200:203]
  s_add_u32 s72, s72, 73728
  s_add_u32 m0, s73, 13312
  s_nop 0
  buffer_load_dwordx4 v75, s[24:27], s72 offen lds
  ds_read_b64_tr_b16 v[22:23], v79 offset:0
  v_mfma_f32_16x16x32_bf16 v[204:207], v[34:37], v[70:73], v[204:207]
  ds_read_b64_tr_b16 v[24:25], v79 offset:512
  v_mfma_f32_16x16x32_bf16 v[208:211], v[38:41], v[58:61], v[208:211]
  s_add_u32 s72, s72, 73728
  s_add_u32 m0, s73, 14336
  s_nop 0
  buffer_load_dwordx4 v74, s[24:27], s72 offen lds
  v_mfma_f32_16x16x32_bf16 v[212:215], v[38:41], v[62:65], v[212:215]
  v_mfma_f32_16x16x32_bf16 v[216:219], v[38:41], v[66:69], v[216:219]
  s_add_u32 s72, s72, 73728
  s_add_u32 m0, s73, 15360
  s_nop 0
  buffer_load_dwordx4 v75, s[24:27], s72 offen lds
  v_mfma_f32_16x16x32_bf16 v[220:223], v[38:41], v[70:73], v[220:223]
  s_cmp_eq_u32 s89, 20
  s_cbranch_scc1 GA_47
GR_48:
  s_waitcnt lgkmcnt(0)
  s_waitcnt vmcnt(6)
  v_mfma_f32_16x16x32_bf16 v[96:99], v[10:13], v[42:45], v[96:99]
  ds_read_b64_tr_b16 v[26:27], v76 offset:4096
  v_mfma_f32_16x16x32_bf16 v[100:103], v[10:13], v[46:49], v[100:103]
  ds_read_b64_tr_b16 v[28:29], v76 offset:4608
  v_mfma_f32_16x16x32_bf16 v[104:107], v[10:13], v[50:53], v[104:107]
  ds_read_b64_tr_b16 v[30:31], v77 offset:4096
  v_mfma_f32_16x16x32_bf16 v[108:111], v[10:13], v[54:57], v[108:111]
  ds_read_b64_tr_b16 v[32:33], v77 offset:4608
  v_mfma_f32_16x16x32_bf16 v[112:115], v[14:17], v[42:45], v[112:115]
  ds_read_b64_tr_b16 v[34:35], v78 offset:4096
  v_mfma_f32_16x16x32_bf16 v[116:119], v[14:17], v[46:49], v[116:119]
  ds_read_b64_tr_b16 v[36:37], v78 offset:4608
  v_mfma_f32_16x16x32_bf16 v[120:123], v[14:17], v[50:53], v[120:123]
  ds_read_b64_tr_b16 v[38:39], v79 offset:4096
  v_mfma_f32_16x16x32_bf16 v[124:127], v[14:17], v[54:57], v[124:127]
  ds_read_b64_tr_b16 v[40:41], v79 offset:4608
  v_mfma_f32_16x16x32_bf16 v[128:131], v[18:21], v[42:45], v[128:131]
  s_add_u32 s72, s75, s78
  s_add_u32 s72, s72, 2654336
  s_sub_u32 s72, s72, s82
  s_add_u32 m0, s73, 0
  s_nop 0
  buffer_load_dwordx4 v74, s[24:27], s72 offen lds
  v_mfma_f32_16x16x32_bf16 v[132:135], v[18:21], v[46:49], v[132:135]
  v_mfma_f32_16x16x32_bf16 v[136:139], v[18:21], v[50:53], v[136:139]
  s_add_u32 s72, s72, 73728
  s_add_u32 m0, s73, 1024
  s_nop 0
  buffer_load_dwordx4 v75, s[24:27], s72 offen lds
  v_mfma_f32_16x16x32_bf16 v[140:143], v[18:21], v[54:57], v[140:143]
  v_mfma_f32_16x16x32_bf16 v[144:147], v[22:25], v[42:45], v[144:147]
  s_add_u32 s72, s72, 73728
  s_add_u32 m0, s73, 2048
  s_nop 0
  buffer_load_dwordx4 v74, s[24:27], s72 offen lds
  v_mfma_f32_16x16x32_bf16 v[148:151], v[22:25], v[46:49], v[148:151]
  v_mfma_f32_16x16x32_bf16 v[152:155], v[22:25], v[50:53], v[152:155]
  s_add_u32 s72, s72, 73728
  s_add_u32 m0, s73, 3072
  s_nop 0
  buffer_load_dwordx4 v75, s[24:27], s72 offen lds
  v_mfma_f32_16x16x32_bf16 v[156:159], v[22:25], v[54:57], v[156:159]
  s_cmp_eq_u32 s89, 21
  s_cbranch_scc1 GA_49
GR_50:
  s_waitcnt lgkmcnt(0)
  s_waitcnt vmcnt(8)
  v_mfma_f32_16x16x32_bf16 v[160:163], v[26:29], v[42:45], v[160:163]
  ds_read_b64_tr_b16 v[10:11], v80 offset:8192
  v_mfma_f32_16x16x32_bf16 v[164:167], v[26:29], v[46:49], v[164:167]
  ds_read_b64_tr_b16 v[12:13], v80 offset:8448
  v_mfma_f32_16x16x32_bf16 v[168:171], v[26:29], v[50:53], v[168:171]
  ds_read_b64_tr_b16 v[14:15], v81 offset:8192
  v_mfma_f32_16x16x32_bf16 v[172:175], v[26:29], v[54:57], v[172:175]
  ds_read_b64_tr_b16 v[16:17], v81 offset:8448
  v_mfma_f32_16x16x32_bf16 v[176:179], v[30:33], v[42:45], v[176:179]
  v_mfma_f32_16x16x32_bf16 v[180:183], v[30:33], v[46:49], v[180:183]
  v_mfma_f32_16x16x32_bf16 v[184:187], v[30:33], v[50:53], v[184:187]
  v_mfma_f32_16x16x32_bf16 v[188:191], v[30:33], v[54:57], v[188:191]
  v_mfma_f32_16x16x32_bf16 v[192:195], v[34:37], v[42:45], v[192:195]
  s_add_u32 s72, s75, s78
  s_add_u32 s72, s72, 2949120
  s_add_u32 s72, s72, s82
  s_add_u32 m0, s73, 4096
  s_nop 0
  buffer_load_dwordx4 v74, s[24:27], s72 offen lds
  v_mfma_f32_16x16x32_bf16 v[196:199], v[34:37], v[46:49], v[196:199]
  v_mfma_f32_16x16x32_bf16 v[200:203], v[34:37], v[50:53], v[200:203]
  s_add_u32 s72, s72, 73728
  s_add_u32 m0, s73, 5120
  s_nop 0
  buffer_load_dwordx4 v75, s[24:27], s72 offen lds
  v_mfma_f32_16x16x32_bf16 v[204:207], v[34:37], v[54:57], v[204:207]
  v_mfma_f32_16x16x32_bf16 v[208:211], v[38:41], v[42:45], v[208:211]
  s_add_u32 s72, s72, 73728
  s_add_u32 m0, s73, 6144
  s_nop 0
  buffer_load_dwordx4 v74, s[24:27], s72 offen lds
  v_mfma_f32_16x16x32_bf16 v[212:215], v[38:41], v[46:49], v[212:215]
  v_mfma_f32_16x16x32_bf16 v[216:219], v[38:41], v[50:53], v[216:219]
  s_add_u32 s72, s72, 73728
  s_add_u32 m0, s73, 7168
  s_nop 0
  buffer_load_dwordx4 v75, s[24:27], s72 offen lds
  v_mfma_f32_16x16x32_bf16 v[220:223], v[38:41], v[54:57], v[220:223]
  s_cmp_eq_u32 s89, 22
  s_cbranch_scc1 GA_51
GR_52:
  s_waitcnt lgkmcnt(0)
  s_waitcnt vmcnt(8)
  v_mfma_f32_16x16x32_bf16 v[224:227], v[10:13], v[42:45], v[224:227]
  s_add_u32 s72, s75, s78
  s_add_u32 s72, s72, 2949248
  s_add_u32 s72, s72, s82
  s_add_u32 m0, s73, 8192
  s_nop 0
  buffer_load_dwordx4 v74, s[24:27], s72 offen lds
  ds_read_b128 v[58:61], v83 offset:4096
  ds_read_b128 v[62:65], v83 offset:22528
  ds_read_b128 v[66:69], v83 offset:40960
  v_mfma_f32_16x16x32_bf16 v[228:231], v[10:13], v[46:49], v[228:231]
  ds_read_b128 v[70:73], v83 offset:59392
  ds_read_b64_tr_b16 v[26:27], v76 offset:12288
  ds_read_b64_tr_b16 v[28:29], v76 offset:12800
  v_mfma_f32_16x16x32_bf16 v[232:235], v[10:13], v[50:53], v[232:235]
  s_add_u32 s72, s72, 73728
  s_add_u32 m0, s73, 9216
  s_nop 0
  buffer_load_dwordx4 v75, s[24:27], s72 offen lds
  ds_read_b64_tr_b16 v[30:31], v77 offset:12288
  ds_read_b64_tr_b16 v[32:33], v77 offset:12800
  ds_read_b64_tr_b16 v[34:35], v78 offset:12288
  v_mfma_f32_16x16x32_bf16 v[236:239], v[10:13], v[54:57], v[236:239]
  ds_read_b64_tr_b16 v[36:37], v78 offset:12800
  ds_read_b64_tr_b16 v[38:39], v79 offset:12288
  ds_read_b64_tr_b16 v[40:41], v79 offset:12800
  v_mfma_f32_16x16x32_bf16 v[240:243], v[14:17], v[42:45], v[240:243]
  s_add_u32 s72, s72, 73728
  s_add_u32 m0, s73, 10240
  s_nop 0
  buffer_load_dwordx4 v74, s[24:27], s72 offen lds
  v_mfma_f32_16x16x32_bf16 v[244:247], v[14:17], v[46:49], v[244:247]
  v_mfma_f32_16x16x32_bf16 v[248:251], v[14:17], v[50:53], v[248:251]
  s_add_u32 s72, s72, 73728
  s_add_u32 m0, s73, 11264
  s_nop 0
  buffer_load_dwordx4 v75, s[24:27], s72 offen lds
  v_mfma_f32_16x16x32_bf16 v[252:255], v[14:17], v[54:57], v[252:255]
  s_cmp_eq_u32 s89, 23
  s_cbranch_scc1 GA_53
GR_54:
  s_waitcnt lgkmcnt(0)
  s_waitcnt vmcnt(8)
  v_mfma_f32_16x16x32_bf16 v[96:99], v[26:29], v[58:61], v[96:99]
  ds_read_b64_tr_b16 v[10:11], v76 offset:0
  v_mfma_f32_16x16x32_bf16 v[100:103], v[26:29], v[62:65], v[100:103]
  ds_read_b64_tr_b16 v[12:13], v76 offset:512
  v_mfma_f32_16x16x32_bf16 v[104:107], v[26:29], v[66:69], v[104:107]
  ds_read_b64_tr_b16 v[14:15], v77 offset:0
  v_mfma_f32_16x16x32_bf16 v[108:111], v[26:29], v[70:73], v[108:111]
  ds_read_b64_tr_b16 v[16:17], v77 offset:512
  v_mfma_f32_16x16x32_bf16 v[112:115], v[30:33], v[58:61], v[112:115]
  ds_read_b64_tr_b16 v[18:19], v78 offset:0
  v_mfma_f32_16x16x32_bf16 v[116:119], v[30:33], v[62:65], v[116:119]
  ds_read_b64_tr_b16 v[20:21], v78 offset:512
  v_mfma_f32_16x16x32_bf16 v[120:123], v[30:33], v[66:69], v[120:123]
  ds_read_b64_tr_b16 v[22:23], v79 offset:0
  v_mfma_f32_16x16x32_bf16 v[124:127], v[30:33], v[70:73], v[124:127]
  ds_read_b64_tr_b16 v[24:25], v79 offset:512
  v_mfma_f32_16x16x32_bf16 v[128:131], v[34:37], v[58:61], v[128:131]
  ds_read_b32 v86, v84 offset:84
  v_mfma_f32_16x16x32_bf16 v[132:135], v[34:37], v[62:65], v[132:135]
  v_mfma_f32_16x16x32_bf16 v[136:139], v[34:37], v[66:69], v[136:139]
  v_mfma_f32_16x16x32_bf16 v[140:143], v[34:37], v[70:73], v[140:143]
  v_mfma_f32_16x16x32_bf16 v[144:147], v[38:41], v[58:61], v[144:147]
  s_add_u32 s72, s75, s79
  s_add_u32 s72, s72, 2949120
  s_add_u32 s72, s72, s82
  s_add_u32 m0, s73, 12288
  s_nop 0
  buffer_load_dwordx4 v87, s[24:27], s72 offen lds
  v_mfma_f32_16x16x32_bf16 v[148:151], v[38:41], v[62:65], v[148:151]
  v_mfma_f32_16x16x32_bf16 v[152:155], v[38:41], v[66:69], v[152:155]
  s_add_u32 s72, s72, 147456
  s_add_u32 m0, s73, 13312
  s_nop 0
  buffer_load_dwordx4 v87, s[24:27], s72 offen lds
  v_mfma_f32_16x16x32_bf16 v[156:159], v[38:41], v[70:73], v[156:159]
  s_cmp_eq_u32 s89, 24
  s_cbranch_scc1 GA_55
GR_56:
  s_waitcnt lgkmcnt(0)
  s_waitcnt vmcnt(6)
  v_readfirstlane_b32 s6, v86
  v_mfma_f32_16x16x32_bf16 v[160:163], v[10:13], v[58:61], v[160:163]
  s_nop 1
  s_cmp_ge_u32 s6, 4
  s_cbranch_scc1 XOK_57
  s_mov_b32 s95, 400000
W_58:
  ds_read_b32 v3, v84 offset:84
  s_waitcnt lgkmcnt(0)
  v_readfirstlane_b32 s6, v3
  s_nop 3
  s_cmp_ge_u32 s6, 4
  s_cbranch_scc1 WD_59
  s_sleep 1
  s_sub_u32 s95, s95, 1
  s_cmp_lg_u32 s95, 0
  s_cbranch_scc1 W_58
WD_59:
XOK_57:
  ds_read_b128 v[42:45], v82 offset:5120
  v_mfma_f32_16x16x32_bf16 v[164:167], v[10:13], v[62:65], v[164:167]
  ds_read_b128 v[46:49], v82 offset:23552
  v_mfma_f32_16x16x32_bf16 v[168:171], v[10:13], v[66:69], v[168:171]
  ds_read_b128 v[50:53], v82 offset:41984
  v_mfma_f32_16x16x32_bf16 v[172:175], v[10:13], v[70:73], v[172:175]
  ds_read_b128 v[54:57], v82 offset:60416
  v_mfma_f32_16x16x32_bf16 v[176:179], v[14:17], v[58:61], v[176:179]
  ds_read_b64_tr_b16 v[26:27], v76 offset:4096
  v_mfma_f32_16x16x32_bf16 v[180:183], v[14:17], v[62:65], v[180:183]
  ds_read_b64_tr_b16 v[28:29], v76 offset:4608
  v_mfma_f32_16x16x32_bf16 v[184:187], v[14:17], v[66:69], v[184:187]
  ds_read_b64_tr_b16 v[30:31], v77 offset:4096
  v_mfma_f32_16x16x32_bf16 v[188:191], v[14:17], v[70:73], v[188:191]
  ds_read_b64_tr_b16 v[32:33], v77 offset:4608
  v_mfma_f32_16x16x32_bf16 v[192:195], v[18:21], v[58:61], v[192:195]
  s_add_u32 s72, s75, s78
  s_add_u32 s72, s72, 3244032
  s_sub_u32 s72, s72, s82
  s_add_u32 m0, s73, 0
  s_nop 0
  buffer_load_dwordx4 v74, s[24:27], s72 offen lds
  ds_read_b64_tr_b16 v[34:35], v78 offset:4096
  v_mfma_f32_16x16x32_bf16 v[196:199], v[18:21], v[62:65], v[196:199]
  ds_read_b64_tr_b16 v[36:37], v78 offset:4608
  v_mfma_f32_16x16x32_bf16 v[200:203], v[18:21], v[66:69], v[200:203]
  s_add_u32 s72, s72, 73728
  s_add_u32 m0, s73, 1024
  s_nop 0
  buffer_load_dwordx4 v75, s[24:27], s72 offen lds
  ds_read_b64_tr_b16 v[38:39], v79 offset:4096
  v_mfma_f32_16x16x32_bf16 v[204:207], v[18:21], v[70:73], v[204:207]
  ds_read_b64_tr_b16 v[40:41], v79 offset:4608
  v_mfma_f32_16x16x32_bf16 v[208:211], v[22:25], v[58:61], v[208:211]
  s_add_u32 s72, s72, 73728
  s_add_u32 m0, s73, 2048
  s_nop 0
  buffer_load_dwordx4 v74, s[24:27], s72 offen lds
  v_mfma_f32_16x16x32_bf16 v[212:215], v[22:25], v[62:65], v[212:215]
  v_mfma_f32_16x16x32_bf16 v[216:219], v[22:25], v[66:69], v[216:219]
  s_add_u32 s72, s72, 73728
  s_add_u32 m0, s73, 3072
  s_nop 0
  buffer_load_dwordx4 v75, s[24:27], s72 offen lds
  v_mfma_f32_16x16x32_bf16 v[220:223], v[22:25], v[70:73], v[220:223]
  s_cmp_eq_u32 s89, 25
  s_cbranch_scc1 GA_60
GR_61:
  s_waitcnt lgkmcnt(0)
  s_waitcnt vmcnt(6)
  v_mfma_f32_16x16x32_bf16 v[96:99], v[26:29], v[42:45], v[96:99]
  ds_read_b64_tr_b16 v[10:11], v76 offset:8192
  v_mfma_f32_16x16x32_bf16 v[100:103], v[26:29], v[46:49], v[100:103]
  ds_read_b64_tr_b16 v[12:13], v76 offset:8704
  v_mfma_f32_16x16x32_bf16 v[104:107], v[26:29], v[50:53], v[104:107]
  ds_read_b64_tr_b16 v[14:15], v77 offset:8192
  v_mfma_f32_16x16x32_bf16 v[108:111], v[26:29], v[54:57], v[108:111]
  ds_read_b64_tr_b16 v[16:17], v77 offset:8704
  v_mfma_f32_16x16x32_bf16 v[112:115], v[30:33], v[42:45], v[112:115]
  ds_read_b64_tr_b16 v[18:19], v78 offset:8192
  v_mfma_f32_16x16x32_bf16 v[116:119], v[30:33], v[46:49], v[116:119]
  ds_read_b64_tr_b16 v[20:21], v78 offset:8704
  v_mfma_f32_16x16x32_bf16 v[120:123], v[30:33], v[50:53], v[120:123]
  ds_read_b64_tr_b16 v[22:23], v79 offset:8192
  v_mfma_f32_16x16x32_bf16 v[124:127], v[30:33], v[54:57], v[124:127]
  ds_read_b64_tr_b16 v[24:25], v79 offset:8704
  v_mfma_f32_16x16x32_bf16 v[128:131], v[34:37], v[42:45], v[128:131]
  s_add_u32 s72, s75, s78
  s_add_u32 s72, s72, 3244160
  s_sub_u32 s72, s72, s82
  s_add_u32 m0, s73, 4096
  s_nop 0
  buffer_load_dwordx4 v74, s[24:27], s72 offen lds
  v_mfma_f32_16x16x32_bf16 v[132:135], v[34:37], v[46:49], v[132:135]
  v_mfma_f32_16x16x32_bf16 v[136:139], v[34:37], v[50:53], v[136:139]
  s_add_u32 s72, s72, 73728
  s_add_u32 m0, s73, 5120
  s_nop 0
  buffer_load_dwordx4 v75, s[24:27], s72 offen lds
  v_mfma_f32_16x16x32_bf16 v[140:143], v[34:37], v[54:57], v[140:143]
  v_mfma_f32_16x16x32_bf16 v[144:147], v[38:41], v[42:45], v[144:147]
  s_add_u32 s72, s72, 73728
  s_add_u32 m0, s73, 6144
  s_nop 0
  buffer_load_dwordx4 v74, s[24:27], s72 offen lds
  v_mfma_f32_16x16x32_bf16 v[148:151], v[38:41], v[46:49], v[148:151]
  v_mfma_f32_16x16x32_bf16 v[152:155], v[38:41], v[50:53], v[152:155]
  s_add_u32 s72, s72, 73728
  s_add_u32 m0, s73, 7168
  s_nop 0
  buffer_load_dwordx4 v75, s[24:27], s72 offen lds
  v_mfma_f32_16x16x32_bf16 v[156:159], v[38:41], v[54:57], v[156:159]
  s_cmp_eq_u32 s89, 26
  s_cbranch_scc1 GA_62
GR_63:
  s_waitcnt lgkmcnt(0)
  s_waitcnt vmcnt(8)
  v_mfma_f32_16x16x32_bf16 v[160:163], v[10:13], v[42:45], v[160:163]
  ds_read_b64_tr_b16 v[26:27], v80 offset:12288
  v_mfma_f32_16x16x32_bf16 v[164:167], v[10:13], v[46:49], v[164:167]
  ds_read_b64_tr_b16 v[28:29], v80 offset:12544
  v_mfma_f32_16x16x32_bf16 v[168:171], v[10:13], v[50:53], v[168:171]
  ds_read_b64_tr_b16 v[30:31], v81 offset:12288
  v_mfma_f32_16x16x32_bf16 v[172:175], v[10:13], v[54:57], v[172:175]
  ds_read_b64_tr_b16 v[32:33], v81 offset:12544
  v_mfma_f32_16x16x32_bf16 v[176:179], v[14:17], v[42:45], v[176:179]
  v_mfma_f32_16x16x32_bf16 v[180:183], v[14:17], v[46:49], v[180:183]
  v_mfma_f32_16x16x32_bf16 v[184:187], v[14:17], v[50:53], v[184:187]
  v_mfma_f32_16x16x32_bf16 v[188:191], v[14:17], v[54:57], v[188:191]
  v_mfma_f32_16x16x32_bf16 v[192:195], v[18:21], v[42:45], v[192:195]
  s_add_u32 s72, s75, s78
  s_add_u32 s72, s72, 3538944
  s_add_u32 s72, s72, s82
  s_add_u32 m0, s73, 8192
  s_nop 0
  buffer_load_dwordx4 v74, s[24:27], s72 offen lds
  v_mfma_f32_16x16x32_bf16 v[196:199], v[18:21], v[46:49], v[196:199]
  v_mfma_f32_16x16x32_bf16 v[200:203], v[18:21], v[50:53], v[200:203]
  s_add_u32 s72, s72, 73728
  s_add_u32 m0, s73, 9216
  s_nop 0
  buffer_load_dwordx4 v75, s[24:27], s72 offen lds
  v_mfma_f32_16x16x32_bf16 v[204:207], v[18:21], v[54:57], v[204:207]
  v_mfma_f32_16x16x32_bf16 v[208:211], v[22:25], v[42:45], v[208:211]
  s_add_u32 s72, s72, 73728
  s_add_u32 m0, s73, 10240
  s_nop 0
  buffer_load_dwordx4 v74, s[24:27], s72 offen lds
  v_mfma_f32_16x16x32_bf16 v[212:215], v[22:25], v[46:49], v[212:215]
  v_mfma_f32_16x16x32_bf16 v[216:219], v[22:25], v[50:53], v[216:219]
  s_add_u32 s72, s72, 73728
  s_add_u32 m0, s73, 11264
  s_nop 0
  buffer_load_dwordx4 v75, s[24:27], s72 offen lds
  v_mfma_f32_16x16x32_bf16 v[220:223], v[22:25], v[54:57], v[220:223]
  s_cmp_eq_u32 s89, 27
  s_cbranch_scc1 GA_64
GR_65:
  s_waitcnt lgkmcnt(0)
  s_waitcnt vmcnt(8)
  v_mfma_f32_16x16x32_bf16 v[224:227], v[26:29], v[42:45], v[224:227]
  s_add_u32 s72, s75, s78
  s_add_u32 s72, s72, 3539072
  s_add_u32 s72, s72, s82
  s_add_u32 m0, s73, 12288
  s_nop 0
  buffer_load_dwordx4 v74, s[24:27], s72 offen lds
  ds_read_b128 v[58:61], v83 offset:5120
  ds_read_b128 v[62:65], v83 offset:23552
  ds_read_b128 v[66:69], v83 offset:41984
  v_mfma_f32_16x16x32_bf16 v[228:231], v[26:29], v[46:49], v[228:231]
  ds_read_b128 v[70:73], v83 offset:60416
  ds_read_b64_tr_b16 v[10:11], v76 offset:0
  ds_read_b64_tr_b16 v[12:13], v76 offset:512
  v_mfma_f32_16x16x32_bf16 v[232:235], v[26:29], v[50:53], v[232:235]
  s_add_u32 s72, s72, 73728
  s_add_u32 m0, s73, 13312
  s_nop 0
  buffer_load_dwordx4 v75, s[24:27], s72 offen lds
  ds_read_b64_tr_b16 v[14:15], v77 offset:0
  ds_read_b64_tr_b16 v[16:17], v77 offset:512
  ds_read_b64_tr_b16 v[18:19], v78 offset:0
  v_mfma_f32_16x16x32_bf16 v[236:239], v[26:29], v[54:57], v[236:239]
  ds_read_b64_tr_b16 v[20:21], v78 offset:512
  ds_read_b64_tr_b16 v[22:23], v79 offset:0
  ds_read_b64_tr_b16 v[24:25], v79 offset:512
  v_mfma_f32_16x16x32_bf16 v[240:243], v[30:33], v[42:45], v[240:243]
  s_add_u32 s72, s72, 73728
  s_add_u32 m0, s73, 14336
  s_nop 0
  buffer_load_dwordx4 v74, s[24:27], s72 offen lds
  v_mfma_f32_16x16x32_bf16 v[244:247], v[30:33], v[46:49], v[244:247]
  v_mfma_f32_16x16x32_bf16 v[248:251], v[30:33], v[50:53], v[248:251]
  s_add_u32 s72, s72, 73728
  s_add_u32 m0, s73, 15360
  s_nop 0
  buffer_load_dwordx4 v75, s[24:27], s72 offen lds
  v_mfma_f32_16x16x32_bf16 v[252:255], v[30:33], v[54:57], v[252:255]
  s_cmp_eq_u32 s89, 28
  s_cbranch_scc1 GA_66
GR_67:
  s_waitcnt lgkmcnt(0)
  s_waitcnt vmcnt(8)
  v_mfma_f32_16x16x32_bf16 v[96:99], v[10:13], v[58:61], v[96:99]
  ds_read_b64_tr_b16 v[26:27], v76 offset:4096
  v_mfma_f32_16x16x32_bf16 v[100:103], v[10:13], v[62:65], v[100:103]
  ds_read_b64_tr_b16 v[28:29], v76 offset:4608
  v_mfma_f32_16x16x32_bf16 v[104:107], v[10:13], v[66:69], v[104:107]
  ds_read_b64_tr_b16 v[30:31], v77 offset:4096
  v_mfma_f32_16x16x32_bf16 v[108:111], v[10:13], v[70:73], v[108:111]
  ds_read_b64_tr_b16 v[32:33], v77 offset:4608
  v_mfma_f32_16x16x32_bf16 v[112:115], v[14:17], v[58:61], v[112:115]
  ds_read_b64_tr_b16 v[34:35], v78 offset:4096
  v_mfma_f32_16x16x32_bf16 v[116:119], v[14:17], v[62:65], v[116:119]
  ds_read_b64_tr_b16 v[36:37], v78 offset:4608
  v_mfma_f32_16x16x32_bf16 v[120:123], v[14:17], v[66:69], v[120:123]
  ds_read_b64_tr_b16 v[38:39], v79 offset:4096
  v_mfma_f32_16x16x32_bf16 v[124:127], v[14:17], v[70:73], v[124:127]
  ds_read_b64_tr_b16 v[40:41], v79 offset:4608
  v_mfma_f32_16x16x32_bf16 v[128:131], v[18:21], v[58:61], v[128:131]
  ds_read_b32 v86, v84 offset:88
  v_mfma_f32_16x16x32_bf16 v[132:135], v[18:21], v[62:65], v[132:135]
  v_mfma_f32_16x16x32_bf16 v[136:139], v[18:21], v[66:69], v[136:139]
  v_mfma_f32_16x16x32_bf16 v[140:143], v[18:21], v[70:73], v[140:143]
  v_mfma_f32_16x16x32_bf16 v[144:147], v[22:25], v[58:61], v[144:147]
  s_add_u32 s72, s75, s79
  s_add_u32 s72, s72, 3538944
  s_add_u32 s72, s72, s82
  s_add_u32 m0, s73, 0
  s_nop 0
  buffer_load_dwordx4 v87, s[24:27], s72 offen lds
  v_mfma_f32_16x16x32_bf16 v[148:151], v[22:25], v[62:65], v[148:151]
  v_mfma_f32_16x16x32_bf16 v[152:155], v[22:25], v[66:69], v[152:155]
  s_add_u32 s72, s72, 147456
  s_add_u32 m0, s73, 1024
  s_nop 0
  buffer_load_dwordx4 v87, s[24:27], s72 offen lds
  v_mfma_f32_16x16x32_bf16 v[156:159], v[22:25], v[70:73], v[156:159]
  s_cmp_eq_u32 s89, 29
  s_cbranch_scc1 GA_68
GR_69:
  s_waitcnt lgkmcnt(0)
  s_waitcnt vmcnt(6)
  v_readfirstlane_b32 s6, v86
  v_mfma_f32_16x16x32_bf16 v[160:163], v[26:29], v[58:61], v[160:163]
  s_nop 1
  s_cmp_ge_u32 s6, 4
  s_cbranch_scc1 XOK_70
  s_mov_b32 s95, 400000
W_71:
  ds_read_b32 v3, v84 offset:88
  s_waitcnt lgkmcnt(0)
  v_readfirstlane_b32 s6, v3
  s_nop 3
  s_cmp_ge_u32 s6, 4
  s_cbranch_scc1 WD_72
  s_sleep 1
  s_sub_u32 s95, s95, 1
  s_cmp_lg_u32 s95, 0
  s_cbranch_scc1 W_71
WD_72:
XOK_70:
  ds_read_b128 v[42:45], v82 offset:6144
  v_mfma_f32_16x16x32_bf16 v[164:167], v[26:29], v[62:65], v[164:167]
  ds_read_b128 v[46:49], v82 offset:24576
  v_mfma_f32_16x16x32_bf16 v[168:171], v[26:29], v[66:69], v[168:171]
  ds_read_b128 v[50:53], v82 offset:43008
  v_mfma_f32_16x16x32_bf16 v[172:175], v[26:29], v[70:73], v[172:175]
  ds_read_b128 v[54:57], v82 offset:61440
  v_mfma_f32_16x16x32_bf16 v[176:179], v[30:33], v[58:61], v[176:179]
  ds_read_b64_tr_b16 v[10:11], v76 offset:8192
  v_mfma_f32_16x16x32_bf16 v[180:183], v[30:33], v[62:65], v[180:183]
  ds_read_b64_tr_b16 v[12:13], v76 offset:8704
  v_mfma_f32_16x16x32_bf16 v[184:187], v[30:33], v[66:69], v[184:187]
  ds_read_b64_tr_b16 v[14:15], v77 offset:8192
  v_mfma_f32_16x16x32_bf16 v[188:191], v[30:33], v[70:73], v[188:191]
  ds_read_b64_tr_b16 v[16:17], v77 offset:8704
  v_mfma_f32_16x16x32_bf16 v[192:195], v[34:37], v[58:61], v[192:195]
  s_add_u32 s72, s75, s78
  s_add_u32 s72, s72, 3833856
  s_sub_u32 s72, s72, s82
  s_add_u32 m0, s73, 4096
  s_nop 0
  buffer_load_dwordx4 v74, s[24:27], s72 offen lds
  ds_read_b64_tr_b16 v[18:19], v78 offset:8192
  v_mfma_f32_16x16x32_bf16 v[196:199], v[34:37], v[62:65], v[196:199]
  ds_read_b64_tr_b16 v[20:21], v78 offset:8704
  v_mfma_f32_16x16x32_bf16 v[200:203], v[34:37], v[66:69], v[200:203]
  s_add_u32 s72, s72, 73728
  s_add_u32 m0, s73, 5120
  s_nop 0
  buffer_load_dwordx4 v75, s[24:27], s72 offen lds
  ds_read_b64_tr_b16 v[22:23], v79 offset:8192
  v_mfma_f32_16x16x32_bf16 v[204:207], v[34:37], v[70:73], v[204:207]
  ds_read_b64_tr_b16 v[24:25], v79 offset:8704
  v_mfma_f32_16x16x32_bf16 v[208:211], v[38:41], v[58:61], v[208:211]
  s_add_u32 s72, s72, 73728
  s_add_u32 m0, s73, 6144
  s_nop 0
  buffer_load_dwordx4 v74, s[24:27], s72 offen lds
  v_mfma_f32_16x16x32_bf16 v[212:215], v[38:41], v[62:65], v[212:215]
  v_mfma_f32_16x16x32_bf16 v[216:219], v[38:41], v[66:69], v[216:219]
  s_add_u32 s72, s72, 73728
  s_add_u32 m0, s73, 7168
  s_nop 0
  buffer_load_dwordx4 v75, s[24:27], s72 offen lds
  v_mfma_f32_16x16x32_bf16 v[220:223], v[38:41], v[70:73], v[220:223]
  s_cmp_eq_u32 s89, 30
  s_cbranch_scc1 GA_73
GR_74:
  s_waitcnt lgkmcnt(0)
  s_waitcnt vmcnt(6)
  v_mfma_f32_16x16x32_bf16 v[96:99], v[10:13], v[42:45], v[96:99]
  ds_read_b64_tr_b16 v[26:27], v76 offset:12288
  v_mfma_f32_16x16x32_bf16 v[100:103], v[10:13], v[46:49], v[100:103]
  ds_read_b64_tr_b16 v[28:29], v76 offset:12800
  v_mfma_f32_16x16x32_bf16 v[104:107], v[10:13], v[50:53], v[104:107]
  ds_read_b64_tr_b16 v[30:31], v77 offset:12288
  v_mfma_f32_16x16x32_bf16 v[108:111], v[10:13], v[54:57], v[108:111]
  ds_read_b64_tr_b16 v[32:33], v77 offset:12800
  v_mfma_f32_16x16x32_bf16 v[112:115], v[14:17], v[42:45], v[112:115]
  ds_read_b64_tr_b16 v[34:35], v78 offset:12288
  v_mfma_f32_16x16x32_bf16 v[116:119], v[14:17], v[46:49], v[116:119]
  ds_read_b64_tr_b16 v[36:37], v78 offset:12800
  v_mfma_f32_16x16x32_bf16 v[120:123], v[14:17], v[50:53], v[120:123]
  ds_read_b64_tr_b16 v[38:39], v79 offset:12288
  v_mfma_f32_16x16x32_bf16 v[124:127], v[14:17], v[54:57], v[124:127]
  ds_read_b64_tr_b16 v[40:41], v79 offset:12800
  v_mfma_f32_16x16x32_bf16 v[128:131], v[18:21], v[42:45], v[128:131]
  s_add_u32 s72, s75, s78
  s_add_u32 s72, s72, 3833984
  s_sub_u32 s72, s72, s82
  s_add_u32 m0, s73, 8192
  s_nop 0
  buffer_load_dwordx4 v74, s[24:27], s72 offen lds
  v_mfma_f32_16x16x32_bf16 v[132:135], v[18:21], v[46:49], v[132:135]
  v_mfma_f32_16x16x32_bf16 v[136:139], v[18:21], v[50:53], v[136:139]
  s_add_u32 s72, s72, 73728
  s_add_u32 m0, s73, 9216
  s_nop 0
  buffer_load_dwordx4 v75, s[24:27], s72 offen lds
  v_mfma_f32_16x16x32_bf16 v[140:143], v[18:21], v[54:57], v[140:143]
  v_mfma_f32_16x16x32_bf16 v[144:147], v[22:25], v[42:45], v[144:147]
  s_add_u32 s72, s72, 73728
  s_add_u32 m0, s73, 10240
  s_nop 0
  buffer_load_dwordx4 v74, s[24:27], s72 offen lds
  v_mfma_f32_16x16x32_bf16 v[148:151], v[22:25], v[46:49], v[148:151]
  v_mfma_f32_16x16x32_bf16 v[152:155], v[22:25], v[50:53], v[152:155]
  s_add_u32 s72, s72, 73728
  s_add_u32 m0, s73, 11264
  s_nop 0
  buffer_load_dwordx4 v75, s[24:27], s72 offen lds
  v_mfma_f32_16x16x32_bf16 v[156:159], v[22:25], v[54:57], v[156:159]
  s_cmp_eq_u32 s89, 31
  s_cbranch_scc1 GA_75
GR_76:
  s_waitcnt lgkmcnt(0)
  s_waitcnt vmcnt(8)
  v_mfma_f32_16x16x32_bf16 v[160:163], v[26:29], v[42:45], v[160:163]
  ds_read_b64_tr_b16 v[10:11], v80 offset:0
  v_mfma_f32_16x16x32_bf16 v[164:167], v[26:29], v[46:49], v[164:167]
  ds_read_b64_tr_b16 v[12:13], v80 offset:256
  v_mfma_f32_16x16x32_bf16 v[168:171], v[26:29], v[50:53], v[168:171]
  ds_read_b64_tr_b16 v[14:15], v81 offset:0
  v_mfma_f32_16x16x32_bf16 v[172:175], v[26:29], v[54:57], v[172:175]
  ds_read_b64_tr_b16 v[16:17], v81 offset:256
  v_mfma_f32_16x16x32_bf16 v[176:179], v[30:33], v[42:45], v[176:179]
  v_mfma_f32_16x16x32_bf16 v[180:183], v[30:33], v[46:49], v[180:183]
  v_mfma_f32_16x16x32_bf16 v[184:187], v[30:33], v[50:53], v[184:187]
  v_mfma_f32_16x16x32_bf16 v[188:191], v[30:33], v[54:57], v[188:191]
  v_mfma_f32_16x16x32_bf16 v[192:195], v[34:37], v[42:45], v[192:195]
  s_add_u32 s72, s75, s78
  s_add_u32 s72, s72, 4128768
  s_add_u32 s72, s72, s82
  s_add_u32 m0, s73, 12288
  s_nop 0
  buffer_load_dwordx4 v74, s[24:27], s72 offen lds
  v_mfma_f32_16x16x32_bf16 v[196:199], v[34:37], v[46:49], v[196:199]
  v_mfma_f32_16x16x32_bf16 v[200:203], v[34:37], v[50:53], v[200:203]
  s_add_u32 s72, s72, 73728
  s_add_u32 m0, s73, 13312
  s_nop 0
  buffer_load_dwordx4 v75, s[24:27], s72 offen lds
  v_mfma_f32_16x16x32_bf16 v[204:207], v[34:37], v[54:57], v[204:207]
  v_mfma_f32_16x16x32_bf16 v[208:211], v[38:41], v[42:45], v[208:211]
  s_add_u32 s72, s72, 73728
  s_add_u32 m0, s73, 14336
  s_nop 0
  buffer_load_dwordx4 v74, s[24:27], s72 offen lds
  v_mfma_f32_16x16x32_bf16 v[212:215], v[38:41], v[46:49], v[212:215]
  v_mfma_f32_16x16x32_bf16 v[216:219], v[38:41], v[50:53], v[216:219]
  s_add_u32 s72, s72, 73728
  s_add_u32 m0, s73, 15360
  s_nop 0
  buffer_load_dwordx4 v75, s[24:27], s72 offen lds
  v_mfma_f32_16x16x32_bf16 v[220:223], v[38:41], v[54:57], v[220:223]
  s_waitcnt lgkmcnt(0)
  s_waitcnt vmcnt(8)
  v_mfma_f32_16x16x32_bf16 v[224:227], v[10:13], v[42:45], v[224:227]
  s_add_u32 s72, s75, s78
  s_add_u32 s72, s72, 4128896
  s_add_u32 s72, s72, s82
  s_add_u32 m0, s73, 0
  s_nop 0
  buffer_load_dwordx4 v74, s[24:27], s72 offen lds
  ds_read_b128 v[58:61], v83 offset:6144
  ds_read_b128 v[62:65], v83 offset:24576
  ds_read_b128 v[66:69], v83 offset:43008
  v_mfma_f32_16x16x32_bf16 v[228:231], v[10:13], v[46:49], v[228:231]
  ds_read_b128 v[70:73], v83 offset:61440
  ds_read_b64_tr_b16 v[26:27], v76 offset:4096
  ds_read_b64_tr_b16 v[28:29], v76 offset:4608
  v_mfma_f32_16x16x32_bf16 v[232:235], v[10:13], v[50:53], v[232:235]
  s_add_u32 s72, s72, 73728
  s_add_u32 m0, s73, 1024
  s_nop 0
  buffer_load_dwordx4 v75, s[24:27], s72 offen lds
  ds_read_b64_tr_b16 v[30:31], v77 offset:4096
  ds_read_b64_tr_b16 v[32:33], v77 offset:4608
  ds_read_b64_tr_b16 v[34:35], v78 offset:4096
  v_mfma_f32_16x16x32_bf16 v[236:239], v[10:13], v[54:57], v[236:239]
  ds_read_b64_tr_b16 v[36:37], v78 offset:4608
  ds_read_b64_tr_b16 v[38:39], v79 offset:4096
  ds_read_b64_tr_b16 v[40:41], v79 offset:4608
  v_mfma_f32_16x16x32_bf16 v[240:243], v[14:17], v[42:45], v[240:243]
  s_add_u32 s72, s72, 73728
  s_add_u32 m0, s73, 2048
  s_nop 0
  buffer_load_dwordx4 v74, s[24:27], s72 offen lds
  v_mfma_f32_16x16x32_bf16 v[244:247], v[14:17], v[46:49], v[244:247]
  v_mfma_f32_16x16x32_bf16 v[248:251], v[14:17], v[50:53], v[248:251]
  s_add_u32 s72, s72, 73728
  s_add_u32 m0, s73, 3072
  s_nop 0
  buffer_load_dwordx4 v75, s[24:27], s72 offen lds
  v_mfma_f32_16x16x32_bf16 v[252:255], v[14:17], v[54:57], v[252:255]
  s_waitcnt lgkmcnt(0)
  s_waitcnt vmcnt(8)
  v_mfma_f32_16x16x32_bf16 v[96:99], v[26:29], v[58:61], v[96:99]
  ds_read_b64_tr_b16 v[10:11], v76 offset:8192
  v_mfma_f32_16x16x32_bf16 v[100:103], v[26:29], v[62:65], v[100:103]
  ds_read_b64_tr_b16 v[12:13], v76 offset:8704
  v_mfma_f32_16x16x32_bf16 v[104:107], v[26:29], v[66:69], v[104:107]
  ds_read_b64_tr_b16 v[14:15], v77 offset:8192
  v_mfma_f32_16x16x32_bf16 v[108:111], v[26:29], v[70:73], v[108:111]
  ds_read_b64_tr_b16 v[16:17], v77 offset:8704
  v_mfma_f32_16x16x32_bf16 v[112:115], v[30:33], v[58:61], v[112:115]
  ds_read_b64_tr_b16 v[18:19], v78 offset:8192
  v_mfma_f32_16x16x32_bf16 v[116:119], v[30:33], v[62:65], v[116:119]
  ds_read_b64_tr_b16 v[20:21], v78 offset:8704
  v_mfma_f32_16x16x32_bf16 v[120:123], v[30:33], v[66:69], v[120:123]
  ds_read_b64_tr_b16 v[22:23], v79 offset:8192
  v_mfma_f32_16x16x32_bf16 v[124:127], v[30:33], v[70:73], v[124:127]
  ds_read_b64_tr_b16 v[24:25], v79 offset:8704
  v_mfma_f32_16x16x32_bf16 v[128:131], v[34:37], v[58:61], v[128:131]
  ds_read_b32 v86, v84 offset:92
  v_mfma_f32_16x16x32_bf16 v[132:135], v[34:37], v[62:65], v[132:135]
  v_mfma_f32_16x16x32_bf16 v[136:139], v[34:37], v[66:69], v[136:139]
  v_mfma_f32_16x16x32_bf16 v[140:143], v[34:37], v[70:73], v[140:143]
  v_mfma_f32_16x16x32_bf16 v[144:147], v[38:41], v[58:61], v[144:147]
  s_add_u32 s72, s75, s79
  s_add_u32 s72, s72, 4128768
  s_add_u32 s72, s72, s82
  s_add_u32 m0, s73, 4096
  s_nop 0
  buffer_load_dwordx4 v87, s[24:27], s72 offen lds
  v_mfma_f32_16x16x32_bf16 v[148:151], v[38:41], v[62:65], v[148:151]
  v_mfma_f32_16x16x32_bf16 v[152:155], v[38:41], v[66:69], v[152:155]
  s_add_u32 s72, s72, 147456
  s_add_u32 m0, s73, 5120
  s_nop 0
  buffer_load_dwordx4 v87, s[24:27], s72 offen lds
  v_mfma_f32_16x16x32_bf16 v[156:159], v[38:41], v[70:73], v[156:159]
  s_waitcnt lgkmcnt(0)
  s_waitcnt vmcnt(6)
  v_readfirstlane_b32 s6, v86
  v_mfma_f32_16x16x32_bf16 v[160:163], v[10:13], v[58:61], v[160:163]
  s_nop 1
  s_cmp_ge_u32 s6, 4
  s_cbranch_scc1 XOK_77
  s_mov_b32 s95, 400000
W_78:
  ds_read_b32 v3, v84 offset:92
  s_waitcnt lgkmcnt(0)
  v_readfirstlane_b32 s6, v3
  s_nop 3
  s_cmp_ge_u32 s6, 4
  s_cbranch_scc1 WD_79
  s_sleep 1
  s_sub_u32 s95, s95, 1
  s_cmp_lg_u32 s95, 0
  s_cbranch_scc1 W_78
WD_79:
XOK_77:
  ds_read_b128 v[42:45], v82 offset:7168
  v_mfma_f32_16x16x32_bf16 v[164:167], v[10:13], v[62:65], v[164:167]
  ds_read_b128 v[46:49], v82 offset:25600
  v_mfma_f32_16x16x32_bf16 v[168:171], v[10:13], v[66:69], v[168:171]
  ds_read_b128 v[50:53], v82 offset:44032
  v_mfma_f32_16x16x32_bf16 v[172:175], v[10:13], v[70:73], v[172:175]
  ds_read_b128 v[54:57], v82 offset:62464
  v_mfma_f32_16x16x32_bf16 v[176:179], v[14:17], v[58:61], v[176:179]
  ds_read_b64_tr_b16 v[26:27], v76 offset:12288
  v_mfma_f32_16x16x32_bf16 v[180:183], v[14:17], v[62:65], v[180:183]
  ds_read_b64_tr_b16 v[28:29], v76 offset:12800
  v_mfma_f32_16x16x32_bf16 v[184:187], v[14:17], v[66:69], v[184:187]
  ds_read_b64_tr_b16 v[30:31], v77 offset:12288
  v_mfma_f32_16x16x32_bf16 v[188:191], v[14:17], v[70:73], v[188:191]
  ds_read_b64_tr_b16 v[32:33], v77 offset:12800
  v_mfma_f32_16x16x32_bf16 v[192:195], v[18:21], v[58:61], v[192:195]
  s_add_u32 s72, s75, s78
  s_add_u32 s72, s72, 4423680
  s_sub_u32 s72, s72, s82
  s_add_u32 m0, s73, 8192
  s_nop 0
  buffer_load_dwordx4 v74, s[24:27], s72 offen lds
  ds_read_b64_tr_b16 v[34:35], v78 offset:12288
  v_mfma_f32_16x16x32_bf16 v[196:199], v[18:21], v[62:65], v[196:199]
  ds_read_b64_tr_b16 v[36:37], v78 offset:12800
  v_mfma_f32_16x16x32_bf16 v[200:203], v[18:21], v[66:69], v[200:203]
  s_add_u32 s72, s72, 73728
  s_add_u32 m0, s73, 9216
  s_nop 0
  buffer_load_dwordx4 v75, s[24:27], s72 offen lds
  ds_read_b64_tr_b16 v[38:39], v79 offset:12288
  v_mfma_f32_16x16x32_bf16 v[204:207], v[18:21], v[70:73], v[204:207]
  ds_read_b64_tr_b16 v[40:41], v79 offset:12800
  v_mfma_f32_16x16x32_bf16 v[208:211], v[22:25], v[58:61], v[208:211]
  s_add_u32 s72, s72, 73728
  s_add_u32 m0, s73, 10240
  s_nop 0
  buffer_load_dwordx4 v74, s[24:27], s72 offen lds
  v_mfma_f32_16x16x32_bf16 v[212:215], v[22:25], v[62:65], v[212:215]
  v_mfma_f32_16x16x32_bf16 v[216:219], v[22:25], v[66:69], v[216:219]
  s_add_u32 s72, s72, 73728
  s_add_u32 m0, s73, 11264
  s_nop 0
  buffer_load_dwordx4 v75, s[24:27], s72 offen lds
  v_mfma_f32_16x16x32_bf16 v[220:223], v[22:25], v[70:73], v[220:223]
  s_waitcnt lgkmcnt(0)
  s_waitcnt vmcnt(6)
  v_mfma_f32_16x16x32_bf16 v[96:99], v[26:29], v[42:45], v[96:99]
  ds_read_b64_tr_b16 v[10:11], v76 offset:0
  v_mfma_f32_16x16x32_bf16 v[100:103], v[26:29], v[46:49], v[100:103]
  ds_read_b64_tr_b16 v[12:13], v76 offset:512
  v_mfma_f32_16x16x32_bf16 v[104:107], v[26:29], v[50:53], v[104:107]
  ds_read_b64_tr_b16 v[14:15], v77 offset:0
  v_mfma_f32_16x16x32_bf16 v[108:111], v[26:29], v[54:57], v[108:111]
  ds_read_b64_tr_b16 v[16:17], v77 offset:512
  v_mfma_f32_16x16x32_bf16 v[112:115], v[30:33], v[42:45], v[112:115]
  ds_read_b64_tr_b16 v[18:19], v78 offset:0
  v_mfma_f32_16x16x32_bf16 v[116:119], v[30:33], v[46:49], v[116:119]
  ds_read_b64_tr_b16 v[20:21], v78 offset:512
  v_mfma_f32_16x16x32_bf16 v[120:123], v[30:33], v[50:53], v[120:123]
  ds_read_b64_tr_b16 v[22:23], v79 offset:0
  v_mfma_f32_16x16x32_bf16 v[124:127], v[30:33], v[54:57], v[124:127]
  ds_read_b64_tr_b16 v[24:25], v79 offset:512
  v_mfma_f32_16x16x32_bf16 v[128:131], v[34:37], v[42:45], v[128:131]
  s_add_u32 s72, s75, s78
  s_add_u32 s72, s72, 4423808
  s_sub_u32 s72, s72, s82
  s_add_u32 m0, s73, 12288
  s_nop 0
  buffer_load_dwordx4 v74, s[24:27], s72 offen lds
  v_mfma_f32_16x16x32_bf16 v[132:135], v[34:37], v[46:49], v[132:135]
  v_mfma_f32_16x16x32_bf16 v[136:139], v[34:37], v[50:53], v[136:139]
  s_add_u32 s72, s72, 73728
  s_add_u32 m0, s73, 13312
  s_nop 0
  buffer_load_dwordx4 v75, s[24:27], s72 offen lds
  v_mfma_f32_16x16x32_bf16 v[140:143], v[34:37], v[54:57], v[140:143]
  v_mfma_f32_16x16x32_bf16 v[144:147], v[38:41], v[42:45], v[144:147]
  s_add_u32 s72, s72, 73728
  s_add_u32 m0, s73, 14336
  s_nop 0
  buffer_load_dwordx4 v74, s[24:27], s72 offen lds
  v_mfma_f32_16x16x32_bf16 v[148:151], v[38:41], v[46:49], v[148:151]
  v_mfma_f32_16x16x32_bf16 v[152:155], v[38:41], v[50:53], v[152:155]
  s_add_u32 s72, s72, 73728
  s_add_u32 m0, s73, 15360
  s_nop 0
  buffer_load_dwordx4 v75, s[24:27], s72 offen lds
  v_mfma_f32_16x16x32_bf16 v[156:159], v[38:41], v[54:57], v[156:159]
  s_waitcnt lgkmcnt(0)
  s_waitcnt vmcnt(8)
  v_mfma_f32_16x16x32_bf16 v[160:163], v[10:13], v[42:45], v[160:163]
  ds_read_b64_tr_b16 v[26:27], v80 offset:4096
  v_mfma_f32_16x16x32_bf16 v[164:167], v[10:13], v[46:49], v[164:167]
  ds_read_b64_tr_b16 v[28:29], v80 offset:4352
  v_mfma_f32_16x16x32_bf16 v[168:171], v[10:13], v[50:53], v[168:171]
  ds_read_b64_tr_b16 v[30:31], v81 offset:4096
  v_mfma_f32_16x16x32_bf16 v[172:175], v[10:13], v[54:57], v[172:175]
  ds_read_b64_tr_b16 v[32:33], v81 offset:4352
  v_mfma_f32_16x16x32_bf16 v[176:179], v[14:17], v[42:45], v[176:179]
  v_mfma_f32_16x16x32_bf16 v[180:183], v[14:17], v[46:49], v[180:183]
  v_mfma_f32_16x16x32_bf16 v[184:187], v[14:17], v[50:53], v[184:187]
  v_mfma_f32_16x16x32_bf16 v[188:191], v[14:17], v[54:57], v[188:191]
  v_mfma_f32_16x16x32_bf16 v[192:195], v[18:21], v[42:45], v[192:195]
  s_add_u32 s72, s75, s78
  s_add_u32 s72, s72, 4718592
  s_add_u32 s72, s72, s82
  s_add_u32 m0, s73, 0
  s_nop 0
  buffer_load_dwordx4 v74, s[24:27], s72 offen lds
  v_mfma_f32_16x16x32_bf16 v[196:199], v[18:21], v[46:49], v[196:199]
  v_mfma_f32_16x16x32_bf16 v[200:203], v[18:21], v[50:53], v[200:203]
  s_add_u32 s72, s72, 73728
  s_add_u32 m0, s73, 1024
  s_nop 0
  buffer_load_dwordx4 v75, s[24:27], s72 offen lds
  v_mfma_f32_16x16x32_bf16 v[204:207], v[18:21], v[54:57], v[204:207]
  v_mfma_f32_16x16x32_bf16 v[208:211], v[22:25], v[42:45], v[208:211]
  s_add_u32 s72, s72, 73728
  s_add_u32 m0, s73, 2048
  s_nop 0
  buffer_load_dwordx4 v74, s[24:27], s72 offen lds
  v_mfma_f32_16x16x32_bf16 v[212:215], v[22:25], v[46:49], v[212:215]
  v_mfma_f32_16x16x32_bf16 v[216:219], v[22:25], v[50:53], v[216:219]
  s_add_u32 s72, s72, 73728
  s_add_u32 m0, s73, 3072
  s_nop 0
  buffer_load_dwordx4 v75, s[24:27], s72 offen lds
  v_mfma_f32_16x16x32_bf16 v[220:223], v[22:25], v[54:57], v[220:223]
  s_waitcnt lgkmcnt(0)
  s_waitcnt vmcnt(8)
  v_mfma_f32_16x16x32_bf16 v[224:227], v[26:29], v[42:45], v[224:227]
  s_add_u32 s72, s75, s78
  s_add_u32 s72, s72, 4718720
  s_add_u32 s72, s72, s82
  s_add_u32 m0, s73, 4096
  s_nop 0
  buffer_load_dwordx4 v74, s[24:27], s72 offen lds
  ds_read_b128 v[58:61], v83 offset:7168
  ds_read_b128 v[62:65], v83 offset:25600
  ds_read_b128 v[66:69], v83 offset:44032
  v_mfma_f32_16x16x32_bf16 v[228:231], v[26:29], v[46:49], v[228:231]
  ds_read_b128 v[70:73], v83 offset:62464
  ds_read_b64_tr_b16 v[10:11], v76 offset:8192
  ds_read_b64_tr_b16 v[12:13], v76 offset:8704
  v_mfma_f32_16x16x32_bf16 v[232:235], v[26:29], v[50:53], v[232:235]
  s_add_u32 s72, s72, 73728
  s_add_u32 m0, s73, 5120
  s_nop 0
  buffer_load_dwordx4 v75, s[24:27], s72 offen lds
  ds_read_b64_tr_b16 v[14:15], v77 offset:8192
  ds_read_b64_tr_b16 v[16:17], v77 offset:8704
  ds_read_b64_tr_b16 v[18:19], v78 offset:8192
  v_mfma_f32_16x16x32_bf16 v[236:239], v[26:29], v[54:57], v[236:239]
  ds_read_b64_tr_b16 v[20:21], v78 offset:8704
  ds_read_b64_tr_b16 v[22:23], v79 offset:8192
  ds_read_b64_tr_b16 v[24:25], v79 offset:8704
  v_mfma_f32_16x16x32_bf16 v[240:243], v[30:33], v[42:45], v[240:243]
  s_add_u32 s72, s72, 73728
  s_add_u32 m0, s73, 6144
  s_nop 0
  buffer_load_dwordx4 v74, s[24:27], s72 offen lds
  v_mfma_f32_16x16x32_bf16 v[244:247], v[30:33], v[46:49], v[244:247]
  v_mfma_f32_16x16x32_bf16 v[248:251], v[30:33], v[50:53], v[248:251]
  s_add_u32 s72, s72, 73728
  s_add_u32 m0, s73, 7168
  s_nop 0
  buffer_load_dwordx4 v75, s[24:27], s72 offen lds
  v_mfma_f32_16x16x32_bf16 v[252:255], v[30:33], v[54:57], v[252:255]
  s_waitcnt lgkmcnt(0)
  s_waitcnt vmcnt(8)
  v_mfma_f32_16x16x32_bf16 v[96:99], v[10:13], v[58:61], v[96:99]
  ds_read_b64_tr_b16 v[26:27], v76 offset:12288
  v_mfma_f32_16x16x32_bf16 v[100:103], v[10:13], v[62:65], v[100:103]
  ds_read_b64_tr_b16 v[28:29], v76 offset:12800
  v_mfma_f32_16x16x32_bf16 v[104:107], v[10:13], v[66:69], v[104:107]
  ds_read_b64_tr_b16 v[30:31], v77 offset:12288
  v_mfma_f32_16x16x32_bf16 v[108:111], v[10:13], v[70:73], v[108:111]
  ds_read_b64_tr_b16 v[32:33], v77 offset:12800
  v_mfma_f32_16x16x32_bf16 v[112:115], v[14:17], v[58:61], v[112:115]
  ds_read_b64_tr_b16 v[34:35], v78 offset:12288
  v_mfma_f32_16x16x32_bf16 v[116:119], v[14:17], v[62:65], v[116:119]
  ds_read_b64_tr_b16 v[36:37], v78 offset:12800
  v_mfma_f32_16x16x32_bf16 v[120:123], v[14:17], v[66:69], v[120:123]
  ds_read_b64_tr_b16 v[38:39], v79 offset:12288
  v_mfma_f32_16x16x32_bf16 v[124:127], v[14:17], v[70:73], v[124:127]
  ds_read_b64_tr_b16 v[40:41], v79 offset:12800
  v_mfma_f32_16x16x32_bf16 v[128:131], v[18:21], v[58:61], v[128:131]
  ds_read_b32 v86, v84 offset:96
  v_mfma_f32_16x16x32_bf16 v[132:135], v[18:21], v[62:65], v[132:135]
  v_mfma_f32_16x16x32_bf16 v[136:139], v[18:21], v[66:69], v[136:139]
  v_mfma_f32_16x16x32_bf16 v[140:143], v[18:21], v[70:73], v[140:143]
  v_mfma_f32_16x16x32_bf16 v[144:147], v[22:25], v[58:61], v[144:147]
  s_add_u32 s72, s75, s79
  s_add_u32 s72, s72, 4718592
  s_add_u32 s72, s72, s82
  s_add_u32 m0, s73, 8192
  s_nop 0
  buffer_load_dwordx4 v87, s[24:27], s72 offen lds
  v_mfma_f32_16x16x32_bf16 v[148:151], v[22:25], v[62:65], v[148:151]
  v_mfma_f32_16x16x32_bf16 v[152:155], v[22:25], v[66:69], v[152:155]
  s_add_u32 s72, s72, 147456
  s_add_u32 m0, s73, 9216
  s_nop 0
  buffer_load_dwordx4 v87, s[24:27], s72 offen lds
  v_mfma_f32_16x16x32_bf16 v[156:159], v[22:25], v[70:73], v[156:159]
  s_waitcnt lgkmcnt(0)
  s_waitcnt vmcnt(6)
  v_readfirstlane_b32 s6, v86
  v_mfma_f32_16x16x32_bf16 v[160:163], v[26:29], v[58:61], v[160:163]
  s_nop 1
  s_cmp_ge_u32 s6, 4
  s_cbranch_scc1 XOK_80
  s_mov_b32 s95, 400000
W_81:
  ds_read_b32 v3, v84 offset:96
  s_waitcnt lgkmcnt(0)
  v_readfirstlane_b32 s6, v3
  s_nop 3
  s_cmp_ge_u32 s6, 4
  s_cbranch_scc1 WD_82
  s_sleep 1
  s_sub_u32 s95, s95, 1
  s_cmp_lg_u32 s95, 0
  s_cbranch_scc1 W_81
WD_82:
XOK_80:
  ds_read_b128 v[42:45], v82 offset:8192
  v_mfma_f32_16x16x32_bf16 v[164:167], v[26:29], v[62:65], v[164:167]
  ds_read_b128 v[46:49], v82 offset:26624
  v_mfma_f32_16x16x32_bf16 v[168:171], v[26:29], v[66:69], v[168:171]
  ds_read_b128 v[50:53], v82 offset:45056
  v_mfma_f32_16x16x32_bf16 v[172:175], v[26:29], v[70:73], v[172:175]
  ds_read_b128 v[54:57], v82 offset:63488
  v_mfma_f32_16x16x32_bf16 v[176:179], v[30:33], v[58:61], v[176:179]
  ds_read_b64_tr_b16 v[10:11], v76 offset:0
  v_mfma_f32_16x16x32_bf16 v[180:183], v[30:33], v[62:65], v[180:183]
  ds_read_b64_tr_b16 v[12:13], v76 offset:512
  v_mfma_f32_16x16x32_bf16 v[184:187], v[30:33], v[66:69], v[184:187]
  ds_read_b64_tr_b16 v[14:15], v77 offset:0
  v_mfma_f32_16x16x32_bf16 v[188:191], v[30:33], v[70:73], v[188:191]
  ds_read_b64_tr_b16 v[16:17], v77 offset:512
  v_mfma_f32_16x16x32_bf16 v[192:195], v[34:37], v[58:61], v[192:195]
  s_add_u32 s72, s75, s78
  s_add_u32 s72, s72, 5013504
  s_sub_u32 s72, s72, s82
  s_add_u32 m0, s73, 12288
  s_nop 0
  buffer_load_dwordx4 v74, s[24:27], s72 offen lds
  ds_read_b64_tr_b16 v[18:19], v78 offset:0
  v_mfma_f32_16x16x32_bf16 v[196:199], v[34:37], v[62:65], v[196:199]
  ds_read_b64_tr_b16 v[20:21], v78 offset:512
  v_mfma_f32_16x16x32_bf16 v[200:203], v[34:37], v[66:69], v[200:203]
  s_add_u32 s72, s72, 73728
  s_add_u32 m0, s73, 13312
  s_nop 0
  buffer_load_dwordx4 v75, s[24:27], s72 offen lds
  ds_read_b64_tr_b16 v[22:23], v79 offset:0
  v_mfma_f32_16x16x32_bf16 v[204:207], v[34:37], v[70:73], v[204:207]
  ds_read_b64_tr_b16 v[24:25], v79 offset:512
  v_mfma_f32_16x16x32_bf16 v[208:211], v[38:41], v[58:61], v[208:211]
  s_add_u32 s72, s72, 73728
  s_add_u32 m0, s73, 14336
  s_nop 0
  buffer_load_dwordx4 v74, s[24:27], s72 offen lds
  v_mfma_f32_16x16x32_bf16 v[212:215], v[38:41], v[62:65], v[212:215]
  v_mfma_f32_16x16x32_bf16 v[216:219], v[38:41], v[66:69], v[216:219]
  s_add_u32 s72, s72, 73728
  s_add_u32 m0, s73, 15360
  s_nop 0
  buffer_load_dwordx4 v75, s[24:27], s72 offen lds
  v_mfma_f32_16x16x32_bf16 v[220:223], v[38:41], v[70:73], v[220:223]
  s_waitcnt lgkmcnt(0)
  s_waitcnt vmcnt(6)
  v_mfma_f32_16x16x32_bf16 v[96:99], v[10:13], v[42:45], v[96:99]
  ds_read_b64_tr_b16 v[26:27], v76 offset:4096
  v_mfma_f32_16x16x32_bf16 v[100:103], v[10:13], v[46:49], v[100:103]
  ds_read_b64_tr_b16 v[28:29], v76 offset:4608
  v_mfma_f32_16x16x32_bf16 v[104:107], v[10:13], v[50:53], v[104:107]
  ds_read_b64_tr_b16 v[30:31], v77 offset:4096
  v_mfma_f32_16x16x32_bf16 v[108:111], v[10:13], v[54:57], v[108:111]
  ds_read_b64_tr_b16 v[32:33], v77 offset:4608
  v_mfma_f32_16x16x32_bf16 v[112:115], v[14:17], v[42:45], v[112:115]
  ds_read_b64_tr_b16 v[34:35], v78 offset:4096
  v_mfma_f32_16x16x32_bf16 v[116:119], v[14:17], v[46:49], v[116:119]
  ds_read_b64_tr_b16 v[36:37], v78 offset:4608
  v_mfma_f32_16x16x32_bf16 v[120:123], v[14:17], v[50:53], v[120:123]
  ds_read_b64_tr_b16 v[38:39], v79 offset:4096
  v_mfma_f32_16x16x32_bf16 v[124:127], v[14:17], v[54:57], v[124:127]
  ds_read_b64_tr_b16 v[40:41], v79 offset:4608
  v_mfma_f32_16x16x32_bf16 v[128:131], v[18:21], v[42:45], v[128:131]
  s_add_u32 s72, s75, s78
  s_add_u32 s72, s72, 5013632
  s_sub_u32 s72, s72, s82
  s_add_u32 m0, s73, 0
  s_nop 0
  buffer_load_dwordx4 v74, s[24:27], s72 offen lds
  v_mfma_f32_16x16x32_bf16 v[132:135], v[18:21], v[46:49], v[132:135]
  v_mfma_f32_16x16x32_bf16 v[136:139], v[18:21], v[50:53], v[136:139]
  s_add_u32 s72, s72, 73728
  s_add_u32 m0, s73, 1024
  s_nop 0
  buffer_load_dwordx4 v75, s[24:27], s72 offen lds
  v_mfma_f32_16x16x32_bf16 v[140:143], v[18:21], v[54:57], v[140:143]
  v_mfma_f32_16x16x32_bf16 v[144:147], v[22:25], v[42:45], v[144:147]
  s_add_u32 s72, s72, 73728
  s_add_u32 m0, s73, 2048
  s_nop 0
  buffer_load_dwordx4 v74, s[24:27], s72 offen lds
  v_mfma_f32_16x16x32_bf16 v[148:151], v[22:25], v[46:49], v[148:151]
  v_mfma_f32_16x16x32_bf16 v[152:155], v[22:25], v[50:53], v[152:155]
  s_add_u32 s72, s72, 73728
  s_add_u32 m0, s73, 3072
  s_nop 0
  buffer_load_dwordx4 v75, s[24:27], s72 offen lds
  v_mfma_f32_16x16x32_bf16 v[156:159], v[22:25], v[54:57], v[156:159]
  s_waitcnt lgkmcnt(0)
  s_waitcnt vmcnt(8)
  v_lshrrev_b32 v3, 3, v0
  v_mul_u32_u24 v3, 1152, v3
  v_and_b32 v4, 7, v0
  v_lshrrev_b32 v5, 4, v0
  v_lshlrev_b32 v6, 1, v5
  v_xor_b32 v6, v6, v4
  v_lshlrev_b32 v6, 4, v6
  v_add_u32 v74, v3, v6
  v_lshrrev_b32 v3, 2, v0
  v_mul_u32_u24 v3, 1152, v3
  v_and_b32 v4, 3, v0
  v_lshrrev_b32 v5, 4, v0
  v_and_b32 v5, 1, v5
  v_lshlrev_b32 v5, 1, v5
  v_xor_b32 v4, v4, v5
  v_lshlrev_b32 v4, 4, v4
  v_add_u32 v87, v3, v4
  v_mul_u32_u24 v3, 7282, v0
  v_lshrrev_b32 v3, 16, v3
  v_mul_u32_u24 v4, 9, v3
  v_sub_u32 v4, v0, v4
  v_lshlrev_b32 v4, 7, v4
  v_mov_b32 v6, 268435456
  s_mul_i32 s6, s4, 18
  s_mul_i32 s7, s3, 5
  s_add_u32 s6, s6, s7
  v_add_u32 v5, s6, v3
  v_mul_u32_u24 v5, 1152, v5
  v_cmp_gt_u32 vcc, 45, v0
  v_add_u32 v5, v5, v4
  s_nop 0
  v_cndmask_b32 v5, v6, v5, vcc
  buffer_load_dword v9, v5, s[28:31], s76 offen
  s_cmp_eq_u32 s3, 0
  s_cbranch_scc0 PO_83
  s_cmp_lt_u32 s4, 24
  s_cbranch_scc0 PO_83
  s_mul_i32 s6, s4, 3
  v_add_u32 v5, s6, v3
  v_mul_u32_u24 v5, 1152, v5
  v_cmp_gt_u32 vcc, 27, v0
  v_add_u32 v5, v5, v4
  s_nop 0
  v_cndmask_b32 v5, v6, v5, vcc
  buffer_load_dword v9, v5, s[20:23], s77 offen
PO_83:
  v_mfma_f32_16x16x32_bf16 v[160:163], v[26:29], v[42:45], v[160:163]
  ds_read_b64_tr_b16 v[10:11], v80 offset:8192
  v_mfma_f32_16x16x32_bf16 v[164:167], v[26:29], v[46:49], v[164:167]
  ds_read_b64_tr_b16 v[12:13], v80 offset:8448
  v_mfma_f32_16x16x32_bf16 v[168:171], v[26:29], v[50:53], v[168:171]
  ds_read_b64_tr_b16 v[14:15], v81 offset:8192
  v_mfma_f32_16x16x32_bf16 v[172:175], v[26:29], v[54:57], v[172:175]
  ds_read_b64_tr_b16 v[16:17], v81 offset:8448
  v_mfma_f32_16x16x32_bf16 v[176:179], v[30:33], v[42:45], v[176:179]
  v_mfma_f32_16x16x32_bf16 v[180:183], v[30:33], v[46:49], v[180:183]
  v_mfma_f32_16x16x32_bf16 v[184:187], v[30:33], v[50:53], v[184:187]
  v_mfma_f32_16x16x32_bf16 v[188:191], v[30:33], v[54:57], v[188:191]
  v_mfma_f32_16x16x32_bf16 v[192:195], v[34:37], v[42:45], v[192:195]
  s_add_u32 s72, s76, s78
  s_add_u32 s72, s72, 0
  s_add_u32 s72, s72, s83
  s_add_u32 m0, s73, 4096
  s_nop 0
  buffer_load_dwordx4 v74, s[28:31], s72 offen lds
  v_mfma_f32_16x16x32_bf16 v[196:199], v[34:37], v[46:49], v[196:199]
  v_mfma_f32_16x16x32_bf16 v[200:203], v[34:37], v[50:53], v[200:203]
  s_add_u32 s72, s72, 9216
  s_add_u32 m0, s73, 5120
  s_nop 0
  buffer_load_dwordx4 v74, s[28:31], s72 offen lds
  v_mfma_f32_16x16x32_bf16 v[204:207], v[34:37], v[54:57], v[204:207]
  v_mfma_f32_16x16x32_bf16 v[208:211], v[38:41], v[42:45], v[208:211]
  s_add_u32 s72, s72, 9216
  s_add_u32 m0, s73, 6144
  s_nop 0
  buffer_load_dwordx4 v74, s[28:31], s72 offen lds
  v_mfma_f32_16x16x32_bf16 v[212:215], v[38:41], v[46:49], v[212:215]
  v_mfma_f32_16x16x32_bf16 v[216:219], v[38:41], v[50:53], v[216:219]
  s_add_u32 s72, s72, 9216
  s_add_u32 m0, s73, 7168
  s_nop 0
  buffer_load_dwordx4 v74, s[28:31], s72 offen lds
  v_mfma_f32_16x16x32_bf16 v[220:223], v[38:41], v[54:57], v[220:223]
  s_waitcnt lgkmcnt(0)
  s_waitcnt vmcnt(9)
  v_mfma_f32_16x16x32_bf16 v[224:227], v[10:13], v[42:45], v[224:227]
  s_add_u32 s72, s76, s78
  s_add_u32 s72, s72, 128
  s_add_u32 s72, s72, s83
  s_add_u32 m0, s73, 8192
  s_nop 0
  buffer_load_dwordx4 v74, s[28:31], s72 offen lds
  ds_read_b128 v[58:61], v83 offset:8192
  ds_read_b128 v[62:65], v83 offset:26624
  ds_read_b128 v[66:69], v83 offset:45056
  v_mfma_f32_16x16x32_bf16 v[228:231], v[10:13], v[46:49], v[228:231]
  ds_read_b128 v[70:73], v83 offset:63488
  ds_read_b64_tr_b16 v[26:27], v76 offset:12288
  ds_read_b64_tr_b16 v[28:29], v76 offset:12800
  v_mfma_f32_16x16x32_bf16 v[232:235], v[10:13], v[50:53], v[232:235]
  s_add_u32 s72, s72, 9216
  s_add_u32 m0, s73, 9216
  s_nop 0
  buffer_load_dwordx4 v74, s[28:31], s72 offen lds
  ds_read_b64_tr_b16 v[30:31], v77 offset:12288
  ds_read_b64_tr_b16 v[32:33], v77 offset:12800
  ds_read_b64_tr_b16 v[34:35], v78 offset:12288
  v_mfma_f32_16x16x32_bf16 v[236:239], v[10:13], v[54:57], v[236:239]
  ds_read_b64_tr_b16 v[36:37], v78 offset:12800
  ds_read_b64_tr_b16 v[38:39], v79 offset:12288
  ds_read_b64_tr_b16 v[40:41], v79 offset:12800
  v_mfma_f32_16x16x32_bf16 v[240:243], v[14:17], v[42:45], v[240:243]
  s_add_u32 s72, s72, 9216
  s_add_u32 m0, s73, 10240
  s_nop 0
  buffer_load_dwordx4 v74, s[28:31], s72 offen lds
  v_mfma_f32_16x16x32_bf16 v[244:247], v[14:17], v[46:49], v[244:247]
  v_mfma_f32_16x16x32_bf16 v[248:251], v[14:17], v[50:53], v[248:251]
  s_add_u32 s72, s72, 9216
  s_add_u32 m0, s73, 11264
  s_nop 0
  buffer_load_dwordx4 v74, s[28:31], s72 offen lds
  v_mfma_f32_16x16x32_bf16 v[252:255], v[14:17], v[54:57], v[252:255]
  s_waitcnt lgkmcnt(0)
  s_waitcnt vmcnt(9)
  s_waitcnt lgkmcnt(0)
  s_mov_b64 s[92:93], exec
  s_mov_b64 exec, 1
  ds_add_u32 v84, v85 offset:8
  s_mov_b64 exec, s[92:93]
  v_mfma_f32_16x16x32_bf16 v[96:99], v[26:29], v[58:61], v[96:99]
  ds_read_b64_tr_b16 v[10:11], v76 offset:0
  v_mfma_f32_16x16x32_bf16 v[100:103], v[26:29], v[62:65], v[100:103]
  ds_read_b64_tr_b16 v[12:13], v76 offset:512
  v_mfma_f32_16x16x32_bf16 v[104:107], v[26:29], v[66:69], v[104:107]
  ds_read_b64_tr_b16 v[14:15], v77 offset:0
  v_mfma_f32_16x16x32_bf16 v[108:111], v[26:29], v[70:73], v[108:111]
  ds_read_b64_tr_b16 v[16:17], v77 offset:512
  v_mfma_f32_16x16x32_bf16 v[112:115], v[30:33], v[58:61], v[112:115]
  ds_read_b64_tr_b16 v[18:19], v78 offset:0
  v_mfma_f32_16x16x32_bf16 v[116:119], v[30:33], v[62:65], v[116:119]
  ds_read_b64_tr_b16 v[20:21], v78 offset:512
  v_mfma_f32_16x16x32_bf16 v[120:123], v[30:33], v[66:69], v[120:123]
  ds_read_b64_tr_b16 v[22:23], v79 offset:0
  v_mfma_f32_16x16x32_bf16 v[124:127], v[30:33], v[70:73], v[124:127]
  ds_read_b64_tr_b16 v[24:25], v79 offset:512
  v_mfma_f32_16x16x32_bf16 v[128:131], v[34:37], v[58:61], v[128:131]
  v_mfma_f32_16x16x32_bf16 v[132:135], v[34:37], v[62:65], v[132:135]
  v_mfma_f32_16x16x32_bf16 v[136:139], v[34:37], v[66:69], v[136:139]
  v_mfma_f32_16x16x32_bf16 v[140:143], v[34:37], v[70:73], v[140:143]
  v_mfma_f32_16x16x32_bf16 v[144:147], v[38:41], v[58:61], v[144:147]
  s_add_u32 s72, s76, s79
  s_add_u32 s72, s72, 0
  s_add_u32 s72, s72, s83
  s_add_u32 m0, s73, 12288
  s_nop 0
  buffer_load_dwordx4 v87, s[28:31], s72 offen lds
  v_mfma_f32_16x16x32_bf16 v[148:151], v[38:41], v[62:65], v[148:151]
  v_mfma_f32_16x16x32_bf16 v[152:155], v[38:41], v[66:69], v[152:155]
  s_add_u32 s72, s72, 18432
  s_add_u32 m0, s73, 13312
  s_nop 0
  buffer_load_dwordx4 v87, s[28:31], s72 offen lds
  v_mfma_f32_16x16x32_bf16 v[156:159], v[38:41], v[70:73], v[156:159]
  s_waitcnt lgkmcnt(0)
  v_mfma_f32_16x16x32_bf16 v[160:163], v[10:13], v[58:61], v[160:163]
  v_mfma_f32_16x16x32_bf16 v[164:167], v[10:13], v[62:65], v[164:167]
  v_mfma_f32_16x16x32_bf16 v[168:171], v[10:13], v[66:69], v[168:171]
  v_mfma_f32_16x16x32_bf16 v[172:175], v[10:13], v[70:73], v[172:175]
  v_mfma_f32_16x16x32_bf16 v[176:179], v[14:17], v[58:61], v[176:179]
  v_mfma_f32_16x16x32_bf16 v[180:183], v[14:17], v[62:65], v[180:183]
  v_mfma_f32_16x16x32_bf16 v[184:187], v[14:17], v[66:69], v[184:187]
  v_mfma_f32_16x16x32_bf16 v[188:191], v[14:17], v[70:73], v[188:191]
  v_mfma_f32_16x16x32_bf16 v[192:195], v[18:21], v[58:61], v[192:195]
  s_add_u32 s72, s76, s78
  s_add_u32 s72, s72, 36864
  s_sub_u32 s72, s72, s83
  s_add_u32 m0, s73, 0
  s_nop 0
  buffer_load_dwordx4 v74, s[28:31], s72 offen lds
  v_mfma_f32_16x16x32_bf16 v[196:199], v[18:21], v[62:65], v[196:199]
  v_mfma_f32_16x16x32_bf16 v[200:203], v[18:21], v[66:69], v[200:203]
  s_add_u32 s72, s72, 9216
  s_add_u32 m0, s73, 1024
  s_nop 0
  buffer_load_dwordx4 v74, s[28:31], s72 offen lds
  v_mfma_f32_16x16x32_bf16 v[204:207], v[18:21], v[70:73], v[204:207]
  v_mfma_f32_16x16x32_bf16 v[208:211], v[22:25], v[58:61], v[208:211]
  s_add_u32 s72, s72, 9216
  s_add_u32 m0, s73, 2048
  s_nop 0
  buffer_load_dwordx4 v74, s[28:31], s72 offen lds
  v_mfma_f32_16x16x32_bf16 v[212:215], v[22:25], v[62:65], v[212:215]
  v_mfma_f32_16x16x32_bf16 v[216:219], v[22:25], v[66:69], v[216:219]
  s_add_u32 s72, s72, 9216
  s_add_u32 m0, s73, 3072
  s_nop 0
  buffer_load_dwordx4 v74, s[28:31], s72 offen lds
  v_mfma_f32_16x16x32_bf16 v[220:223], v[22:25], v[70:73], v[220:223]
  s_setprio 3
  s_mov_b32 s95, 400000
W_84:
  ds_read_b32 v3, v84 offset:44
  s_waitcnt lgkmcnt(0)
  v_readfirstlane_b32 s6, v3
  s_nop 3
  s_cmp_ge_u32 s6, 4
  s_cbranch_scc1 WD_85
  s_sleep 1
  s_sub_u32 s95, s95, 1
  s_cmp_lg_u32 s95, 0
  s_cbranch_scc1 W_84
WD_85:
  s_lshl_b32 s85, s3, 12
  s_add_u32 s85, s85, 139264
  s_xor_b32 s86, s3, 1
  s_lshl_b32 s86, s86, 12
  s_add_u32 s86, s86, 139264
  s_nop 7
  s_cmp_eq_u32 s80, 0
  s_cbranch_scc1 PS_86
  v_swap_b32 v224, v232
  v_swap_b32 v225, v233
  v_swap_b32 v226, v234
  v_swap_b32 v227, v235
  v_swap_b32 v228, v236
  v_swap_b32 v229, v237
  v_swap_b32 v230, v238
  v_swap_b32 v231, v239
  v_swap_b32 v240, v248
  v_swap_b32 v241, v249
  v_swap_b32 v242, v250
  v_swap_b32 v243, v251
  v_swap_b32 v244, v252
  v_swap_b32 v245, v253
  v_swap_b32 v246, v254
  v_swap_b32 v247, v255
PS_86:
  v_lshlrev_b32 v3, 4, v0
  v_add_u32 v4, s85, v3
  v_add_u32 v86, s86, v3
  ds_write_b128 v4, v[232:235] offset:0
  ds_write_b128 v4, v[236:239] offset:1024
  ds_write_b128 v4, v[248:251] offset:2048
  ds_write_b128 v4, v[252:255] offset:3072
  s_waitcnt lgkmcnt(0)
  s_mov_b64 s[92:93], exec
  s_mov_b64 exec, 1
  ds_add_u32 v84, v85 offset:52
  s_mov_b64 exec, s[92:93]
  s_mov_b32 s95, 400000
W_87:
  ds_read_b32 v3, v84 offset:0
  s_waitcnt lgkmcnt(0)
  v_readfirstlane_b32 s6, v3
  s_nop 3
  s_cmp_ge_u32 s6, 1
  s_cbranch_scc1 WD_88
  s_sleep 1
  s_sub_u32 s95, s95, 1
  s_cmp_lg_u32 s95, 0
  s_cbranch_scc1 W_87
WD_88:
  v_and_b32 v3, 15, v0
  v_lshlrev_b32 v3, 2, v3
  v_add_u32 v4, 163328, v3
  ds_read_b32 v5, v4
  ds_read_b32 v6, v4 offset:64
  ds_read_b32 v7, v4 offset:128
  ds_read_b32 v8, v4 offset:192
  v_lshlrev_b32 v3, 4, v0
  s_lshl_b32 s85, s3, 14
  v_add_u32 v94, s85, v3
  s_lshl_b32 s85, s80, 12
  v_add_u32 v82, s85, v3
  s_sub_u32 s85, 4096, s85
  v_add_u32 v83, s85, v3
  s_waitcnt lgkmcnt(0)
  v_sub_f32 v5, 1.0, v5
  v_sub_f32 v6, 1.0, v6
  v_sub_f32 v7, 1.0, v7
  v_sub_f32 v8, 1.0, v8
  v_cvt_pk_bf16_f32 v5, v5, v6
  v_cvt_pk_bf16_f32 v7, v7, v8
  v_lshlrev_b32 v88, 16, v5
  v_and_b32 v89, 0xffff0000, v5
  v_lshlrev_b32 v90, 16, v7
  v_and_b32 v91, 0xffff0000, v7
  s_cmp_eq_u32 s80, 0
  s_cselect_b64 s[86:87], -1, 0
  s_nop 0
  v_cndmask_b32 v92, v90, v88, s[86:87]
  v_cndmask_b32 v93, v91, v89, s[86:87]
  v_and_b32 v3, 15, v0
  v_lshrrev_b32 v4, 4, v0
  v_lshrrev_b32 v5, 2, v3
  v_and_b32 v3, 3, v3
  v_lshlrev_b32 v3, 3, v3
  v_add_u32 v3, s73, v3
  v_lshlrev_b32 v6, 2, v4
  v_add_u32 v6, v6, v5
  v_lshrrev_b32 v5, 1, v5
  v_lshlrev_b32 v7, 1, v4
  v_add_u32 v5, v5, v7
  v_and_b32 v5, 3, v5
  v_lshlrev_b32 v7, 7, v6
  v_add_u32 v7, v7, v3
  v_xor_b32 v8, 0, v5
  v_lshlrev_b32 v8, 5, v8
  v_add_u32 v76, v7, v8
  v_xor_b32 v8, 1, v5
  v_lshlrev_b32 v8, 5, v8
  v_add_u32 v77, v7, v8
  v_xor_b32 v8, 2, v5
  v_lshlrev_b32 v8, 5, v8
  v_add_u32 v78, v7, v8
  v_xor_b32 v8, 3, v5
  v_lshlrev_b32 v8, 5, v8
  v_add_u32 v79, v7, v8
  v_lshlrev_b32 v7, 6, v6
  v_add_u32 v7, v7, v3
  v_and_b32 v4, 1, v4
  v_xor_b32 v8, 0, v4
  v_lshlrev_b32 v8, 5, v8
  v_add_u32 v80, v7, v8
  v_xor_b32 v8, 1, v4
  v_lshlrev_b32 v8, 5, v8
  v_add_u32 v81, v7, v8
  v_pk_mul_f32 v[96:97], v[96:97], v[88:89] op_sel:[0,0] op_sel_hi:[1,0]
  v_pk_mul_f32 v[98:99], v[98:99], v[88:89] op_sel:[0,0] op_sel_hi:[1,0]
  v_pk_mul_f32 v[112:113], v[112:113], v[88:89] op_sel:[0,0] op_sel_hi:[1,0]
  v_pk_mul_f32 v[114:115], v[114:115], v[88:89] op_sel:[0,0] op_sel_hi:[1,0]
  v_cvt_pk_bf16_f32 v96, v96, v97
  v_cvt_pk_bf16_f32 v97, v98, v99
  v_cvt_pk_bf16_f32 v98, v112, v113
  v_cvt_pk_bf16_f32 v99, v114, v115
  v_pk_max_i16 v96, v96, 0
  v_pk_max_i16 v97, v97, 0
  v_pk_max_i16 v98, v98, 0
  v_pk_max_i16 v99, v99, 0
  v_pk_mul_f32 v[100:101], v[100:101], v[88:89] op_sel:[0,1] op_sel_hi:[1,1]
  v_pk_mul_f32 v[102:103], v[102:103], v[88:89] op_sel:[0,1] op_sel_hi:[1,1]
  v_pk_mul_f32 v[116:117], v[116:117], v[88:89] op_sel:[0,1] op_sel_hi:[1,1]
  v_pk_mul_f32 v[118:119], v[118:119], v[88:89] op_sel:[0,1] op_sel_hi:[1,1]
  v_cvt_pk_bf16_f32 v100, v100, v101
  v_cvt_pk_bf16_f32 v101, v102, v103
  v_cvt_pk_bf16_f32 v102, v116, v117
  v_cvt_pk_bf16_f32 v103, v118, v119
  v_pk_max_i16 v100, v100, 0
  v_pk_max_i16 v101, v101, 0
  v_pk_max_i16 v102, v102, 0
  v_pk_max_i16 v103, v103, 0
  v_pk_mul_f32 v[104:105], v[104:105], v[90:91] op_sel:[0,0] op_sel_hi:[1,0]
  v_pk_mul_f32 v[106:107], v[106:107], v[90:91] op_sel:[0,0] op_sel_hi:[1,0]
  v_pk_mul_f32 v[120:121], v[120:121], v[90:91] op_sel:[0,0] op_sel_hi:[1,0]
  v_pk_mul_f32 v[122:123], v[122:123], v[90:91] op_sel:[0,0] op_sel_hi:[1,0]
  v_cvt_pk_bf16_f32 v104, v104, v105
  v_cvt_pk_bf16_f32 v105, v106, v107
  v_cvt_pk_bf16_f32 v106, v120, v121
  v_cvt_pk_bf16_f32 v107, v122, v123
  v_pk_max_i16 v104, v104, 0
  v_pk_max_i16 v105, v105, 0
  v_pk_max_i16 v106, v106, 0
  v_pk_max_i16 v107, v107, 0
  v_pk_mul_f32 v[108:109], v[108:109], v[90:91] op_sel:[0,1] op_sel_hi:[1,1]
  v_pk_mul_f32 v[110:111], v[110:111], v[90:91] op_sel:[0,1] op_sel_hi:[1,1]
  v_pk_mul_f32 v[124:125], v[124:125], v[90:91] op_sel:[0,1] op_sel_hi:[1,1]
  v_pk_mul_f32 v[126:127], v[126:127], v[90:91] op_sel:[0,1] op_sel_hi:[1,1]
  v_cvt_pk_bf16_f32 v108, v108, v109
  v_cvt_pk_bf16_f32 v109, v110, v111
  v_cvt_pk_bf16_f32 v110, v124, v125
  v_cvt_pk_bf16_f32 v111, v126, v127
  v_pk_max_i16 v108, v108, 0
  v_pk_max_i16 v109, v109, 0
  v_pk_max_i16 v110, v110, 0
  v_pk_max_i16 v111, v111, 0
  v_pk_mul_f32 v[128:129], v[128:129], v[88:89] op_sel:[0,0] op_sel_hi:[1,0]
  v_pk_mul_f32 v[130:131], v[130:131], v[88:89] op_sel:[0,0] op_sel_hi:[1,0]
  v_pk_mul_f32 v[144:145], v[144:145], v[88:89] op_sel:[0,0] op_sel_hi:[1,0]
  v_pk_mul_f32 v[146:147], v[146:147], v[88:89] op_sel:[0,0] op_sel_hi:[1,0]
  v_cvt_pk_bf16_f32 v128, v128, v129
  v_cvt_pk_bf16_f32 v129, v130, v131
  v_cvt_pk_bf16_f32 v130, v144, v145
  v_cvt_pk_bf16_f32 v131, v146, v147
  v_pk_max_i16 v128, v128, 0
  v_pk_max_i16 v129, v129, 0
  v_pk_max_i16 v130, v130, 0
  v_pk_max_i16 v131, v131, 0
  v_pk_mul_f32 v[132:133], v[132:133], v[88:89] op_sel:[0,1] op_sel_hi:[1,1]
  v_pk_mul_f32 v[134:135], v[134:135], v[88:89] op_sel:[0,1] op_sel_hi:[1,1]
  v_pk_mul_f32 v[148:149], v[148:149], v[88:89] op_sel:[0,1] op_sel_hi:[1,1]
  v_pk_mul_f32 v[150:151], v[150:151], v[88:89] op_sel:[0,1] op_sel_hi:[1,1]
  v_cvt_pk_bf16_f32 v132, v132, v133
  v_cvt_pk_bf16_f32 v133, v134, v135
  v_cvt_pk_bf16_f32 v134, v148, v149
  v_cvt_pk_bf16_f32 v135, v150, v151
  v_pk_max_i16 v132, v132, 0
  v_pk_max_i16 v133, v133, 0
  v_pk_max_i16 v134, v134, 0
  v_pk_max_i16 v135, v135, 0
  v_pk_mul_f32 v[136:137], v[136:137], v[90:91] op_sel:[0,0] op_sel_hi:[1,0]
  v_pk_mul_f32 v[138:139], v[138:139], v[90:91] op_sel:[0,0] op_sel_hi:[1,0]
  v_pk_mul_f32 v[152:153], v[152:153], v[90:91] op_sel:[0,0] op_sel_hi:[1,0]
  v_pk_mul_f32 v[154:155], v[154:155], v[90:91] op_sel:[0,0] op_sel_hi:[1,0]
  v_cvt_pk_bf16_f32 v136, v136, v137
  v_cvt_pk_bf16_f32 v137, v138, v139
  v_cvt_pk_bf16_f32 v138, v152, v153
  v_cvt_pk_bf16_f32 v139, v154, v155
  v_pk_max_i16 v136, v136, 0
  v_pk_max_i16 v137, v137, 0
  v_pk_max_i16 v138, v138, 0
  v_pk_max_i16 v139, v139, 0
  v_pk_mul_f32 v[140:141], v[140:141], v[90:91] op_sel:[0,1] op_sel_hi:[1,1]
  v_pk_mul_f32 v[142:143], v[142:143], v[90:91] op_sel:[0,1] op_sel_hi:[1,1]
  v_pk_mul_f32 v[156:157], v[156:157], v[90:91] op_sel:[0,1] op_sel_hi:[1,1]
  v_pk_mul_f32 v[158:159], v[158:159], v[90:91] op_sel:[0,1] op_sel_hi:[1,1]
  v_cvt_pk_bf16_f32 v140, v140, v141
  v_cvt_pk_bf16_f32 v141, v142, v143
  v_cvt_pk_bf16_f32 v142, v156, v157
  v_cvt_pk_bf16_f32 v143, v158, v159
  v_pk_max_i16 v140, v140, 0
  v_pk_max_i16 v141, v141, 0
  v_pk_max_i16 v142, v142, 0
  v_pk_max_i16 v143, v143, 0
  v_pk_mul_f32 v[160:161], v[160:161], v[88:89] op_sel:[0,0] op_sel_hi:[1,0]
  v_pk_mul_f32 v[162:163], v[162:163], v[88:89] op_sel:[0,0] op_sel_hi:[1,0]
  v_pk_mul_f32 v[176:177], v[176:177], v[88:89] op_sel:[0,0] op_sel_hi:[1,0]
  v_pk_mul_f32 v[178:179], v[178:179], v[88:89] op_sel:[0,0] op_sel_hi:[1,0]
  v_cvt_pk_bf16_f32 v160, v160, v161
  v_cvt_pk_bf16_f32 v161, v162, v163
  v_cvt_pk_bf16_f32 v162, v176, v177
  v_cvt_pk_bf16_f32 v163, v178, v179
  v_pk_max_i16 v160, v160, 0
  v_pk_max_i16 v161, v161, 0
  v_pk_max_i16 v162, v162, 0
  v_pk_max_i16 v163, v163, 0
  v_pk_mul_f32 v[164:165], v[164:165], v[88:89] op_sel:[0,1] op_sel_hi:[1,1]
  v_pk_mul_f32 v[166:167], v[166:167], v[88:89] op_sel:[0,1] op_sel_hi:[1,1]
  v_pk_mul_f32 v[180:181], v[180:181], v[88:89] op_sel:[0,1] op_sel_hi:[1,1]
  v_pk_mul_f32 v[182:183], v[182:183], v[88:89] op_sel:[0,1] op_sel_hi:[1,1]
  v_cvt_pk_bf16_f32 v164, v164, v165
  v_cvt_pk_bf16_f32 v165, v166, v167
  v_cvt_pk_bf16_f32 v166, v180, v181
  v_cvt_pk_bf16_f32 v167, v182, v183
  v_pk_max_i16 v164, v164, 0
  v_pk_max_i16 v165, v165, 0
  v_pk_max_i16 v166, v166, 0
  v_pk_max_i16 v167, v167, 0
  v_pk_mul_f32 v[168:169], v[168:169], v[90:91] op_sel:[0,0] op_sel_hi:[1,0]
  v_pk_mul_f32 v[170:171], v[170:171], v[90:91] op_sel:[0,0] op_sel_hi:[1,0]
  v_pk_mul_f32 v[184:185], v[184:185], v[90:91] op_sel:[0,0] op_sel_hi:[1,0]
  v_pk_mul_f32 v[186:187], v[186:187], v[90:91] op_sel:[0,0] op_sel_hi:[1,0]
  v_cvt_pk_bf16_f32 v168, v168, v169
  v_cvt_pk_bf16_f32 v169, v170, v171
  v_cvt_pk_bf16_f32 v170, v184, v185
  v_cvt_pk_bf16_f32 v171, v186, v187
  v_pk_max_i16 v168, v168, 0
  v_pk_max_i16 v169, v169, 0
  v_pk_max_i16 v170, v170, 0
  v_pk_max_i16 v171, v171, 0
  v_pk_mul_f32 v[172:173], v[172:173], v[90:91] op_sel:[0,1] op_sel_hi:[1,1]
  v_pk_mul_f32 v[174:175], v[174:175], v[90:91] op_sel:[0,1] op_sel_hi:[1,1]
  v_pk_mul_f32 v[188:189], v[188:189], v[90:91] op_sel:[0,1] op_sel_hi:[1,1]
  v_pk_mul_f32 v[190:191], v[190:191], v[90:91] op_sel:[0,1] op_sel_hi:[1,1]
  v_cvt_pk_bf16_f32 v172, v172, v173
  v_cvt_pk_bf16_f32 v173, v174, v175
  v_cvt_pk_bf16_f32 v174, v188, v189
  v_cvt_pk_bf16_f32 v175, v190, v191
  v_pk_max_i16 v172, v172, 0
  v_pk_max_i16 v173, v173, 0
  v_pk_max_i16 v174, v174, 0
  v_pk_max_i16 v175, v175, 0
  v_pk_mul_f32 v[192:193], v[192:193], v[88:89] op_sel:[0,0] op_sel_hi:[1,0]
  v_pk_mul_f32 v[194:195], v[194:195], v[88:89] op_sel:[0,0] op_sel_hi:[1,0]
  v_pk_mul_f32 v[208:209], v[208:209], v[88:89] op_sel:[0,0] op_sel_hi:[1,0]
  v_pk_mul_f32 v[210:211], v[210:211], v[88:89] op_sel:[0,0] op_sel_hi:[1,0]
  v_cvt_pk_bf16_f32 v192, v192, v193
  v_cvt_pk_bf16_f32 v193, v194, v195
  v_cvt_pk_bf16_f32 v194, v208, v209
  v_cvt_pk_bf16_f32 v195, v210, v211
  v_pk_max_i16 v192, v192, 0
  v_pk_max_i16 v193, v193, 0
  v_pk_max_i16 v194, v194, 0
  v_pk_max_i16 v195, v195, 0
  v_pk_mul_f32 v[196:197], v[196:197], v[88:89] op_sel:[0,1] op_sel_hi:[1,1]
  v_pk_mul_f32 v[198:199], v[198:199], v[88:89] op_sel:[0,1] op_sel_hi:[1,1]
  v_pk_mul_f32 v[212:213], v[212:213], v[88:89] op_sel:[0,1] op_sel_hi:[1,1]
  v_pk_mul_f32 v[214:215], v[214:215], v[88:89] op_sel:[0,1] op_sel_hi:[1,1]
  v_cvt_pk_bf16_f32 v196, v196, v197
  v_cvt_pk_bf16_f32 v197, v198, v199
  v_cvt_pk_bf16_f32 v198, v212, v213
  v_cvt_pk_bf16_f32 v199, v214, v215
  v_pk_max_i16 v196, v196, 0
  v_pk_max_i16 v197, v197, 0
  v_pk_max_i16 v198, v198, 0
  v_pk_max_i16 v199, v199, 0
  v_pk_mul_f32 v[200:201], v[200:201], v[90:91] op_sel:[0,0] op_sel_hi:[1,0]
  v_pk_mul_f32 v[202:203], v[202:203], v[90:91] op_sel:[0,0] op_sel_hi:[1,0]
  v_pk_mul_f32 v[216:217], v[216:217], v[90:91] op_sel:[0,0] op_sel_hi:[1,0]
  v_pk_mul_f32 v[218:219], v[218:219], v[90:91] op_sel:[0,0] op_sel_hi:[1,0]
  v_cvt_pk_bf16_f32 v200, v200, v201
  v_cvt_pk_bf16_f32 v201, v202, v203
  v_cvt_pk_bf16_f32 v202, v216, v217
  v_cvt_pk_bf16_f32 v203, v218, v219
  v_pk_max_i16 v200, v200, 0
  v_pk_max_i16 v201, v201, 0
  v_pk_max_i16 v202, v202, 0
  v_pk_max_i16 v203, v203, 0
  v_pk_mul_f32 v[204:205], v[204:205], v[90:91] op_sel:[0,1] op_sel_hi:[1,1]
  v_pk_mul_f32 v[206:207], v[206:207], v[90:91] op_sel:[0,1] op_sel_hi:[1,1]
  v_pk_mul_f32 v[220:221], v[220:221], v[90:91] op_sel:[0,1] op_sel_hi:[1,1]
  v_pk_mul_f32 v[222:223], v[222:223], v[90:91] op_sel:[0,1] op_sel_hi:[1,1]
  v_cvt_pk_bf16_f32 v204, v204, v205
  v_cvt_pk_bf16_f32 v205, v206, v207
  v_cvt_pk_bf16_f32 v206, v220, v221
  v_cvt_pk_bf16_f32 v207, v222, v223
  v_pk_max_i16 v204, v204, 0
  v_pk_max_i16 v205, v205, 0
  v_pk_max_i16 v206, v206, 0
  v_pk_max_i16 v207, v207, 0
  s_mov_b32 s95, 400000
W_89:
  ds_read_b32 v3, v84 offset:52
  s_waitcnt lgkmcnt(0)
  v_readfirstlane_b32 s6, v3
  s_nop 3
  s_cmp_ge_u32 s6, 4
  s_cbranch_scc1 WD_90
  s_sleep 1
  s_sub_u32 s95, s95, 1
  s_cmp_lg_u32 s95, 0
  s_cbranch_scc1 W_89
WD_90:
  ds_read_b128 v[232:235], v86 offset:0
  ds_read_b128 v[236:239], v86 offset:1024
  ds_read_b128 v[248:251], v86 offset:2048
  ds_read_b128 v[252:255], v86 offset:3072
  s_waitcnt lgkmcnt(0)
  v_add_f32 v224, v224, v232
  v_add_f32 v225, v225, v233
  v_add_f32 v226, v226, v234
  v_add_f32 v227, v227, v235
  v_add_f32 v228, v228, v236
  v_add_f32 v229, v229, v237
  v_add_f32 v230, v230, v238
  v_add_f32 v231, v231, v239
  v_add_f32 v240, v240, v248
  v_add_f32 v241, v241, v249
  v_add_f32 v242, v242, v250
  v_add_f32 v243, v243, v251
  v_add_f32 v244, v244, v252
  v_add_f32 v245, v245, v253
  v_add_f32 v246, v246, v254
  v_add_f32 v247, v247, v255
  v_pk_mul_f32 v[224:225], v[224:225], v[92:93] op_sel:[0,0] op_sel_hi:[1,0]
  v_pk_mul_f32 v[226:227], v[226:227], v[92:93] op_sel:[0,0] op_sel_hi:[1,0]
  v_pk_mul_f32 v[240:241], v[240:241], v[92:93] op_sel:[0,0] op_sel_hi:[1,0]
  v_pk_mul_f32 v[242:243], v[242:243], v[92:93] op_sel:[0,0] op_sel_hi:[1,0]
  v_cvt_pk_bf16_f32 v224, v224, v225
  v_cvt_pk_bf16_f32 v225, v226, v227
  v_cvt_pk_bf16_f32 v226, v240, v241
  v_cvt_pk_bf16_f32 v227, v242, v243
  v_pk_max_i16 v224, v224, 0
  v_pk_max_i16 v225, v225, 0
  v_pk_max_i16 v226, v226, 0
  v_pk_max_i16 v227, v227, 0
  v_pk_mul_f32 v[228:229], v[228:229], v[92:93] op_sel:[0,1] op_sel_hi:[1,1]
  v_pk_mul_f32 v[230:231], v[230:231], v[92:93] op_sel:[0,1] op_sel_hi:[1,1]
  v_pk_mul_f32 v[244:245], v[244:245], v[92:93] op_sel:[0,1] op_sel_hi:[1,1]
  v_pk_mul_f32 v[246:247], v[246:247], v[92:93] op_sel:[0,1] op_sel_hi:[1,1]
  v_cvt_pk_bf16_f32 v228, v228, v229
  v_cvt_pk_bf16_f32 v229, v230, v231
  v_cvt_pk_bf16_f32 v230, v244, v245
  v_cvt_pk_bf16_f32 v231, v246, v247
  v_pk_max_i16 v228, v228, 0
  v_pk_max_i16 v229, v229, 0
  v_pk_max_i16 v230, v230, 0
  v_pk_max_i16 v231, v231, 0
  s_mov_b32 s95, 400000
W_91:
  ds_read_b32 v3, v84 offset:8
  s_waitcnt lgkmcnt(0)
  v_readfirstlane_b32 s6, v3
  s_nop 3
  s_cmp_ge_u32 s6, 8
  s_cbranch_scc1 WD_92
  s_sleep 1
  s_sub_u32 s95, s95, 1
  s_cmp_lg_u32 s95, 0
  s_cbranch_scc1 W_91
WD_92:
  ds_write_b128 v94, v[96:99] offset:0
  ds_write_b128 v94, v[100:103] offset:1024
  ds_write_b128 v94, v[104:107] offset:2048
  ds_write_b128 v94, v[108:111] offset:3072
  ds_write_b128 v94, v[128:131] offset:4096
  ds_write_b128 v94, v[132:135] offset:5120
  ds_write_b128 v94, v[136:139] offset:6144
  ds_write_b128 v94, v[140:143] offset:7168
  ds_write_b128 v94, v[160:163] offset:8192
  ds_write_b128 v94, v[164:167] offset:9216
  ds_write_b128 v94, v[168:171] offset:10240
  ds_write_b128 v94, v[172:175] offset:11264
  ds_write_b128 v94, v[192:195] offset:12288
  ds_write_b128 v94, v[196:199] offset:13312
  ds_write_b128 v94, v[200:203] offset:14336
  ds_write_b128 v94, v[204:207] offset:15360
  v_lshlrev_b32 v3, 4, v0
  s_add_u32 s85, s81, 16
  s_lshl_b32 s85, s85, 12
  s_lshl_b32 s86, s80, 11
  s_add_u32 s85, s85, s86
  v_add_u32 v4, s85, v3
  ds_write_b128 v4, v[224:227] offset:0
  ds_write_b128 v4, v[228:231] offset:1024
  s_waitcnt lgkmcnt(0)
  s_mov_b64 s[92:93], exec
  s_mov_b64 exec, 1
  ds_add_u32 v84, v85 offset:12
  s_mov_b64 exec, s[92:93]
  s_setprio 0
  s_mov_b32 s95, 400000
W_93:
  ds_read_b32 v3, v84 offset:12
  s_waitcnt lgkmcnt(0)
  v_readfirstlane_b32 s6, v3
  s_nop 3
  s_cmp_ge_u32 s6, 4
  s_cbranch_scc1 WD_94
  s_sleep 1
  s_sub_u32 s95, s95, 1
  s_cmp_lg_u32 s95, 0
  s_cbranch_scc1 W_93
WD_94:
  s_waitcnt vmcnt(10)
  ds_read_b128 v[42:45], v82 offset:0
  ds_read_b128 v[46:49], v82 offset:1024
  ds_read_b128 v[50:53], v82 offset:2048
  ds_read_b128 v[54:57], v82 offset:3072
  ds_read_b64_tr_b16 v[26:27], v76 offset:4096
  ds_read_b64_tr_b16 v[28:29], v76 offset:6144
  ds_read_b64_tr_b16 v[30:31], v77 offset:4096
  ds_read_b64_tr_b16 v[32:33], v77 offset:6144
  ds_read_b64_tr_b16 v[34:35], v78 offset:4096
  ds_read_b64_tr_b16 v[36:37], v78 offset:6144
  ds_read_b64_tr_b16 v[38:39], v79 offset:4096
  ds_read_b64_tr_b16 v[40:41], v79 offset:6144
  s_waitcnt lgkmcnt(0)
  s_waitcnt vmcnt(6)
  v_mfma_f32_16x16x32_bf16 v[96:99], v[26:29], v[42:45], 0
  ds_read_b64_tr_b16 v[10:11], v76 offset:8192
  v_mfma_f32_16x16x32_bf16 v[100:103], v[26:29], v[46:49], 0
  ds_read_b64_tr_b16 v[12:13], v76 offset:10240
  v_mfma_f32_16x16x32_bf16 v[104:107], v[26:29], v[50:53], 0
  ds_read_b64_tr_b16 v[14:15], v77 offset:8192
  v_mfma_f32_16x16x32_bf16 v[108:111], v[26:29], v[54:57], 0
  ds_read_b64_tr_b16 v[16:17], v77 offset:10240
  v_mfma_f32_16x16x32_bf16 v[112:115], v[30:33], v[42:45], 0
  ds_read_b64_tr_b16 v[18:19], v78 offset:8192
  v_mfma_f32_16x16x32_bf16 v[116:119], v[30:33], v[46:49], 0
  ds_read_b64_tr_b16 v[20:21], v78 offset:10240
  v_mfma_f32_16x16x32_bf16 v[120:123], v[30:33], v[50:53], 0
  ds_read_b64_tr_b16 v[22:23], v79 offset:8192
  v_mfma_f32_16x16x32_bf16 v[124:127], v[30:33], v[54:57], 0
  ds_read_b64_tr_b16 v[24:25], v79 offset:10240
  v_mfma_f32_16x16x32_bf16 v[128:131], v[34:37], v[42:45], 0
  s_add_u32 s72, s76, s78
  s_add_u32 s72, s72, 36992
  s_sub_u32 s72, s72, s83
  s_add_u32 m0, s73, 4096
  s_nop 0
  buffer_load_dwordx4 v74, s[28:31], s72 offen lds
  v_mfma_f32_16x16x32_bf16 v[132:135], v[34:37], v[46:49], 0
  v_mfma_f32_16x16x32_bf16 v[136:139], v[34:37], v[50:53], 0
  s_add_u32 s72, s72, 9216
  s_add_u32 m0, s73, 5120
  s_nop 0
  buffer_load_dwordx4 v74, s[28:31], s72 offen lds
  v_mfma_f32_16x16x32_bf16 v[140:143], v[34:37], v[54:57], 0
  v_mfma_f32_16x16x32_bf16 v[144:147], v[38:41], v[42:45], 0
  s_add_u32 s72, s72, 9216
  s_add_u32 m0, s73, 6144
  s_nop 0
  buffer_load_dwordx4 v74, s[28:31], s72 offen lds
  v_mfma_f32_16x16x32_bf16 v[148:151], v[38:41], v[46:49], 0
  v_mfma_f32_16x16x32_bf16 v[152:155], v[38:41], v[50:53], 0
  s_add_u32 s72, s72, 9216
  s_add_u32 m0, s73, 7168
  s_nop 0
  buffer_load_dwordx4 v74, s[28:31], s72 offen lds
  v_mfma_f32_16x16x32_bf16 v[156:159], v[38:41], v[54:57], 0
  s_waitcnt lgkmcnt(0)
  s_waitcnt vmcnt(8)
  v_mfma_f32_16x16x32_bf16 v[160:163], v[10:13], v[42:45], 0
  ds_read_b64_tr_b16 v[26:27], v80 offset:12288
  v_mfma_f32_16x16x32_bf16 v[164:167], v[10:13], v[46:49], 0
  ds_read_b64_tr_b16 v[28:29], v80 offset:13312
  v_mfma_f32_16x16x32_bf16 v[168:171], v[10:13], v[50:53], 0
  ds_read_b64_tr_b16 v[30:31], v81 offset:12288
  v_mfma_f32_16x16x32_bf16 v[172:175], v[10:13], v[54:57], 0
  ds_read_b64_tr_b16 v[32:33], v81 offset:13312
  v_mfma_f32_16x16x32_bf16 v[176:179], v[14:17], v[42:45], 0
  v_mfma_f32_16x16x32_bf16 v[180:183], v[14:17], v[46:49], 0
  v_mfma_f32_16x16x32_bf16 v[184:187], v[14:17], v[50:53], 0
  v_mfma_f32_16x16x32_bf16 v[188:191], v[14:17], v[54:57], 0
  v_mfma_f32_16x16x32_bf16 v[192:195], v[18:21], v[42:45], 0
  s_add_u32 s72, s76, s78
  s_add_u32 s72, s72, 73728
  s_add_u32 s72, s72, s83
  s_add_u32 m0, s73, 8192
  s_nop 0
  buffer_load_dwordx4 v74, s[28:31], s72 offen lds
  v_mfma_f32_16x16x32_bf16 v[196:199], v[18:21], v[46:49], 0
  v_mfma_f32_16x16x32_bf16 v[200:203], v[18:21], v[50:53], 0
  s_add_u32 s72, s72, 9216
  s_add_u32 m0, s73, 9216
  s_nop 0
  buffer_load_dwordx4 v74, s[28:31], s72 offen lds
  v_mfma_f32_16x16x32_bf16 v[204:207], v[18:21], v[54:57], 0
  v_mfma_f32_16x16x32_bf16 v[208:211], v[22:25], v[42:45], 0
  s_add_u32 s72, s72, 9216
  s_add_u32 m0, s73, 10240
  s_nop 0
  buffer_load_dwordx4 v74, s[28:31], s72 offen lds
  v_mfma_f32_16x16x32_bf16 v[212:215], v[22:25], v[46:49], 0
  v_mfma_f32_16x16x32_bf16 v[216:219], v[22:25], v[50:53], 0
  s_add_u32 s72, s72, 9216
  s_add_u32 m0, s73, 11264
  s_nop 0
  buffer_load_dwordx4 v74, s[28:31], s72 offen lds
  v_mfma_f32_16x16x32_bf16 v[220:223], v[22:25], v[54:57], 0
  s_waitcnt lgkmcnt(0)
  s_waitcnt vmcnt(8)
  v_mfma_f32_16x16x32_bf16 v[224:227], v[26:29], v[42:45], 0
  s_add_u32 s72, s76, s78
  s_add_u32 s72, s72, 73856
  s_add_u32 s72, s72, s83
  s_add_u32 m0, s73, 12288
  s_nop 0
  buffer_load_dwordx4 v74, s[28:31], s72 offen lds
  ds_read_b128 v[58:61], v83 offset:0
  ds_read_b128 v[62:65], v83 offset:1024
  ds_read_b128 v[66:69], v83 offset:2048
  v_mfma_f32_16x16x32_bf16 v[228:231], v[26:29], v[46:49], 0
  ds_read_b128 v[70:73], v83 offset:3072
  ds_read_b64_tr_b16 v[10:11], v76 offset:0
  ds_read_b64_tr_b16 v[12:13], v76 offset:2048
  v_mfma_f32_16x16x32_bf16 v[232:235], v[26:29], v[50:53], 0
  s_add_u32 s72, s72, 9216
  s_add_u32 m0, s73, 13312
  s_nop 0
  buffer_load_dwordx4 v74, s[28:31], s72 offen lds
  ds_read_b64_tr_b16 v[14:15], v77 offset:0
  ds_read_b64_tr_b16 v[16:17], v77 offset:2048
  ds_read_b64_tr_b16 v[18:19], v78 offset:0
  v_mfma_f32_16x16x32_bf16 v[236:239], v[26:29], v[54:57], 0
  ds_read_b64_tr_b16 v[20:21], v78 offset:2048
  ds_read_b64_tr_b16 v[22:23], v79 offset:0
  ds_read_b64_tr_b16 v[24:25], v79 offset:2048
  v_mfma_f32_16x16x32_bf16 v[240:243], v[30:33], v[42:45], 0
  s_add_u32 s72, s72, 9216
  s_add_u32 m0, s73, 14336
  s_nop 0
  buffer_load_dwordx4 v74, s[28:31], s72 offen lds
  v_mfma_f32_16x16x32_bf16 v[244:247], v[30:33], v[46:49], 0
  v_mfma_f32_16x16x32_bf16 v[248:251], v[30:33], v[50:53], 0
  s_add_u32 s72, s72, 9216
  s_add_u32 m0, s73, 15360
  s_nop 0
  buffer_load_dwordx4 v74, s[28:31], s72 offen lds
  v_mfma_f32_16x16x32_bf16 v[252:255], v[30:33], v[54:57], 0
  s_waitcnt lgkmcnt(0)
  s_waitcnt vmcnt(8)
  v_mfma_f32_16x16x32_bf16 v[96:99], v[10:13], v[58:61], v[96:99]
  ds_read_b64_tr_b16 v[26:27], v76 offset:4096
  v_mfma_f32_16x16x32_bf16 v[100:103], v[10:13], v[62:65], v[100:103]
  ds_read_b64_tr_b16 v[28:29], v76 offset:6144
  v_mfma_f32_16x16x32_bf16 v[104:107], v[10:13], v[66:69], v[104:107]
  ds_read_b64_tr_b16 v[30:31], v77 offset:4096
  v_mfma_f32_16x16x32_bf16 v[108:111], v[10:13], v[70:73], v[108:111]
  ds_read_b64_tr_b16 v[32:33], v77 offset:6144
  v_mfma_f32_16x16x32_bf16 v[112:115], v[14:17], v[58:61], v[112:115]
  ds_read_b64_tr_b16 v[34:35], v78 offset:4096
  v_mfma_f32_16x16x32_bf16 v[116:119], v[14:17], v[62:65], v[116:119]
  ds_read_b64_tr_b16 v[36:37], v78 offset:6144
  v_mfma_f32_16x16x32_bf16 v[120:123], v[14:17], v[66:69], v[120:123]
  ds_read_b64_tr_b16 v[38:39], v79 offset:4096
  v_mfma_f32_16x16x32_bf16 v[124:127], v[14:17], v[70:73], v[124:127]
  ds_read_b64_tr_b16 v[40:41], v79 offset:6144
  v_mfma_f32_16x16x32_bf16 v[128:131], v[18:21], v[58:61], v[128:131]
  v_mfma_f32_16x16x32_bf16 v[132:135], v[18:21], v[62:65], v[132:135]
  v_mfma_f32_16x16x32_bf16 v[136:139], v[18:21], v[66:69], v[136:139]
  v_mfma_f32_16x16x32_bf16 v[140:143], v[18:21], v[70:73], v[140:143]
  v_mfma_f32_16x16x32_bf16 v[144:147], v[22:25], v[58:61], v[144:147]
  s_add_u32 s72, s76, s79
  s_add_u32 s72, s72, 73728
  s_add_u32 s72, s72, s83
  s_add_u32 m0, s73, 0
  s_nop 0
  buffer_load_dwordx4 v87, s[28:31], s72 offen lds
  v_mfma_f32_16x16x32_bf16 v[148:151], v[22:25], v[62:65], v[148:151]
  v_mfma_f32_16x16x32_bf16 v[152:155], v[22:25], v[66:69], v[152:155]
  s_add_u32 s72, s72, 18432
  s_add_u32 m0, s73, 1024
  s_nop 0
  buffer_load_dwordx4 v87, s[28:31], s72 offen lds
  v_mfma_f32_16x16x32_bf16 v[156:159], v[22:25], v[70:73], v[156:159]
  s_waitcnt lgkmcnt(0)
  s_waitcnt vmcnt(6)
  v_mfma_f32_16x16x32_bf16 v[160:163], v[26:29], v[58:61], v[160:163]
  ds_read_b128 v[42:45], v82 offset:8192
  v_mfma_f32_16x16x32_bf16 v[164:167], v[26:29], v[62:65], v[164:167]
  ds_read_b128 v[46:49], v82 offset:9216
  v_mfma_f32_16x16x32_bf16 v[168:171], v[26:29], v[66:69], v[168:171]
  ds_read_b128 v[50:53], v82 offset:10240
  v_mfma_f32_16x16x32_bf16 v[172:175], v[26:29], v[70:73], v[172:175]
  ds_read_b128 v[54:57], v82 offset:11264
  v_mfma_f32_16x16x32_bf16 v[176:179], v[30:33], v[58:61], v[176:179]
  ds_read_b64_tr_b16 v[10:11], v76 offset:8192
  v_mfma_f32_16x16x32_bf16 v[180:183], v[30:33], v[62:65], v[180:183]
  ds_read_b64_tr_b16 v[12:13], v76 offset:10240
  v_mfma_f32_16x16x32_bf16 v[184:187], v[30:33], v[66:69], v[184:187]
  ds_read_b64_tr_b16 v[14:15], v77 offset:8192
  v_mfma_f32_16x16x32_bf16 v[188:191], v[30:33], v[70:73], v[188:191]
  ds_read_b64_tr_b16 v[16:17], v77 offset:10240
  v_mfma_f32_16x16x32_bf16 v[192:195], v[34:37], v[58:61], v[192:195]
  s_add_u32 s72, s76, s78
  s_add_u32 s72, s72, 110592
  s_sub_u32 s72, s72, s83
  s_add_u32 m0, s73, 4096
  s_nop 0
  buffer_load_dwordx4 v74, s[28:31], s72 offen lds
  ds_read_b64_tr_b16 v[18:19], v78 offset:8192
  v_mfma_f32_16x16x32_bf16 v[196:199], v[34:37], v[62:65], v[196:199]
  ds_read_b64_tr_b16 v[20:21], v78 offset:10240
  v_mfma_f32_16x16x32_bf16 v[200:203], v[34:37], v[66:69], v[200:203]
  s_add_u32 s72, s72, 9216
  s_add_u32 m0, s73, 5120
  s_nop 0
  buffer_load_dwordx4 v74, s[28:31], s72 offen lds
  ds_read_b64_tr_b16 v[22:23], v79 offset:8192
  v_mfma_f32_16x16x32_bf16 v[204:207], v[34:37], v[70:73], v[204:207]
  ds_read_b64_tr_b16 v[24:25], v79 offset:10240
  v_mfma_f32_16x16x32_bf16 v[208:211], v[38:41], v[58:61], v[208:211]
  s_add_u32 s72, s72, 9216
  s_add_u32 m0, s73, 6144
  s_nop 0
  buffer_load_dwordx4 v74, s[28:31], s72 offen lds
  v_mfma_f32_16x16x32_bf16 v[212:215], v[38:41], v[62:65], v[212:215]
  v_mfma_f32_16x16x32_bf16 v[216:219], v[38:41], v[66:69], v[216:219]
  s_add_u32 s72, s72, 9216
  s_add_u32 m0, s73, 7168
  s_nop 0
  buffer_load_dwordx4 v74, s[28:31], s72 offen lds
  v_mfma_f32_16x16x32_bf16 v[220:223], v[38:41], v[70:73], v[220:223]
  s_waitcnt lgkmcnt(0)
  s_waitcnt vmcnt(6)
  v_mfma_f32_16x16x32_bf16 v[96:99], v[10:13], v[42:45], v[96:99]
  ds_read_b64_tr_b16 v[26:27], v76 offset:12288
  v_mfma_f32_16x16x32_bf16 v[100:103], v[10:13], v[46:49], v[100:103]
  ds_read_b64_tr_b16 v[28:29], v76 offset:14336
  v_mfma_f32_16x16x32_bf16 v[104:107], v[10:13], v[50:53], v[104:107]
  ds_read_b64_tr_b16 v[30:31], v77 offset:12288
  v_mfma_f32_16x16x32_bf16 v[108:111], v[10:13], v[54:57], v[108:111]
  ds_read_b64_tr_b16 v[32:33], v77 offset:14336
  v_mfma_f32_16x16x32_bf16 v[112:115], v[14:17], v[42:45], v[112:115]
  ds_read_b64_tr_b16 v[34:35], v78 offset:12288
  v_mfma_f32_16x16x32_bf16 v[116:119], v[14:17], v[46:49], v[116:119]
  ds_read_b64_tr_b16 v[36:37], v78 offset:14336
  v_mfma_f32_16x16x32_bf16 v[120:123], v[14:17], v[50:53], v[120:123]
  ds_read_b64_tr_b16 v[38:39], v79 offset:12288
  v_mfma_f32_16x16x32_bf16 v[124:127], v[14:17], v[54:57], v[124:127]
  ds_read_b64_tr_b16 v[40:41], v79 offset:14336
  v_mfma_f32_16x16x32_bf16 v[128:131], v[18:21], v[42:45], v[128:131]
  s_add_u32 s72, s76, s78
  s_add_u32 s72, s72, 110720
  s_sub_u32 s72, s72, s83
  s_add_u32 m0, s73, 8192
  s_nop 0
  buffer_load_dwordx4 v74, s[28:31], s72 offen lds
  v_mfma_f32_16x16x32_bf16 v[132:135], v[18:21], v[46:49], v[132:135]
  v_mfma_f32_16x16x32_bf16 v[136:139], v[18:21], v[50:53], v[136:139]
  s_add_u32 s72, s72, 9216
  s_add_u32 m0, s73, 9216
  s_nop 0
  buffer_load_dwordx4 v74, s[28:31], s72 offen lds
  v_mfma_f32_16x16x32_bf16 v[140:143], v[18:21], v[54:57], v[140:143]
  v_mfma_f32_16x16x32_bf16 v[144:147], v[22:25], v[42:45], v[144:147]
  s_add_u32 s72, s72, 9216
  s_add_u32 m0, s73, 10240
  s_nop 0
  buffer_load_dwordx4 v74, s[28:31], s72 offen lds
  v_mfma_f32_16x16x32_bf16 v[148:151], v[22:25], v[46:49], v[148:151]
  v_mfma_f32_16x16x32_bf16 v[152:155], v[22:25], v[50:53], v[152:155]
  s_add_u32 s72, s72, 9216
  s_add_u32 m0, s73, 11264
  s_nop 0
  buffer_load_dwordx4 v74, s[28:31], s72 offen lds
  v_mfma_f32_16x16x32_bf16 v[156:159], v[22:25], v[54:57], v[156:159]
  s_waitcnt lgkmcnt(0)
  s_waitcnt vmcnt(8)
  v_mfma_f32_16x16x32_bf16 v[160:163], v[26:29], v[42:45], v[160:163]
  ds_read_b64_tr_b16 v[10:11], v80 offset:0
  v_mfma_f32_16x16x32_bf16 v[164:167], v[26:29], v[46:49], v[164:167]
  ds_read_b64_tr_b16 v[12:13], v80 offset:1024
  v_mfma_f32_16x16x32_bf16 v[168:171], v[26:29], v[50:53], v[168:171]
  ds_read_b64_tr_b16 v[14:15], v81 offset:0
  v_mfma_f32_16x16x32_bf16 v[172:175], v[26:29], v[54:57], v[172:175]
  ds_read_b64_tr_b16 v[16:17], v81 offset:1024
  v_mfma_f32_16x16x32_bf16 v[176:179], v[30:33], v[42:45], v[176:179]
  v_mfma_f32_16x16x32_bf16 v[180:183], v[30:33], v[46:49], v[180:183]
  v_mfma_f32_16x16x32_bf16 v[184:187], v[30:33], v[50:53], v[184:187]
  v_mfma_f32_16x16x32_bf16 v[188:191], v[30:33], v[54:57], v[188:191]
  v_mfma_f32_16x16x32_bf16 v[192:195], v[34:37], v[42:45], v[192:195]
  s_add_u32 s72, s76, s78
  s_add_u32 s72, s72, 147456
  s_add_u32 s72, s72, s83
  s_add_u32 m0, s73, 12288
  s_nop 0
  buffer_load_dwordx4 v74, s[28:31], s72 offen lds
  v_mfma_f32_16x16x32_bf16 v[196:199], v[34:37], v[46:49], v[196:199]
  v_mfma_f32_16x16x32_bf16 v[200:203], v[34:37], v[50:53], v[200:203]
  s_add_u32 s72, s72, 9216
  s_add_u32 m0, s73, 13312
  s_nop 0
  buffer_load_dwordx4 v74, s[28:31], s72 offen lds
  v_mfma_f32_16x16x32_bf16 v[204:207], v[34:37], v[54:57], v[204:207]
  v_mfma_f32_16x16x32_bf16 v[208:211], v[38:41], v[42:45], v[208:211]
  s_add_u32 s72, s72, 9216
  s_add_u32 m0, s73, 14336
  s_nop 0
  buffer_load_dwordx4 v74, s[28:31], s72 offen lds
  v_mfma_f32_16x16x32_bf16 v[212:215], v[38:41], v[46:49], v[212:215]
  v_mfma_f32_16x16x32_bf16 v[216:219], v[38:41], v[50:53], v[216:219]
  s_add_u32 s72, s72, 9216
  s_add_u32 m0, s73, 15360
  s_nop 0
  buffer_load_dwordx4 v74, s[28:31], s72 offen lds
  v_mfma_f32_16x16x32_bf16 v[220:223], v[38:41], v[54:57], v[220:223]
  s_waitcnt lgkmcnt(0)
  s_waitcnt vmcnt(8)
  v_mfma_f32_16x16x32_bf16 v[224:227], v[10:13], v[42:45], v[224:227]
  s_add_u32 s72, s76, s78
  s_add_u32 s72, s72, 147584
  s_add_u32 s72, s72, s83
  s_add_u32 m0, s73, 0
  s_nop 0
  buffer_load_dwordx4 v74, s[28:31], s72 offen lds
  ds_read_b128 v[58:61], v83 offset:8192
  ds_read_b128 v[62:65], v83 offset:9216
  ds_read_b128 v[66:69], v83 offset:10240
  v_mfma_f32_16x16x32_bf16 v[228:231], v[10:13], v[46:49], v[228:231]
  ds_read_b128 v[70:73], v83 offset:11264
  ds_read_b64_tr_b16 v[26:27], v76 offset:4096
  ds_read_b64_tr_b16 v[28:29], v76 offset:6144
  v_mfma_f32_16x16x32_bf16 v[232:235], v[10:13], v[50:53], v[232:235]
  s_add_u32 s72, s72, 9216
  s_add_u32 m0, s73, 1024
  s_nop 0
  buffer_load_dwordx4 v74, s[28:31], s72 offen lds
  ds_read_b64_tr_b16 v[30:31], v77 offset:4096
  ds_read_b64_tr_b16 v[32:33], v77 offset:6144
  ds_read_b64_tr_b16 v[34:35], v78 offset:4096
  v_mfma_f32_16x16x32_bf16 v[236:239], v[10:13], v[54:57], v[236:239]
  ds_read_b64_tr_b16 v[36:37], v78 offset:6144
  ds_read_b64_tr_b16 v[38:39], v79 offset:4096
  ds_read_b64_tr_b16 v[40:41], v79 offset:6144
  v_mfma_f32_16x16x32_bf16 v[240:243], v[14:17], v[42:45], v[240:243]
  s_add_u32 s72, s72, 9216
  s_add_u32 m0, s73, 2048
  s_nop 0
  buffer_load_dwordx4 v74, s[28:31], s72 offen lds
  v_mfma_f32_16x16x32_bf16 v[244:247], v[14:17], v[46:49], v[244:247]
  v_mfma_f32_16x16x32_bf16 v[248:251], v[14:17], v[50:53], v[248:251]
  s_add_u32 s72, s72, 9216
  s_add_u32 m0, s73, 3072
  s_nop 0
  buffer_load_dwordx4 v74, s[28:31], s72 offen lds
  v_mfma_f32_16x16x32_bf16 v[252:255], v[14:17], v[54:57], v[252:255]
  s_waitcnt lgkmcnt(0)
  s_waitcnt vmcnt(8)
  v_mfma_f32_16x16x32_bf16 v[96:99], v[26:29], v[58:61], v[96:99]
  ds_read_b64_tr_b16 v[10:11], v76 offset:8192
  v_mfma_f32_16x16x32_bf16 v[100:103], v[26:29], v[62:65], v[100:103]
  ds_read_b64_tr_b16 v[12:13], v76 offset:10240
  v_mfma_f32_16x16x32_bf16 v[104:107], v[26:29], v[66:69], v[104:107]
  ds_read_b64_tr_b16 v[14:15], v77 offset:8192
  v_mfma_f32_16x16x32_bf16 v[108:111], v[26:29], v[70:73], v[108:111]
  ds_read_b64_tr_b16 v[16:17], v77 offset:10240
  v_mfma_f32_16x16x32_bf16 v[112:115], v[30:33], v[58:61], v[112:115]
  ds_read_b64_tr_b16 v[18:19], v78 offset:8192
  v_mfma_f32_16x16x32_bf16 v[116:119], v[30:33], v[62:65], v[116:119]
  ds_read_b64_tr_b16 v[20:21], v78 offset:10240
  v_mfma_f32_16x16x32_bf16 v[120:123], v[30:33], v[66:69], v[120:123]
  ds_read_b64_tr_b16 v[22:23], v79 offset:8192
  v_mfma_f32_16x16x32_bf16 v[124:127], v[30:33], v[70:73], v[124:127]
  ds_read_b64_tr_b16 v[24:25], v79 offset:10240
  v_mfma_f32_16x16x32_bf16 v[128:131], v[34:37], v[58:61], v[128:131]
  v_mfma_f32_16x16x32_bf16 v[132:135], v[34:37], v[62:65], v[132:135]
  v_mfma_f32_16x16x32_bf16 v[136:139], v[34:37], v[66:69], v[136:139]
  v_mfma_f32_16x16x32_bf16 v[140:143], v[34:37], v[70:73], v[140:143]
  v_mfma_f32_16x16x32_bf16 v[144:147], v[38:41], v[58:61], v[144:147]
  s_add_u32 s72, s76, s79
  s_add_u32 s72, s72, 147456
  s_add_u32 s72, s72, s83
  s_add_u32 m0, s73, 4096
  s_nop 0
  buffer_load_dwordx4 v87, s[28:31], s72 offen lds
  v_mfma_f32_16x16x32_bf16 v[148:151], v[38:41], v[62:65], v[148:151]
  v_mfma_f32_16x16x32_bf16 v[152:155], v[38:41], v[66:69], v[152:155]
  s_add_u32 s72, s72, 18432
  s_add_u32 m0, s73, 5120
  s_nop 0
  buffer_load_dwordx4 v87, s[28:31], s72 offen lds
  v_mfma_f32_16x16x32_bf16 v[156:159], v[38:41], v[70:73], v[156:159]
  s_waitcnt lgkmcnt(0)
  s_waitcnt vmcnt(6)
  v_mfma_f32_16x16x32_bf16 v[160:163], v[10:13], v[58:61], v[160:163]
  ds_read_b128 v[42:45], v82 offset:16384
  v_mfma_f32_16x16x32_bf16 v[164:167], v[10:13], v[62:65], v[164:167]
  ds_read_b128 v[46:49], v82 offset:17408
  v_mfma_f32_16x16x32_bf16 v[168:171], v[10:13], v[66:69], v[168:171]
  ds_read_b128 v[50:53], v82 offset:18432
  v_mfma_f32_16x16x32_bf16 v[172:175], v[10:13], v[70:73], v[172:175]
  ds_read_b128 v[54:57], v82 offset:19456
  v_mfma_f32_16x16x32_bf16 v[176:179], v[14:17], v[58:61], v[176:179]
  ds_read_b64_tr_b16 v[26:27], v76 offset:12288
  v_mfma_f32_16x16x32_bf16 v[180:183], v[14:17], v[62:65], v[180:183]
  ds_read_b64_tr_b16 v[28:29], v76 offset:14336
  v_mfma_f32_16x16x32_bf16 v[184:187], v[14:17], v[66:69], v[184:187]
  ds_read_b64_tr_b16 v[30:31], v77 offset:12288
  v_mfma_f32_16x16x32_bf16 v[188:191], v[14:17], v[70:73], v[188:191]
  ds_read_b64_tr_b16 v[32:33], v77 offset:14336
  v_mfma_f32_16x16x32_bf16 v[192:195], v[18:21], v[58:61], v[192:195]
  s_add_u32 s72, s76, s78
  s_add_u32 s72, s72, 184320
  s_sub_u32 s72, s72, s83
  s_add_u32 m0, s73, 8192
  s_nop 0
  buffer_load_dwordx4 v74, s[28:31], s72 offen lds
  ds_read_b64_tr_b16 v[34:35], v78 offset:12288
  v_mfma_f32_16x16x32_bf16 v[196:199], v[18:21], v[62:65], v[196:199]
  ds_read_b64_tr_b16 v[36:37], v78 offset:14336
  v_mfma_f32_16x16x32_bf16 v[200:203], v[18:21], v[66:69], v[200:203]
  s_add_u32 s72, s72, 9216
  s_add_u32 m0, s73, 9216
  s_nop 0
  buffer_load_dwordx4 v74, s[28:31], s72 offen lds
  ds_read_b64_tr_b16 v[38:39], v79 offset:12288
  v_mfma_f32_16x16x32_bf16 v[204:207], v[18:21], v[70:73], v[204:207]
  ds_read_b64_tr_b16 v[40:41], v79 offset:14336
  v_mfma_f32_16x16x32_bf16 v[208:211], v[22:25], v[58:61], v[208:211]
  s_add_u32 s72, s72, 9216
  s_add_u32 m0, s73, 10240
  s_nop 0
  buffer_load_dwordx4 v74, s[28:31], s72 offen lds
  v_mfma_f32_16x16x32_bf16 v[212:215], v[22:25], v[62:65], v[212:215]
  v_mfma_f32_16x16x32_bf16 v[216:219], v[22:25], v[66:69], v[216:219]
  s_add_u32 s72, s72, 9216
  s_add_u32 m0, s73, 11264
  s_nop 0
  buffer_load_dwordx4 v74, s[28:31], s72 offen lds
  v_mfma_f32_16x16x32_bf16 v[220:223], v[22:25], v[70:73], v[220:223]
  s_waitcnt lgkmcnt(0)
  s_waitcnt vmcnt(6)
  v_mfma_f32_16x16x32_bf16 v[96:99], v[26:29], v[42:45], v[96:99]
  ds_read_b64_tr_b16 v[10:11], v76 offset:0
  v_mfma_f32_16x16x32_bf16 v[100:103], v[26:29], v[46:49], v[100:103]
  ds_read_b64_tr_b16 v[12:13], v76 offset:2048
  v_mfma_f32_16x16x32_bf16 v[104:107], v[26:29], v[50:53], v[104:107]
  ds_read_b64_tr_b16 v[14:15], v77 offset:0
  v_mfma_f32_16x16x32_bf16 v[108:111], v[26:29], v[54:57], v[108:111]
  ds_read_b64_tr_b16 v[16:17], v77 offset:2048
  v_mfma_f32_16x16x32_bf16 v[112:115], v[30:33], v[42:45], v[112:115]
  ds_read_b64_tr_b16 v[18:19], v78 offset:0
  v_mfma_f32_16x16x32_bf16 v[116:119], v[30:33], v[46:49], v[116:119]
  ds_read_b64_tr_b16 v[20:21], v78 offset:2048
  v_mfma_f32_16x16x32_bf16 v[120:123], v[30:33], v[50:53], v[120:123]
  ds_read_b64_tr_b16 v[22:23], v79 offset:0
  v_mfma_f32_16x16x32_bf16 v[124:127], v[30:33], v[54:57], v[124:127]
  ds_read_b64_tr_b16 v[24:25], v79 offset:2048
  v_mfma_f32_16x16x32_bf16 v[128:131], v[34:37], v[42:45], v[128:131]
  s_add_u32 s72, s76, s78
  s_add_u32 s72, s72, 184448
  s_sub_u32 s72, s72, s83
  s_add_u32 m0, s73, 12288
  s_nop 0
  buffer_load_dwordx4 v74, s[28:31], s72 offen lds
  v_mfma_f32_16x16x32_bf16 v[132:135], v[34:37], v[46:49], v[132:135]
  v_mfma_f32_16x16x32_bf16 v[136:139], v[34:37], v[50:53], v[136:139]
  s_add_u32 s72, s72, 9216
  s_add_u32 m0, s73, 13312
  s_nop 0
  buffer_load_dwordx4 v74, s[28:31], s72 offen lds
  v_mfma_f32_16x16x32_bf16 v[140:143], v[34:37], v[54:57], v[140:143]
  v_mfma_f32_16x16x32_bf16 v[144:147], v[38:41], v[42:45], v[144:147]
  s_add_u32 s72, s72, 9216
  s_add_u32 m0, s73, 14336
  s_nop 0
  buffer_load_dwordx4 v74, s[28:31], s72 offen lds
  v_mfma_f32_16x16x32_bf16 v[148:151], v[38:41], v[46:49], v[148:151]
  v_mfma_f32_16x16x32_bf16 v[152:155], v[38:41], v[50:53], v[152:155]
  s_add_u32 s72, s72, 9216
  s_add_u32 m0, s73, 15360
  s_nop 0
  buffer_load_dwordx4 v74, s[28:31], s72 offen lds
  v_mfma_f32_16x16x32_bf16 v[156:159], v[38:41], v[54:57], v[156:159]
  s_waitcnt lgkmcnt(0)
  s_waitcnt vmcnt(8)
  v_mfma_f32_16x16x32_bf16 v[160:163], v[10:13], v[42:45], v[160:163]
  ds_read_b64_tr_b16 v[26:27], v80 offset:4096
  v_mfma_f32_16x16x32_bf16 v[164:167], v[10:13], v[46:49], v[164:167]
  ds_read_b64_tr_b16 v[28:29], v80 offset:5120
  v_mfma_f32_16x16x32_bf16 v[168:171], v[10:13], v[50:53], v[168:171]
  ds_read_b64_tr_b16 v[30:31], v81 offset:4096
  v_mfma_f32_16x16x32_bf16 v[172:175], v[10:13], v[54:57], v[172:175]
  ds_read_b64_tr_b16 v[32:33], v81 offset:5120
  v_mfma_f32_16x16x32_bf16 v[176:179], v[14:17], v[42:45], v[176:179]
  v_mfma_f32_16x16x32_bf16 v[180:183], v[14:17], v[46:49], v[180:183]
  v_mfma_f32_16x16x32_bf16 v[184:187], v[14:17], v[50:53], v[184:187]
  v_mfma_f32_16x16x32_bf16 v[188:191], v[14:17], v[54:57], v[188:191]
  v_mfma_f32_16x16x32_bf16 v[192:195], v[18:21], v[42:45], v[192:195]
  s_add_u32 s72, s76, s78
  s_add_u32 s72, s72, 221184
  s_add_u32 s72, s72, s83
  s_add_u32 m0, s73, 0
  s_nop 0
  buffer_load_dwordx4 v74, s[28:31], s72 offen lds
  v_mfma_f32_16x16x32_bf16 v[196:199], v[18:21], v[46:49], v[196:199]
  v_mfma_f32_16x16x32_bf16 v[200:203], v[18:21], v[50:53], v[200:203]
  s_add_u32 s72, s72, 9216
  s_add_u32 m0, s73, 1024
  s_nop 0
  buffer_load_dwordx4 v74, s[28:31], s72 offen lds
  v_mfma_f32_16x16x32_bf16 v[204:207], v[18:21], v[54:57], v[204:207]
  v_mfma_f32_16x16x32_bf16 v[208:211], v[22:25], v[42:45], v[208:211]
  s_add_u32 s72, s72, 9216
  s_add_u32 m0, s73, 2048
  s_nop 0
  buffer_load_dwordx4 v74, s[28:31], s72 offen lds
  v_mfma_f32_16x16x32_bf16 v[212:215], v[22:25], v[46:49], v[212:215]
  v_mfma_f32_16x16x32_bf16 v[216:219], v[22:25], v[50:53], v[216:219]
  s_add_u32 s72, s72, 9216
  s_add_u32 m0, s73, 3072
  s_nop 0
  buffer_load_dwordx4 v74, s[28:31], s72 offen lds
  v_mfma_f32_16x16x32_bf16 v[220:223], v[22:25], v[54:57], v[220:223]
  s_waitcnt lgkmcnt(0)
  s_waitcnt vmcnt(8)
  v_mfma_f32_16x16x32_bf16 v[224:227], v[26:29], v[42:45], v[224:227]
  s_add_u32 s72, s76, s78
  s_add_u32 s72, s72, 221312
  s_add_u32 s72, s72, s83
  s_add_u32 m0, s73, 4096
  s_nop 0
  buffer_load_dwordx4 v74, s[28:31], s72 offen lds
  ds_read_b128 v[58:61], v83 offset:16384
  ds_read_b128 v[62:65], v83 offset:17408
  ds_read_b128 v[66:69], v83 offset:18432
  v_mfma_f32_16x16x32_bf16 v[228:231], v[26:29], v[46:49], v[228:231]
  ds_read_b128 v[70:73], v83 offset:19456
  ds_read_b64_tr_b16 v[10:11], v76 offset:8192
  ds_read_b64_tr_b16 v[12:13], v76 offset:10240
  v_mfma_f32_16x16x32_bf16 v[232:235], v[26:29], v[50:53], v[232:235]
  s_add_u32 s72, s72, 9216
  s_add_u32 m0, s73, 5120
  s_nop 0
  buffer_load_dwordx4 v74, s[28:31], s72 offen lds
  ds_read_b64_tr_b16 v[14:15], v77 offset:8192
  ds_read_b64_tr_b16 v[16:17], v77 offset:10240
  ds_read_b64_tr_b16 v[18:19], v78 offset:8192
  v_mfma_f32_16x16x32_bf16 v[236:239], v[26:29], v[54:57], v[236:239]
  ds_read_b64_tr_b16 v[20:21], v78 offset:10240
  ds_read_b64_tr_b16 v[22:23], v79 offset:8192
  ds_read_b64_tr_b16 v[24:25], v79 offset:10240
  v_mfma_f32_16x16x32_bf16 v[240:243], v[30:33], v[42:45], v[240:243]
  s_add_u32 s72, s72, 9216
  s_add_u32 m0, s73, 6144
  s_nop 0
  buffer_load_dwordx4 v74, s[28:31], s72 offen lds
  v_mfma_f32_16x16x32_bf16 v[244:247], v[30:33], v[46:49], v[244:247]
  v_mfma_f32_16x16x32_bf16 v[248:251], v[30:33], v[50:53], v[248:251]
  s_add_u32 s72, s72, 9216
  s_add_u32 m0, s73, 7168
  s_nop 0
  buffer_load_dwordx4 v74, s[28:31], s72 offen lds
  v_mfma_f32_16x16x32_bf16 v[252:255], v[30:33], v[54:57], v[252:255]
  s_waitcnt lgkmcnt(0)
  s_waitcnt vmcnt(8)
  v_mfma_f32_16x16x32_bf16 v[96:99], v[10:13], v[58:61], v[96:99]
  ds_read_b64_tr_b16 v[26:27], v76 offset:12288
  v_mfma_f32_16x16x32_bf16 v[100:103], v[10:13], v[62:65], v[100:103]
  ds_read_b64_tr_b16 v[28:29], v76 offset:14336
  v_mfma_f32_16x16x32_bf16 v[104:107], v[10:13], v[66:69], v[104:107]
  ds_read_b64_tr_b16 v[30:31], v77 offset:12288
  v_mfma_f32_16x16x32_bf16 v[108:111], v[10:13], v[70:73], v[108:111]
  ds_read_b64_tr_b16 v[32:33], v77 offset:14336
  v_mfma_f32_16x16x32_bf16 v[112:115], v[14:17], v[58:61], v[112:115]
  ds_read_b64_tr_b16 v[34:35], v78 offset:12288
  v_mfma_f32_16x16x32_bf16 v[116:119], v[14:17], v[62:65], v[116:119]
  ds_read_b64_tr_b16 v[36:37], v78 offset:14336
  v_mfma_f32_16x16x32_bf16 v[120:123], v[14:17], v[66:69], v[120:123]
  ds_read_b64_tr_b16 v[38:39], v79 offset:12288
  v_mfma_f32_16x16x32_bf16 v[124:127], v[14:17], v[70:73], v[124:127]
  ds_read_b64_tr_b16 v[40:41], v79 offset:14336
  v_mfma_f32_16x16x32_bf16 v[128:131], v[18:21], v[58:61], v[128:131]
  v_mfma_f32_16x16x32_bf16 v[132:135], v[18:21], v[62:65], v[132:135]
  v_mfma_f32_16x16x32_bf16 v[136:139], v[18:21], v[66:69], v[136:139]
  v_mfma_f32_16x16x32_bf16 v[140:143], v[18:21], v[70:73], v[140:143]
  v_mfma_f32_16x16x32_bf16 v[144:147], v[22:25], v[58:61], v[144:147]
  s_add_u32 s72, s76, s79
  s_add_u32 s72, s72, 221184
  s_add_u32 s72, s72, s83
  s_add_u32 m0, s73, 8192
  s_nop 0
  buffer_load_dwordx4 v87, s[28:31], s72 offen lds
  v_mfma_f32_16x16x32_bf16 v[148:151], v[22:25], v[62:65], v[148:151]
  v_mfma_f32_16x16x32_bf16 v[152:155], v[22:25], v[66:69], v[152:155]
  s_add_u32 s72, s72, 18432
  s_add_u32 m0, s73, 9216
  s_nop 0
  buffer_load_dwordx4 v87, s[28:31], s72 offen lds
  v_mfma_f32_16x16x32_bf16 v[156:159], v[22:25], v[70:73], v[156:159]
  s_waitcnt lgkmcnt(0)
  s_waitcnt vmcnt(6)
  v_mfma_f32_16x16x32_bf16 v[160:163], v[26:29], v[58:61], v[160:163]
  ds_read_b128 v[42:45], v82 offset:24576
  v_mfma_f32_16x16x32_bf16 v[164:167], v[26:29], v[62:65], v[164:167]
  ds_read_b128 v[46:49], v82 offset:25600
  v_mfma_f32_16x16x32_bf16 v[168:171], v[26:29], v[66:69], v[168:171]
  ds_read_b128 v[50:53], v82 offset:26624
  v_mfma_f32_16x16x32_bf16 v[172:175], v[26:29], v[70:73], v[172:175]
  ds_read_b128 v[54:57], v82 offset:27648
  v_mfma_f32_16x16x32_bf16 v[176:179], v[30:33], v[58:61], v[176:179]
  ds_read_b64_tr_b16 v[10:11], v76 offset:0
  v_mfma_f32_16x16x32_bf16 v[180:183], v[30:33], v[62:65], v[180:183]
  ds_read_b64_tr_b16 v[12:13], v76 offset:2048
  v_mfma_f32_16x16x32_bf16 v[184:187], v[30:33], v[66:69], v[184:187]
  ds_read_b64_tr_b16 v[14:15], v77 offset:0
  v_mfma_f32_16x16x32_bf16 v[188:191], v[30:33], v[70:73], v[188:191]
  ds_read_b64_tr_b16 v[16:17], v77 offset:2048
  v_mfma_f32_16x16x32_bf16 v[192:195], v[34:37], v[58:61], v[192:195]
  s_add_u32 s72, s76, s78
  s_add_u32 s72, s72, 258048
  s_sub_u32 s72, s72, s83
  s_add_u32 m0, s73, 12288
  s_nop 0
  buffer_load_dwordx4 v74, s[28:31], s72 offen lds
  ds_read_b64_tr_b16 v[18:19], v78 offset:0
  v_mfma_f32_16x16x32_bf16 v[196:199], v[34:37], v[62:65], v[196:199]
  ds_read_b64_tr_b16 v[20:21], v78 offset:2048
  v_mfma_f32_16x16x32_bf16 v[200:203], v[34:37], v[66:69], v[200:203]
  s_add_u32 s72, s72, 9216
  s_add_u32 m0, s73, 13312
  s_nop 0
  buffer_load_dwordx4 v74, s[28:31], s72 offen lds
  ds_read_b64_tr_b16 v[22:23], v79 offset:0
  v_mfma_f32_16x16x32_bf16 v[204:207], v[34:37], v[70:73], v[204:207]
  ds_read_b64_tr_b16 v[24:25], v79 offset:2048
  v_mfma_f32_16x16x32_bf16 v[208:211], v[38:41], v[58:61], v[208:211]
  s_add_u32 s72, s72, 9216
  s_add_u32 m0, s73, 14336
  s_nop 0
  buffer_load_dwordx4 v74, s[28:31], s72 offen lds
  v_mfma_f32_16x16x32_bf16 v[212:215], v[38:41], v[62:65], v[212:215]
  v_mfma_f32_16x16x32_bf16 v[216:219], v[38:41], v[66:69], v[216:219]
  s_add_u32 s72, s72, 9216
  s_add_u32 m0, s73, 15360
  s_nop 0
  buffer_load_dwordx4 v74, s[28:31], s72 offen lds
  v_mfma_f32_16x16x32_bf16 v[220:223], v[38:41], v[70:73], v[220:223]
  s_waitcnt lgkmcnt(0)
  s_waitcnt vmcnt(6)
  v_mfma_f32_16x16x32_bf16 v[96:99], v[10:13], v[42:45], v[96:99]
  ds_read_b64_tr_b16 v[26:27], v76 offset:4096
  v_mfma_f32_16x16x32_bf16 v[100:103], v[10:13], v[46:49], v[100:103]
  ds_read_b64_tr_b16 v[28:29], v76 offset:6144
  v_mfma_f32_16x16x32_bf16 v[104:107], v[10:13], v[50:53], v[104:107]
  ds_read_b64_tr_b16 v[30:31], v77 offset:4096
  v_mfma_f32_16x16x32_bf16 v[108:111], v[10:13], v[54:57], v[108:111]
  ds_read_b64_tr_b16 v[32:33], v77 offset:6144
  v_mfma_f32_16x16x32_bf16 v[112:115], v[14:17], v[42:45], v[112:115]
  ds_read_b64_tr_b16 v[34:35], v78 offset:4096
  v_mfma_f32_16x16x32_bf16 v[116:119], v[14:17], v[46:49], v[116:119]
  ds_read_b64_tr_b16 v[36:37], v78 offset:6144
  v_mfma_f32_16x16x32_bf16 v[120:123], v[14:17], v[50:53], v[120:123]
  ds_read_b64_tr_b16 v[38:39], v79 offset:4096
  v_mfma_f32_16x16x32_bf16 v[124:127], v[14:17], v[54:57], v[124:127]
  ds_read_b64_tr_b16 v[40:41], v79 offset:6144
  v_mfma_f32_16x16x32_bf16 v[128:131], v[18:21], v[42:45], v[128:131]
  s_add_u32 s72, s76, s78
  s_add_u32 s72, s72, 258176
  s_sub_u32 s72, s72, s83
  s_add_u32 m0, s73, 0
  s_nop 0
  buffer_load_dwordx4 v74, s[28:31], s72 offen lds
  v_mfma_f32_16x16x32_bf16 v[132:135], v[18:21], v[46:49], v[132:135]
  v_mfma_f32_16x16x32_bf16 v[136:139], v[18:21], v[50:53], v[136:139]
  s_add_u32 s72, s72, 9216
  s_add_u32 m0, s73, 1024
  s_nop 0
  buffer_load_dwordx4 v74, s[28:31], s72 offen lds
  v_mfma_f32_16x16x32_bf16 v[140:143], v[18:21], v[54:57], v[140:143]
  v_mfma_f32_16x16x32_bf16 v[144:147], v[22:25], v[42:45], v[144:147]
  s_add_u32 s72, s72, 9216
  s_add_u32 m0, s73, 2048
  s_nop 0
  buffer_load_dwordx4 v74, s[28:31], s72 offen lds
  v_mfma_f32_16x16x32_bf16 v[148:151], v[22:25], v[46:49], v[148:151]
  v_mfma_f32_16x16x32_bf16 v[152:155], v[22:25], v[50:53], v[152:155]
  s_add_u32 s72, s72, 9216
  s_add_u32 m0, s73, 3072
  s_nop 0
  buffer_load_dwordx4 v74, s[28:31], s72 offen lds
  v_mfma_f32_16x16x32_bf16 v[156:159], v[22:25], v[54:57], v[156:159]
  s_waitcnt lgkmcnt(0)
  s_waitcnt vmcnt(8)
  v_mfma_f32_16x16x32_bf16 v[160:163], v[26:29], v[42:45], v[160:163]
  ds_read_b64_tr_b16 v[10:11], v80 offset:8192
  v_mfma_f32_16x16x32_bf16 v[164:167], v[26:29], v[46:49], v[164:167]
  ds_read_b64_tr_b16 v[12:13], v80 offset:9216
  v_mfma_f32_16x16x32_bf16 v[168:171], v[26:29], v[50:53], v[168:171]
  ds_read_b64_tr_b16 v[14:15], v81 offset:8192
  v_mfma_f32_16x16x32_bf16 v[172:175], v[26:29], v[54:57], v[172:175]
  ds_read_b64_tr_b16 v[16:17], v81 offset:9216
  v_mfma_f32_16x16x32_bf16 v[176:179], v[30:33], v[42:45], v[176:179]
  v_mfma_f32_16x16x32_bf16 v[180:183], v[30:33], v[46:49], v[180:183]
  v_mfma_f32_16x16x32_bf16 v[184:187], v[30:33], v[50:53], v[184:187]
  v_mfma_f32_16x16x32_bf16 v[188:191], v[30:33], v[54:57], v[188:191]
  v_mfma_f32_16x16x32_bf16 v[192:195], v[34:37], v[42:45], v[192:195]
  s_add_u32 s72, s76, s78
  s_add_u32 s72, s72, 294912
  s_add_u32 s72, s72, s83
  s_add_u32 m0, s73, 4096
  s_nop 0
  buffer_load_dwordx4 v74, s[28:31], s72 offen lds
  v_mfma_f32_16x16x32_bf16 v[196:199], v[34:37], v[46:49], v[196:199]
  v_mfma_f32_16x16x32_bf16 v[200:203], v[34:37], v[50:53], v[200:203]
  s_add_u32 s72, s72, 9216
  s_add_u32 m0, s73, 5120
  s_nop 0
  buffer_load_dwordx4 v74, s[28:31], s72 offen lds
  v_mfma_f32_16x16x32_bf16 v[204:207], v[34:37], v[54:57], v[204:207]
  v_mfma_f32_16x16x32_bf16 v[208:211], v[38:41], v[42:45], v[208:211]
  s_add_u32 s72, s72, 9216
  s_add_u32 m0, s73, 6144
  s_nop 0
  buffer_load_dwordx4 v74, s[28:31], s72 offen lds
  v_mfma_f32_16x16x32_bf16 v[212:215], v[38:41], v[46:49], v[212:215]
  v_mfma_f32_16x16x32_bf16 v[216:219], v[38:41], v[50:53], v[216:219]
  s_add_u32 s72, s72, 9216
  s_add_u32 m0, s73, 7168
  s_nop 0
  buffer_load_dwordx4 v74, s[28:31], s72 offen lds
  v_mfma_f32_16x16x32_bf16 v[220:223], v[38:41], v[54:57], v[220:223]
  s_waitcnt lgkmcnt(0)
  s_waitcnt vmcnt(8)
  v_mfma_f32_16x16x32_bf16 v[224:227], v[10:13], v[42:45], v[224:227]
  s_add_u32 s72, s76, s78
  s_add_u32 s72, s72, 295040
  s_add_u32 s72, s72, s83
  s_add_u32 m0, s73, 8192
  s_nop 0
  buffer_load_dwordx4 v74, s[28:31], s72 offen lds
  ds_read_b128 v[58:61], v83 offset:24576
  ds_read_b128 v[62:65], v83 offset:25600
  ds_read_b128 v[66:69], v83 offset:26624
  v_mfma_f32_16x16x32_bf16 v[228:231], v[10:13], v[46:49], v[228:231]
  ds_read_b128 v[70:73], v83 offset:27648
  ds_read_b64_tr_b16 v[26:27], v76 offset:12288
  ds_read_b64_tr_b16 v[28:29], v76 offset:14336
  v_mfma_f32_16x16x32_bf16 v[232:235], v[10:13], v[50:53], v[232:235]
  s_add_u32 s72, s72, 9216
  s_add_u32 m0, s73, 9216
  s_nop 0
  buffer_load_dwordx4 v74, s[28:31], s72 offen lds
  ds_read_b64_tr_b16 v[30:31], v77 offset:12288
  ds_read_b64_tr_b16 v[32:33], v77 offset:14336
  ds_read_b64_tr_b16 v[34:35], v78 offset:12288
  v_mfma_f32_16x16x32_bf16 v[236:239], v[10:13], v[54:57], v[236:239]
  ds_read_b64_tr_b16 v[36:37], v78 offset:14336
  ds_read_b64_tr_b16 v[38:39], v79 offset:12288
  ds_read_b64_tr_b16 v[40:41], v79 offset:14336
  v_mfma_f32_16x16x32_bf16 v[240:243], v[14:17], v[42:45], v[240:243]
  s_add_u32 s72, s72, 9216
  s_add_u32 m0, s73, 10240
  s_nop 0
  buffer_load_dwordx4 v74, s[28:31], s72 offen lds
  v_mfma_f32_16x16x32_bf16 v[244:247], v[14:17], v[46:49], v[244:247]
  v_mfma_f32_16x16x32_bf16 v[248:251], v[14:17], v[50:53], v[248:251]
  s_add_u32 s72, s72, 9216
  s_add_u32 m0, s73, 11264
  s_nop 0
  buffer_load_dwordx4 v74, s[28:31], s72 offen lds
  v_mfma_f32_16x16x32_bf16 v[252:255], v[14:17], v[54:57], v[252:255]
  s_waitcnt lgkmcnt(0)
  s_waitcnt vmcnt(8)
  v_mfma_f32_16x16x32_bf16 v[96:99], v[26:29], v[58:61], v[96:99]
  ds_read_b64_tr_b16 v[10:11], v76 offset:0
  v_mfma_f32_16x16x32_bf16 v[100:103], v[26:29], v[62:65], v[100:103]
  ds_read_b64_tr_b16 v[12:13], v76 offset:2048
  v_mfma_f32_16x16x32_bf16 v[104:107], v[26:29], v[66:69], v[104:107]
  ds_read_b64_tr_b16 v[14:15], v77 offset:0
  v_mfma_f32_16x16x32_bf16 v[108:111], v[26:29], v[70:73], v[108:111]
  ds_read_b64_tr_b16 v[16:17], v77 offset:2048
  v_mfma_f32_16x16x32_bf16 v[112:115], v[30:33], v[58:61], v[112:115]
  ds_read_b64_tr_b16 v[18:19], v78 offset:0
  v_mfma_f32_16x16x32_bf16 v[116:119], v[30:33], v[62:65], v[116:119]
  ds_read_b64_tr_b16 v[20:21], v78 offset:2048
  v_mfma_f32_16x16x32_bf16 v[120:123], v[30:33], v[66:69], v[120:123]
  ds_read_b64_tr_b16 v[22:23], v79 offset:0
  v_mfma_f32_16x16x32_bf16 v[124:127], v[30:33], v[70:73], v[124:127]
  ds_read_b64_tr_b16 v[24:25], v79 offset:2048
  v_mfma_f32_16x16x32_bf16 v[128:131], v[34:37], v[58:61], v[128:131]
  v_mfma_f32_16x16x32_bf16 v[132:135], v[34:37], v[62:65], v[132:135]
  v_mfma_f32_16x16x32_bf16 v[136:139], v[34:37], v[66:69], v[136:139]
  v_mfma_f32_16x16x32_bf16 v[140:143], v[34:37], v[70:73], v[140:143]
  v_mfma_f32_16x16x32_bf16 v[144:147], v[38:41], v[58:61], v[144:147]
  s_add_u32 s72, s76, s79
  s_add_u32 s72, s72, 294912
  s_add_u32 s72, s72, s83
  s_add_u32 m0, s73, 12288
  s_nop 0
  buffer_load_dwordx4 v87, s[28:31], s72 offen lds
  v_mfma_f32_16x16x32_bf16 v[148:151], v[38:41], v[62:65], v[148:151]
  v_mfma_f32_16x16x32_bf16 v[152:155], v[38:41], v[66:69], v[152:155]
  s_add_u32 s72, s72, 18432
  s_add_u32 m0, s73, 13312
  s_nop 0
  buffer_load_dwordx4 v87, s[28:31], s72 offen lds
  v_mfma_f32_16x16x32_bf16 v[156:159], v[38:41], v[70:73], v[156:159]
  s_waitcnt lgkmcnt(0)
  s_waitcnt vmcnt(6)
  v_add_u32 v82, 32768, v82
  v_mfma_f32_16x16x32_bf16 v[160:163], v[10:13], v[58:61], v[160:163]
  ds_read_b128 v[42:45], v82 offset:0
  v_mfma_f32_16x16x32_bf16 v[164:167], v[10:13], v[62:65], v[164:167]
  ds_read_b128 v[46:49], v82 offset:1024
  v_mfma_f32_16x16x32_bf16 v[168:171], v[10:13], v[66:69], v[168:171]
  ds_read_b128 v[50:53], v82 offset:2048
  v_mfma_f32_16x16x32_bf16 v[172:175], v[10:13], v[70:73], v[172:175]
  ds_read_b128 v[54:57], v82 offset:3072
  v_mfma_f32_16x16x32_bf16 v[176:179], v[14:17], v[58:61], v[176:179]
  ds_read_b64_tr_b16 v[26:27], v76 offset:4096
  v_mfma_f32_16x16x32_bf16 v[180:183], v[14:17], v[62:65], v[180:183]
  ds_read_b64_tr_b16 v[28:29], v76 offset:6144
  v_mfma_f32_16x16x32_bf16 v[184:187], v[14:17], v[66:69], v[184:187]
  ds_read_b64_tr_b16 v[30:31], v77 offset:4096
  v_mfma_f32_16x16x32_bf16 v[188:191], v[14:17], v[70:73], v[188:191]
  ds_read_b64_tr_b16 v[32:33], v77 offset:6144
  v_mfma_f32_16x16x32_bf16 v[192:195], v[18:21], v[58:61], v[192:195]
  s_add_u32 s72, s76, s78
  s_add_u32 s72, s72, 331776
  s_sub_u32 s72, s72, s83
  s_add_u32 m0, s73, 0
  s_nop 0
  buffer_load_dwordx4 v74, s[28:31], s72 offen lds
  ds_read_b64_tr_b16 v[34:35], v78 offset:4096
  v_mfma_f32_16x16x32_bf16 v[196:199], v[18:21], v[62:65], v[196:199]
  ds_read_b64_tr_b16 v[36:37], v78 offset:6144
  v_mfma_f32_16x16x32_bf16 v[200:203], v[18:21], v[66:69], v[200:203]
  s_add_u32 s72, s72, 9216
  s_add_u32 m0, s73, 1024
  s_nop 0
  buffer_load_dwordx4 v74, s[28:31], s72 offen lds
  ds_read_b64_tr_b16 v[38:39], v79 offset:4096
  v_mfma_f32_16x16x32_bf16 v[204:207], v[18:21], v[70:73], v[204:207]
  ds_read_b64_tr_b16 v[40:41], v79 offset:6144
  v_mfma_f32_16x16x32_bf16 v[208:211], v[22:25], v[58:61], v[208:211]
  s_add_u32 s72, s72, 9216
  s_add_u32 m0, s73, 2048
  s_nop 0
  buffer_load_dwordx4 v74, s[28:31], s72 offen lds
  v_mfma_f32_16x16x32_bf16 v[212:215], v[22:25], v[62:65], v[212:215]
  v_mfma_f32_16x16x32_bf16 v[216:219], v[22:25], v[66:69], v[216:219]
  s_add_u32 s72, s72, 9216
  s_add_u32 m0, s73, 3072
  s_nop 0
  buffer_load_dwordx4 v74, s[28:31], s72 offen lds
  v_mfma_f32_16x16x32_bf16 v[220:223], v[22:25], v[70:73], v[220:223]
  s_waitcnt lgkmcnt(0)
  s_waitcnt vmcnt(6)
  v_mfma_f32_16x16x32_bf16 v[96:99], v[26:29], v[42:45], v[96:99]
  ds_read_b64_tr_b16 v[10:11], v76 offset:8192
  v_mfma_f32_16x16x32_bf16 v[100:103], v[26:29], v[46:49], v[100:103]
  ds_read_b64_tr_b16 v[12:13], v76 offset:10240
  v_mfma_f32_16x16x32_bf16 v[104:107], v[26:29], v[50:53], v[104:107]
  ds_read_b64_tr_b16 v[14:15], v77 offset:8192
  v_mfma_f32_16x16x32_bf16 v[108:111], v[26:29], v[54:57], v[108:111]
  ds_read_b64_tr_b16 v[16:17], v77 offset:10240
  v_mfma_f32_16x16x32_bf16 v[112:115], v[30:33], v[42:45], v[112:115]
  ds_read_b64_tr_b16 v[18:19], v78 offset:8192
  v_mfma_f32_16x16x32_bf16 v[116:119], v[30:33], v[46:49], v[116:119]
  ds_read_b64_tr_b16 v[20:21], v78 offset:10240
  v_mfma_f32_16x16x32_bf16 v[120:123], v[30:33], v[50:53], v[120:123]
  ds_read_b64_tr_b16 v[22:23], v79 offset:8192
  v_mfma_f32_16x16x32_bf16 v[124:127], v[30:33], v[54:57], v[124:127]
  ds_read_b64_tr_b16 v[24:25], v79 offset:10240
  v_mfma_f32_16x16x32_bf16 v[128:131], v[34:37], v[42:45], v[128:131]
  s_add_u32 s72, s76, s78
  s_add_u32 s72, s72, 331904
  s_sub_u32 s72, s72, s83
  s_add_u32 m0, s73, 4096
  s_nop 0
  buffer_load_dwordx4 v74, s[28:31], s72 offen lds
  v_mfma_f32_16x16x32_bf16 v[132:135], v[34:37], v[46:49], v[132:135]
  v_mfma_f32_16x16x32_bf16 v[136:139], v[34:37], v[50:53], v[136:139]
  s_add_u32 s72, s72, 9216
  s_add_u32 m0, s73, 5120
  s_nop 0
  buffer_load_dwordx4 v74, s[28:31], s72 offen lds
  v_mfma_f32_16x16x32_bf16 v[140:143], v[34:37], v[54:57], v[140:143]
  v_mfma_f32_16x16x32_bf16 v[144:147], v[38:41], v[42:45], v[144:147]
  s_add_u32 s72, s72, 9216
  s_add_u32 m0, s73, 6144
  s_nop 0
  buffer_load_dwordx4 v74, s[28:31], s72 offen lds
  v_mfma_f32_16x16x32_bf16 v[148:151], v[38:41], v[46:49], v[148:151]
  v_mfma_f32_16x16x32_bf16 v[152:155], v[38:41], v[50:53], v[152:155]
  s_add_u32 s72, s72, 9216
  s_add_u32 m0, s73, 7168
  s_nop 0
  buffer_load_dwordx4 v74, s[28:31], s72 offen lds
  v_mfma_f32_16x16x32_bf16 v[156:159], v[38:41], v[54:57], v[156:159]
  s_waitcnt lgkmcnt(0)
  s_waitcnt vmcnt(8)
  v_mfma_f32_16x16x32_bf16 v[160:163], v[10:13], v[42:45], v[160:163]
  ds_read_b64_tr_b16 v[26:27], v80 offset:12288
  v_mfma_f32_16x16x32_bf16 v[164:167], v[10:13], v[46:49], v[164:167]
  ds_read_b64_tr_b16 v[28:29], v80 offset:13312
  v_mfma_f32_16x16x32_bf16 v[168:171], v[10:13], v[50:53], v[168:171]
  ds_read_b64_tr_b16 v[30:31], v81 offset:12288
  v_mfma_f32_16x16x32_bf16 v[172:175], v[10:13], v[54:57], v[172:175]
  ds_read_b64_tr_b16 v[32:33], v81 offset:13312
  v_mfma_f32_16x16x32_bf16 v[176:179], v[14:17], v[42:45], v[176:179]
  v_mfma_f32_16x16x32_bf16 v[180:183], v[14:17], v[46:49], v[180:183]
  v_mfma_f32_16x16x32_bf16 v[184:187], v[14:17], v[50:53], v[184:187]
  v_mfma_f32_16x16x32_bf16 v[188:191], v[14:17], v[54:57], v[188:191]
  v_mfma_f32_16x16x32_bf16 v[192:195], v[18:21], v[42:45], v[192:195]
  s_add_u32 s72, s76, s78
  s_add_u32 s72, s72, 368640
  s_add_u32 s72, s72, s83
  s_add_u32 m0, s73, 8192
  s_nop 0
  buffer_load_dwordx4 v74, s[28:31], s72 offen lds
  v_mfma_f32_16x16x32_bf16 v[196:199], v[18:21], v[46:49], v[196:199]
  v_mfma_f32_16x16x32_bf16 v[200:203], v[18:21], v[50:53], v[200:203]
  s_add_u32 s72, s72, 9216
  s_add_u32 m0, s73, 9216
  s_nop 0
  buffer_load_dwordx4 v74, s[28:31], s72 offen lds
  v_mfma_f32_16x16x32_bf16 v[204:207], v[18:21], v[54:57], v[204:207]
  v_mfma_f32_16x16x32_bf16 v[208:211], v[22:25], v[42:45], v[208:211]
  s_add_u32 s72, s72, 9216
  s_add_u32 m0, s73, 10240
  s_nop 0
  buffer_load_dwordx4 v74, s[28:31], s72 offen lds
  v_mfma_f32_16x16x32_bf16 v[212:215], v[22:25], v[46:49], v[212:215]
  v_mfma_f32_16x16x32_bf16 v[216:219], v[22:25], v[50:53], v[216:219]
  s_add_u32 s72, s72, 9216
  s_add_u32 m0, s73, 11264
  s_nop 0
  buffer_load_dwordx4 v74, s[28:31], s72 offen lds
  v_mfma_f32_16x16x32_bf16 v[220:223], v[22:25], v[54:57], v[220:223]
  s_waitcnt lgkmcnt(0)
  s_waitcnt vmcnt(8)
  v_add_u32 v83, 32768, v83
  v_mfma_f32_16x16x32_bf16 v[224:227], v[26:29], v[42:45], v[224:227]
  s_add_u32 s72, s76, s78
  s_add_u32 s72, s72, 368768
  s_add_u32 s72, s72, s83
  s_add_u32 m0, s73, 12288
  s_nop 0
  buffer_load_dwordx4 v74, s[28:31], s72 offen lds
  ds_read_b128 v[58:61], v83 offset:0
  ds_read_b128 v[62:65], v83 offset:1024
  ds_read_b128 v[66:69], v83 offset:2048
  v_mfma_f32_16x16x32_bf16 v[228:231], v[26:29], v[46:49], v[228:231]
  ds_read_b128 v[70:73], v83 offset:3072
  ds_read_b64_tr_b16 v[10:11], v76 offset:0
  ds_read_b64_tr_b16 v[12:13], v76 offset:2048
  v_mfma_f32_16x16x32_bf16 v[232:235], v[26:29], v[50:53], v[232:235]
  s_add_u32 s72, s72, 9216
  s_add_u32 m0, s73, 13312
  s_nop 0
  buffer_load_dwordx4 v74, s[28:31], s72 offen lds
  ds_read_b64_tr_b16 v[14:15], v77 offset:0
  ds_read_b64_tr_b16 v[16:17], v77 offset:2048
  ds_read_b64_tr_b16 v[18:19], v78 offset:0
  v_mfma_f32_16x16x32_bf16 v[236:239], v[26:29], v[54:57], v[236:239]
  ds_read_b64_tr_b16 v[20:21], v78 offset:2048
  ds_read_b64_tr_b16 v[22:23], v79 offset:0
  ds_read_b64_tr_b16 v[24:25], v79 offset:2048
  v_mfma_f32_16x16x32_bf16 v[240:243], v[30:33], v[42:45], v[240:243]
  s_add_u32 s72, s72, 9216
  s_add_u32 m0, s73, 14336
  s_nop 0
  buffer_load_dwordx4 v74, s[28:31], s72 offen lds
  v_mfma_f32_16x16x32_bf16 v[244:247], v[30:33], v[46:49], v[244:247]
  v_mfma_f32_16x16x32_bf16 v[248:251], v[30:33], v[50:53], v[248:251]
  s_add_u32 s72, s72, 9216
  s_add_u32 m0, s73, 15360
  s_nop 0
  buffer_load_dwordx4 v74, s[28:31], s72 offen lds
  v_mfma_f32_16x16x32_bf16 v[252:255], v[30:33], v[54:57], v[252:255]
  s_waitcnt lgkmcnt(0)
  s_waitcnt vmcnt(8)
  v_mfma_f32_16x16x32_bf16 v[96:99], v[10:13], v[58:61], v[96:99]
  ds_read_b64_tr_b16 v[26:27], v76 offset:4096
  v_mfma_f32_16x16x32_bf16 v[100:103], v[10:13], v[62:65], v[100:103]
  ds_read_b64_tr_b16 v[28:29], v76 offset:6144
  v_mfma_f32_16x16x32_bf16 v[104:107], v[10:13], v[66:69], v[104:107]
  ds_read_b64_tr_b16 v[30:31], v77 offset:4096
  v_mfma_f32_16x16x32_bf16 v[108:111], v[10:13], v[70:73], v[108:111]
  ds_read_b64_tr_b16 v[32:33], v77 offset:6144
  v_mfma_f32_16x16x32_bf16 v[112:115], v[14:17], v[58:61], v[112:115]
  ds_read_b64_tr_b16 v[34:35], v78 offset:4096
  v_mfma_f32_16x16x32_bf16 v[116:119], v[14:17], v[62:65], v[116:119]
  ds_read_b64_tr_b16 v[36:37], v78 offset:6144
  v_mfma_f32_16x16x32_bf16 v[120:123], v[14:17], v[66:69], v[120:123]
  ds_read_b64_tr_b16 v[38:39], v79 offset:4096
  v_mfma_f32_16x16x32_bf16 v[124:127], v[14:17], v[70:73], v[124:127]
  ds_read_b64_tr_b16 v[40:41], v79 offset:6144
  v_mfma_f32_16x16x32_bf16 v[128:131], v[18:21], v[58:61], v[128:131]
  v_mfma_f32_16x16x32_bf16 v[132:135], v[18:21], v[62:65], v[132:135]
  v_mfma_f32_16x16x32_bf16 v[136:139], v[18:21], v[66:69], v[136:139]
  v_mfma_f32_16x16x32_bf16 v[140:143], v[18:21], v[70:73], v[140:143]
  v_mfma_f32_16x16x32_bf16 v[144:147], v[22:25], v[58:61], v[144:147]
  s_add_u32 s72, s76, s79
  s_add_u32 s72, s72, 368640
  s_add_u32 s72, s72, s83
  s_add_u32 m0, s73, 0
  s_nop 0
  buffer_load_dwordx4 v87, s[28:31], s72 offen lds
  v_mfma_f32_16x16x32_bf16 v[148:151], v[22:25], v[62:65], v[148:151]
  v_mfma_f32_16x16x32_bf16 v[152:155], v[22:25], v[66:69], v[152:155]
  s_add_u32 s72, s72, 18432
  s_add_u32 m0, s73, 1024
  s_nop 0
  buffer_load_dwordx4 v87, s[28:31], s72 offen lds
  v_mfma_f32_16x16x32_bf16 v[156:159], v[22:25], v[70:73], v[156:159]
  s_waitcnt lgkmcnt(0)
  s_waitcnt vmcnt(6)
  v_mfma_f32_16x16x32_bf16 v[160:163], v[26:29], v[58:61], v[160:163]
  ds_read_b128 v[42:45], v82 offset:8192
  v_mfma_f32_16x16x32_bf16 v[164:167], v[26:29], v[62:65], v[164:167]
  ds_read_b128 v[46:49], v82 offset:9216
  v_mfma_f32_16x16x32_bf16 v[168:171], v[26:29], v[66:69], v[168:171]
  ds_read_b128 v[50:53], v82 offset:10240
  v_mfma_f32_16x16x32_bf16 v[172:175], v[26:29], v[70:73], v[172:175]
  ds_read_b128 v[54:57], v82 offset:11264
  v_mfma_f32_16x16x32_bf16 v[176:179], v[30:33], v[58:61], v[176:179]
  ds_read_b64_tr_b16 v[10:11], v76 offset:8192
  v_mfma_f32_16x16x32_bf16 v[180:183], v[30:33], v[62:65], v[180:183]
  ds_read_b64_tr_b16 v[12:13], v76 offset:10240
  v_mfma_f32_16x16x32_bf16 v[184:187], v[30:33], v[66:69], v[184:187]
  ds_read_b64_tr_b16 v[14:15], v77 offset:8192
  v_mfma_f32_16x16x32_bf16 v[188:191], v[30:33], v[70:73], v[188:191]
  ds_read_b64_tr_b16 v[16:17], v77 offset:10240
  v_mfma_f32_16x16x32_bf16 v[192:195], v[34:37], v[58:61], v[192:195]
  s_add_u32 s72, s76, s78
  s_add_u32 s72, s72, 405504
  s_sub_u32 s72, s72, s83
  s_add_u32 m0, s73, 4096
  s_nop 0
  buffer_load_dwordx4 v74, s[28:31], s72 offen lds
  ds_read_b64_tr_b16 v[18:19], v78 offset:8192
  v_mfma_f32_16x16x32_bf16 v[196:199], v[34:37], v[62:65], v[196:199]
  ds_read_b64_tr_b16 v[20:21], v78 offset:10240
  v_mfma_f32_16x16x32_bf16 v[200:203], v[34:37], v[66:69], v[200:203]
  s_add_u32 s72, s72, 9216
  s_add_u32 m0, s73, 5120
  s_nop 0
  buffer_load_dwordx4 v74, s[28:31], s72 offen lds
  ds_read_b64_tr_b16 v[22:23], v79 offset:8192
  v_mfma_f32_16x16x32_bf16 v[204:207], v[34:37], v[70:73], v[204:207]
  ds_read_b64_tr_b16 v[24:25], v79 offset:10240
  v_mfma_f32_16x16x32_bf16 v[208:211], v[38:41], v[58:61], v[208:211]
  s_add_u32 s72, s72, 9216
  s_add_u32 m0, s73, 6144
  s_nop 0
  buffer_load_dwordx4 v74, s[28:31], s72 offen lds
  v_mfma_f32_16x16x32_bf16 v[212:215], v[38:41], v[62:65], v[212:215]
  v_mfma_f32_16x16x32_bf16 v[216:219], v[38:41], v[66:69], v[216:219]
  s_add_u32 s72, s72, 9216
  s_add_u32 m0, s73, 7168
  s_nop 0
  buffer_load_dwordx4 v74, s[28:31], s72 offen lds
  v_mfma_f32_16x16x32_bf16 v[220:223], v[38:41], v[70:73], v[220:223]
  s_waitcnt lgkmcnt(0)
  s_waitcnt vmcnt(6)
  v_mfma_f32_16x16x32_bf16 v[96:99], v[10:13], v[42:45], v[96:99]
  ds_read_b64_tr_b16 v[26:27], v76 offset:12288
  v_mfma_f32_16x16x32_bf16 v[100:103], v[10:13], v[46:49], v[100:103]
  ds_read_b64_tr_b16 v[28:29], v76 offset:14336
  v_mfma_f32_16x16x32_bf16 v[104:107], v[10:13], v[50:53], v[104:107]
  ds_read_b64_tr_b16 v[30:31], v77 offset:12288
  v_mfma_f32_16x16x32_bf16 v[108:111], v[10:13], v[54:57], v[108:111]
  ds_read_b64_tr_b16 v[32:33], v77 offset:14336
  v_mfma_f32_16x16x32_bf16 v[112:115], v[14:17], v[42:45], v[112:115]
  ds_read_b64_tr_b16 v[34:35], v78 offset:12288
  v_mfma_f32_16x16x32_bf16 v[116:119], v[14:17], v[46:49], v[116:119]
  ds_read_b64_tr_b16 v[36:37], v78 offset:14336
  v_mfma_f32_16x16x32_bf16 v[120:123], v[14:17], v[50:53], v[120:123]
  ds_read_b64_tr_b16 v[38:39], v79 offset:12288
  v_mfma_f32_16x16x32_bf16 v[124:127], v[14:17], v[54:57], v[124:127]
  ds_read_b64_tr_b16 v[40:41], v79 offset:14336
  v_mfma_f32_16x16x32_bf16 v[128:131], v[18:21], v[42:45], v[128:131]
  s_add_u32 s72, s76, s78
  s_add_u32 s72, s72, 405632
  s_sub_u32 s72, s72, s83
  s_add_u32 m0, s73, 8192
  s_nop 0
  buffer_load_dwordx4 v74, s[28:31], s72 offen lds
  v_mfma_f32_16x16x32_bf16 v[132:135], v[18:21], v[46:49], v[132:135]
  v_mfma_f32_16x16x32_bf16 v[136:139], v[18:21], v[50:53], v[136:139]
  s_add_u32 s72, s72, 9216
  s_add_u32 m0, s73, 9216
  s_nop 0
  buffer_load_dwordx4 v74, s[28:31], s72 offen lds
  v_mfma_f32_16x16x32_bf16 v[140:143], v[18:21], v[54:57], v[140:143]
  v_mfma_f32_16x16x32_bf16 v[144:147], v[22:25], v[42:45], v[144:147]
  s_add_u32 s72, s72, 9216
  s_add_u32 m0, s73, 10240
  s_nop 0
  buffer_load_dwordx4 v74, s[28:31], s72 offen lds
  v_mfma_f32_16x16x32_bf16 v[148:151], v[22:25], v[46:49], v[148:151]
  v_mfma_f32_16x16x32_bf16 v[152:155], v[22:25], v[50:53], v[152:155]
  s_add_u32 s72, s72, 9216
  s_add_u32 m0, s73, 11264
  s_nop 0
  buffer_load_dwordx4 v74, s[28:31], s72 offen lds
  v_mfma_f32_16x16x32_bf16 v[156:159], v[22:25], v[54:57], v[156:159]
  s_waitcnt lgkmcnt(0)
  s_waitcnt vmcnt(8)
  v_mfma_f32_16x16x32_bf16 v[160:163], v[26:29], v[42:45], v[160:163]
  ds_read_b64_tr_b16 v[10:11], v80 offset:0
  v_mfma_f32_16x16x32_bf16 v[164:167], v[26:29], v[46:49], v[164:167]
  ds_read_b64_tr_b16 v[12:13], v80 offset:1024
  v_mfma_f32_16x16x32_bf16 v[168:171], v[26:29], v[50:53], v[168:171]
  ds_read_b64_tr_b16 v[14:15], v81 offset:0
  v_mfma_f32_16x16x32_bf16 v[172:175], v[26:29], v[54:57], v[172:175]
  ds_read_b64_tr_b16 v[16:17], v81 offset:1024
  v_mfma_f32_16x16x32_bf16 v[176:179], v[30:33], v[42:45], v[176:179]
  v_mfma_f32_16x16x32_bf16 v[180:183], v[30:33], v[46:49], v[180:183]
  v_mfma_f32_16x16x32_bf16 v[184:187], v[30:33], v[50:53], v[184:187]
  v_mfma_f32_16x16x32_bf16 v[188:191], v[30:33], v[54:57], v[188:191]
  v_mfma_f32_16x16x32_bf16 v[192:195], v[34:37], v[42:45], v[192:195]
  s_add_u32 s72, s76, s78
  s_add_u32 s72, s72, 442368
  s_add_u32 s72, s72, s83
  s_add_u32 m0, s73, 12288
  s_nop 0
  buffer_load_dwordx4 v74, s[28:31], s72 offen lds
  v_mfma_f32_16x16x32_bf16 v[196:199], v[34:37], v[46:49], v[196:199]
  v_mfma_f32_16x16x32_bf16 v[200:203], v[34:37], v[50:53], v[200:203]
  s_add_u32 s72, s72, 9216
  s_add_u32 m0, s73, 13312
  s_nop 0
  buffer_load_dwordx4 v74, s[28:31], s72 offen lds
  v_mfma_f32_16x16x32_bf16 v[204:207], v[34:37], v[54:57], v[204:207]
  v_mfma_f32_16x16x32_bf16 v[208:211], v[38:41], v[42:45], v[208:211]
  s_add_u32 s72, s72, 9216
  s_add_u32 m0, s73, 14336
  s_nop 0
  buffer_load_dwordx4 v74, s[28:31], s72 offen lds
  v_mfma_f32_16x16x32_bf16 v[212:215], v[38:41], v[46:49], v[212:215]
  v_mfma_f32_16x16x32_bf16 v[216:219], v[38:41], v[50:53], v[216:219]
  s_add_u32 s72, s72, 9216
  s_add_u32 m0, s73, 15360
  s_nop 0
  buffer_load_dwordx4 v74, s[28:31], s72 offen lds
  v_mfma_f32_16x16x32_bf16 v[220:223], v[38:41], v[54:57], v[220:223]
  s_waitcnt lgkmcnt(0)
  s_waitcnt vmcnt(8)
  v_mfma_f32_16x16x32_bf16 v[224:227], v[10:13], v[42:45], v[224:227]
  s_add_u32 s72, s76, s78
  s_add_u32 s72, s72, 442496
  s_add_u32 s72, s72, s83
  s_add_u32 m0, s73, 0
  s_nop 0
  buffer_load_dwordx4 v74, s[28:31], s72 offen lds
  ds_read_b128 v[58:61], v83 offset:8192
  ds_read_b128 v[62:65], v83 offset:9216
  ds_read_b128 v[66:69], v83 offset:10240
  v_mfma_f32_16x16x32_bf16 v[228:231], v[10:13], v[46:49], v[228:231]
  ds_read_b128 v[70:73], v83 offset:11264
  ds_read_b64_tr_b16 v[26:27], v76 offset:4096
  ds_read_b64_tr_b16 v[28:29], v76 offset:6144
  v_mfma_f32_16x16x32_bf16 v[232:235], v[10:13], v[50:53], v[232:235]
  s_add_u32 s72, s72, 9216
  s_add_u32 m0, s73, 1024
  s_nop 0
  buffer_load_dwordx4 v74, s[28:31], s72 offen lds
  ds_read_b64_tr_b16 v[30:31], v77 offset:4096
  ds_read_b64_tr_b16 v[32:33], v77 offset:6144
  ds_read_b64_tr_b16 v[34:35], v78 offset:4096
  v_mfma_f32_16x16x32_bf16 v[236:239], v[10:13], v[54:57], v[236:239]
  ds_read_b64_tr_b16 v[36:37], v78 offset:6144
  ds_read_b64_tr_b16 v[38:39], v79 offset:4096
  ds_read_b64_tr_b16 v[40:41], v79 offset:6144
  v_mfma_f32_16x16x32_bf16 v[240:243], v[14:17], v[42:45], v[240:243]
  s_add_u32 s72, s72, 9216
  s_add_u32 m0, s73, 2048
  s_nop 0
  buffer_load_dwordx4 v74, s[28:31], s72 offen lds
  v_mfma_f32_16x16x32_bf16 v[244:247], v[14:17], v[46:49], v[244:247]
  v_mfma_f32_16x16x32_bf16 v[248:251], v[14:17], v[50:53], v[248:251]
  s_add_u32 s72, s72, 9216
  s_add_u32 m0, s73, 3072
  s_nop 0
  buffer_load_dwordx4 v74, s[28:31], s72 offen lds
  v_mfma_f32_16x16x32_bf16 v[252:255], v[14:17], v[54:57], v[252:255]
  s_waitcnt lgkmcnt(0)
  s_waitcnt vmcnt(8)
  v_mfma_f32_16x16x32_bf16 v[96:99], v[26:29], v[58:61], v[96:99]
  ds_read_b64_tr_b16 v[10:11], v76 offset:8192
  v_mfma_f32_16x16x32_bf16 v[100:103], v[26:29], v[62:65], v[100:103]
  ds_read_b64_tr_b16 v[12:13], v76 offset:10240
  v_mfma_f32_16x16x32_bf16 v[104:107], v[26:29], v[66:69], v[104:107]
  ds_read_b64_tr_b16 v[14:15], v77 offset:8192
  v_mfma_f32_16x16x32_bf16 v[108:111], v[26:29], v[70:73], v[108:111]
  ds_read_b64_tr_b16 v[16:17], v77 offset:10240
  v_mfma_f32_16x16x32_bf16 v[112:115], v[30:33], v[58:61], v[112:115]
  ds_read_b64_tr_b16 v[18:19], v78 offset:8192
  v_mfma_f32_16x16x32_bf16 v[116:119], v[30:33], v[62:65], v[116:119]
  ds_read_b64_tr_b16 v[20:21], v78 offset:10240
  v_mfma_f32_16x16x32_bf16 v[120:123], v[30:33], v[66:69], v[120:123]
  ds_read_b64_tr_b16 v[22:23], v79 offset:8192
  v_mfma_f32_16x16x32_bf16 v[124:127], v[30:33], v[70:73], v[124:127]
  ds_read_b64_tr_b16 v[24:25], v79 offset:10240
  v_mfma_f32_16x16x32_bf16 v[128:131], v[34:37], v[58:61], v[128:131]
  v_mfma_f32_16x16x32_bf16 v[132:135], v[34:37], v[62:65], v[132:135]
  v_mfma_f32_16x16x32_bf16 v[136:139], v[34:37], v[66:69], v[136:139]
  v_mfma_f32_16x16x32_bf16 v[140:143], v[34:37], v[70:73], v[140:143]
  v_mfma_f32_16x16x32_bf16 v[144:147], v[38:41], v[58:61], v[144:147]
  s_add_u32 s72, s76, s79
  s_add_u32 s72, s72, 442368
  s_add_u32 s72, s72, s83
  s_add_u32 m0, s73, 4096
  s_nop 0
  buffer_load_dwordx4 v87, s[28:31], s72 offen lds
  v_mfma_f32_16x16x32_bf16 v[148:151], v[38:41], v[62:65], v[148:151]
  v_mfma_f32_16x16x32_bf16 v[152:155], v[38:41], v[66:69], v[152:155]
  s_add_u32 s72, s72, 18432
  s_add_u32 m0, s73, 5120
  s_nop 0
  buffer_load_dwordx4 v87, s[28:31], s72 offen lds
  v_mfma_f32_16x16x32_bf16 v[156:159], v[38:41], v[70:73], v[156:159]
  s_waitcnt lgkmcnt(0)
  s_waitcnt vmcnt(6)
  v_mfma_f32_16x16x32_bf16 v[160:163], v[10:13], v[58:61], v[160:163]
  ds_read_b128 v[42:45], v82 offset:16384
  v_mfma_f32_16x16x32_bf16 v[164:167], v[10:13], v[62:65], v[164:167]
  ds_read_b128 v[46:49], v82 offset:17408
  v_mfma_f32_16x16x32_bf16 v[168:171], v[10:13], v[66:69], v[168:171]
  ds_read_b128 v[50:53], v82 offset:18432
  v_mfma_f32_16x16x32_bf16 v[172:175], v[10:13], v[70:73], v[172:175]
  ds_read_b128 v[54:57], v82 offset:19456
  v_mfma_f32_16x16x32_bf16 v[176:179], v[14:17], v[58:61], v[176:179]
  ds_read_b64_tr_b16 v[26:27], v76 offset:12288
  v_mfma_f32_16x16x32_bf16 v[180:183], v[14:17], v[62:65], v[180:183]
  ds_read_b64_tr_b16 v[28:29], v76 offset:14336
  v_mfma_f32_16x16x32_bf16 v[184:187], v[14:17], v[66:69], v[184:187]
  ds_read_b64_tr_b16 v[30:31], v77 offset:12288
  v_mfma_f32_16x16x32_bf16 v[188:191], v[14:17], v[70:73], v[188:191]
  ds_read_b64_tr_b16 v[32:33], v77 offset:14336
  v_mfma_f32_16x16x32_bf16 v[192:195], v[18:21], v[58:61], v[192:195]
  s_add_u32 s72, s76, s78
  s_add_u32 s72, s72, 479232
  s_sub_u32 s72, s72, s83
  s_add_u32 m0, s73, 8192
  s_nop 0
  buffer_load_dwordx4 v74, s[28:31], s72 offen lds
  ds_read_b64_tr_b16 v[34:35], v78 offset:12288
  v_mfma_f32_16x16x32_bf16 v[196:199], v[18:21], v[62:65], v[196:199]
  ds_read_b64_tr_b16 v[36:37], v78 offset:14336
  v_mfma_f32_16x16x32_bf16 v[200:203], v[18:21], v[66:69], v[200:203]
  s_add_u32 s72, s72, 9216
  s_add_u32 m0, s73, 9216
  s_nop 0
  buffer_load_dwordx4 v74, s[28:31], s72 offen lds
  ds_read_b64_tr_b16 v[38:39], v79 offset:12288
  v_mfma_f32_16x16x32_bf16 v[204:207], v[18:21], v[70:73], v[204:207]
  ds_read_b64_tr_b16 v[40:41], v79 offset:14336
  v_mfma_f32_16x16x32_bf16 v[208:211], v[22:25], v[58:61], v[208:211]
  s_add_u32 s72, s72, 9216
  s_add_u32 m0, s73, 10240
  s_nop 0
  buffer_load_dwordx4 v74, s[28:31], s72 offen lds
  v_mfma_f32_16x16x32_bf16 v[212:215], v[22:25], v[62:65], v[212:215]
  v_mfma_f32_16x16x32_bf16 v[216:219], v[22:25], v[66:69], v[216:219]
  s_add_u32 s72, s72, 9216
  s_add_u32 m0, s73, 11264
  s_nop 0
  buffer_load_dwordx4 v74, s[28:31], s72 offen lds
  v_mfma_f32_16x16x32_bf16 v[220:223], v[22:25], v[70:73], v[220:223]
  s_waitcnt lgkmcnt(0)
  s_waitcnt vmcnt(6)
  s_lshl_b32 s6, s4, 2
  s_add_u32 s6, s6, 128
  v_mov_b32 v1, 0
  buffer_load_dword v2, v1, s[40:43], s6 offen
  v_mfma_f32_16x16x32_bf16 v[96:99], v[26:29], v[42:45], v[96:99]
  ds_read_b64_tr_b16 v[10:11], v76 offset:0
  v_mfma_f32_16x16x32_bf16 v[100:103], v[26:29], v[46:49], v[100:103]
  ds_read_b64_tr_b16 v[12:13], v76 offset:2048
  v_mfma_f32_16x16x32_bf16 v[104:107], v[26:29], v[50:53], v[104:107]
  ds_read_b64_tr_b16 v[14:15], v77 offset:0
  v_mfma_f32_16x16x32_bf16 v[108:111], v[26:29], v[54:57], v[108:111]
  ds_read_b64_tr_b16 v[16:17], v77 offset:2048
  v_mfma_f32_16x16x32_bf16 v[112:115], v[30:33], v[42:45], v[112:115]
  ds_read_b64_tr_b16 v[18:19], v78 offset:0
  v_mfma_f32_16x16x32_bf16 v[116:119], v[30:33], v[46:49], v[116:119]
  ds_read_b64_tr_b16 v[20:21], v78 offset:2048
  v_mfma_f32_16x16x32_bf16 v[120:123], v[30:33], v[50:53], v[120:123]
  ds_read_b64_tr_b16 v[22:23], v79 offset:0
  v_mfma_f32_16x16x32_bf16 v[124:127], v[30:33], v[54:57], v[124:127]
  ds_read_b64_tr_b16 v[24:25], v79 offset:2048
  v_mfma_f32_16x16x32_bf16 v[128:131], v[34:37], v[42:45], v[128:131]
  s_add_u32 s72, s76, s78
  s_add_u32 s72, s72, 479360
  s_sub_u32 s72, s72, s83
  s_add_u32 m0, s73, 12288
  s_nop 0
  buffer_load_dwordx4 v74, s[28:31], s72 offen lds
  v_mfma_f32_16x16x32_bf16 v[132:135], v[34:37], v[46:49], v[132:135]
  v_mfma_f32_16x16x32_bf16 v[136:139], v[34:37], v[50:53], v[136:139]
  s_add_u32 s72, s72, 9216
  s_add_u32 m0, s73, 13312
  s_nop 0
  buffer_load_dwordx4 v74, s[28:31], s72 offen lds
  v_mfma_f32_16x16x32_bf16 v[140:143], v[34:37], v[54:57], v[140:143]
  v_mfma_f32_16x16x32_bf16 v[144:147], v[38:41], v[42:45], v[144:147]
  s_add_u32 s72, s72, 9216
  s_add_u32 m0, s73, 14336
  s_nop 0
  buffer_load_dwordx4 v74, s[28:31], s72 offen lds
  v_mfma_f32_16x16x32_bf16 v[148:151], v[38:41], v[46:49], v[148:151]
  v_mfma_f32_16x16x32_bf16 v[152:155], v[38:41], v[50:53], v[152:155]
  s_add_u32 s72, s72, 9216
  s_add_u32 m0, s73, 15360
  s_nop 0
  buffer_load_dwordx4 v74, s[28:31], s72 offen lds
  v_mfma_f32_16x16x32_bf16 v[156:159], v[38:41], v[54:57], v[156:159]
  s_waitcnt lgkmcnt(0)
  s_waitcnt vmcnt(9)
  v_mfma_f32_16x16x32_bf16 v[160:163], v[10:13], v[42:45], v[160:163]
  ds_read_b64_tr_b16 v[26:27], v80 offset:4096
  v_mfma_f32_16x16x32_bf16 v[164:167], v[10:13], v[46:49], v[164:167]
  ds_read_b64_tr_b16 v[28:29], v80 offset:5120
  v_mfma_f32_16x16x32_bf16 v[168:171], v[10:13], v[50:53], v[168:171]
  ds_read_b64_tr_b16 v[30:31], v81 offset:4096
  v_mfma_f32_16x16x32_bf16 v[172:175], v[10:13], v[54:57], v[172:175]
  ds_read_b64_tr_b16 v[32:33], v81 offset:5120
  v_mfma_f32_16x16x32_bf16 v[176:179], v[14:17], v[42:45], v[176:179]
  v_mfma_f32_16x16x32_bf16 v[180:183], v[14:17], v[46:49], v[180:183]
  v_mfma_f32_16x16x32_bf16 v[184:187], v[14:17], v[50:53], v[184:187]
  v_mfma_f32_16x16x32_bf16 v[188:191], v[14:17], v[54:57], v[188:191]
  v_mfma_f32_16x16x32_bf16 v[192:195], v[18:21], v[42:45], v[192:195]
  s_add_u32 s72, s76, s78
  s_add_u32 s72, s72, 516096
  s_add_u32 s72, s72, s83
  s_add_u32 m0, s73, 0
  s_nop 0
  buffer_load_dwordx4 v74, s[28:31], s72 offen lds
  v_mfma_f32_16x16x32_bf16 v[196:199], v[18:21], v[46:49], v[196:199]
  v_mfma_f32_16x16x32_bf16 v[200:203], v[18:21], v[50:53], v[200:203]
  s_add_u32 s72, s72, 9216
  s_add_u32 m0, s73, 1024
  s_nop 0
  buffer_load_dwordx4 v74, s[28:31], s72 offen lds
  v_mfma_f32_16x16x32_bf16 v[204:207], v[18:21], v[54:57], v[204:207]
  v_mfma_f32_16x16x32_bf16 v[208:211], v[22:25], v[42:45], v[208:211]
  s_add_u32 s72, s72, 9216
  s_add_u32 m0, s73, 2048
  s_nop 0
  buffer_load_dwordx4 v74, s[28:31], s72 offen lds
  v_mfma_f32_16x16x32_bf16 v[212:215], v[22:25], v[46:49], v[212:215]
  v_mfma_f32_16x16x32_bf16 v[216:219], v[22:25], v[50:53], v[216:219]
  s_add_u32 s72, s72, 9216
  s_add_u32 m0, s73, 3072
  s_nop 0
  buffer_load_dwordx4 v74, s[28:31], s72 offen lds
  v_mfma_f32_16x16x32_bf16 v[220:223], v[22:25], v[54:57], v[220:223]
  s_waitcnt lgkmcnt(0)
  s_waitcnt vmcnt(9)
  v_mfma_f32_16x16x32_bf16 v[224:227], v[26:29], v[42:45], v[224:227]
  s_add_u32 s72, s76, s78
  s_add_u32 s72, s72, 516224
  s_add_u32 s72, s72, s83
  s_add_u32 m0, s73, 4096
  s_nop 0
  buffer_load_dwordx4 v74, s[28:31], s72 offen lds
  ds_read_b128 v[58:61], v83 offset:16384
  ds_read_b128 v[62:65], v83 offset:17408
  ds_read_b128 v[66:69], v83 offset:18432
  v_mfma_f32_16x16x32_bf16 v[228:231], v[26:29], v[46:49], v[228:231]
  ds_read_b128 v[70:73], v83 offset:19456
  ds_read_b64_tr_b16 v[10:11], v76 offset:8192
  ds_read_b64_tr_b16 v[12:13], v76 offset:10240
  v_mfma_f32_16x16x32_bf16 v[232:235], v[26:29], v[50:53], v[232:235]
  s_add_u32 s72, s72, 9216
  s_add_u32 m0, s73, 5120
  s_nop 0
  buffer_load_dwordx4 v74, s[28:31], s72 offen lds
  ds_read_b64_tr_b16 v[14:15], v77 offset:8192
  ds_read_b64_tr_b16 v[16:17], v77 offset:10240
  ds_read_b64_tr_b16 v[18:19], v78 offset:8192
  v_mfma_f32_16x16x32_bf16 v[236:239], v[26:29], v[54:57], v[236:239]
  ds_read_b64_tr_b16 v[20:21], v78 offset:10240
  ds_read_b64_tr_b16 v[22:23], v79 offset:8192
  ds_read_b64_tr_b16 v[24:25], v79 offset:10240
  v_mfma_f32_16x16x32_bf16 v[240:243], v[30:33], v[42:45], v[240:243]
  s_add_u32 s72, s72, 9216
  s_add_u32 m0, s73, 6144
  s_nop 0
  buffer_load_dwordx4 v74, s[28:31], s72 offen lds
  v_mfma_f32_16x16x32_bf16 v[244:247], v[30:33], v[46:49], v[244:247]
  v_mfma_f32_16x16x32_bf16 v[248:251], v[30:33], v[50:53], v[248:251]
  s_add_u32 s72, s72, 9216
  s_add_u32 m0, s73, 7168
  s_nop 0
  buffer_load_dwordx4 v74, s[28:31], s72 offen lds
  v_mfma_f32_16x16x32_bf16 v[252:255], v[30:33], v[54:57], v[252:255]
  s_waitcnt lgkmcnt(0)
  s_waitcnt vmcnt(8)
  v_mfma_f32_16x16x32_bf16 v[96:99], v[10:13], v[58:61], v[96:99]
  ds_read_b64_tr_b16 v[26:27], v76 offset:12288
  v_mfma_f32_16x16x32_bf16 v[100:103], v[10:13], v[62:65], v[100:103]
  ds_read_b64_tr_b16 v[28:29], v76 offset:14336
  v_mfma_f32_16x16x32_bf16 v[104:107], v[10:13], v[66:69], v[104:107]
  ds_read_b64_tr_b16 v[30:31], v77 offset:12288
  v_mfma_f32_16x16x32_bf16 v[108:111], v[10:13], v[70:73], v[108:111]
  ds_read_b64_tr_b16 v[32:33], v77 offset:14336
  v_mfma_f32_16x16x32_bf16 v[112:115], v[14:17], v[58:61], v[112:115]
  ds_read_b64_tr_b16 v[34:35], v78 offset:12288
  v_mfma_f32_16x16x32_bf16 v[116:119], v[14:17], v[62:65], v[116:119]
  ds_read_b64_tr_b16 v[36:37], v78 offset:14336
  v_mfma_f32_16x16x32_bf16 v[120:123], v[14:17], v[66:69], v[120:123]
  ds_read_b64_tr_b16 v[38:39], v79 offset:12288
  v_mfma_f32_16x16x32_bf16 v[124:127], v[14:17], v[70:73], v[124:127]
  ds_read_b64_tr_b16 v[40:41], v79 offset:14336
  v_mfma_f32_16x16x32_bf16 v[128:131], v[18:21], v[58:61], v[128:131]
  v_mfma_f32_16x16x32_bf16 v[132:135], v[18:21], v[62:65], v[132:135]
  v_mfma_f32_16x16x32_bf16 v[136:139], v[18:21], v[66:69], v[136:139]
  v_mfma_f32_16x16x32_bf16 v[140:143], v[18:21], v[70:73], v[140:143]
  v_mfma_f32_16x16x32_bf16 v[144:147], v[22:25], v[58:61], v[144:147]
  s_add_u32 s72, s76, s79
  s_add_u32 s72, s72, 516096
  s_add_u32 s72, s72, s83
  s_add_u32 m0, s73, 8192
  s_nop 0
  buffer_load_dwordx4 v87, s[28:31], s72 offen lds
  v_mfma_f32_16x16x32_bf16 v[148:151], v[22:25], v[62:65], v[148:151]
  v_mfma_f32_16x16x32_bf16 v[152:155], v[22:25], v[66:69], v[152:155]
  s_add_u32 s72, s72, 18432
  s_add_u32 m0, s73, 9216
  s_nop 0
  buffer_load_dwordx4 v87, s[28:31], s72 offen lds
  v_mfma_f32_16x16x32_bf16 v[156:159], v[22:25], v[70:73], v[156:159]
  s_waitcnt lgkmcnt(0)
  s_waitcnt vmcnt(6)
  v_mfma_f32_16x16x32_bf16 v[160:163], v[26:29], v[58:61], v[160:163]
  ds_read_b128 v[42:45], v82 offset:24576
  v_mfma_f32_16x16x32_bf16 v[164:167], v[26:29], v[62:65], v[164:167]
  ds_read_b128 v[46:49], v82 offset:25600
  v_mfma_f32_16x16x32_bf16 v[168:171], v[26:29], v[66:69], v[168:171]
  ds_read_b128 v[50:53], v82 offset:26624
  v_mfma_f32_16x16x32_bf16 v[172:175], v[26:29], v[70:73], v[172:175]
  ds_read_b128 v[54:57], v82 offset:27648
  v_mfma_f32_16x16x32_bf16 v[176:179], v[30:33], v[58:61], v[176:179]
  ds_read_b64_tr_b16 v[10:11], v76 offset:0
  v_mfma_f32_16x16x32_bf16 v[180:183], v[30:33], v[62:65], v[180:183]
  ds_read_b64_tr_b16 v[12:13], v76 offset:2048
  v_mfma_f32_16x16x32_bf16 v[184:187], v[30:33], v[66:69], v[184:187]
  ds_read_b64_tr_b16 v[14:15], v77 offset:0
  v_mfma_f32_16x16x32_bf16 v[188:191], v[30:33], v[70:73], v[188:191]
  ds_read_b64_tr_b16 v[16:17], v77 offset:2048
  v_mfma_f32_16x16x32_bf16 v[192:195], v[34:37], v[58:61], v[192:195]
  s_add_u32 s72, s76, s78
  s_add_u32 s72, s72, 552960
  s_sub_u32 s72, s72, s83
  s_add_u32 m0, s73, 12288
  s_nop 0
  buffer_load_dwordx4 v74, s[28:31], s72 offen lds
  ds_read_b64_tr_b16 v[18:19], v78 offset:0
  v_mfma_f32_16x16x32_bf16 v[196:199], v[34:37], v[62:65], v[196:199]
  ds_read_b64_tr_b16 v[20:21], v78 offset:2048
  v_mfma_f32_16x16x32_bf16 v[200:203], v[34:37], v[66:69], v[200:203]
  s_add_u32 s72, s72, 9216
  s_add_u32 m0, s73, 13312
  s_nop 0
  buffer_load_dwordx4 v74, s[28:31], s72 offen lds
  ds_read_b64_tr_b16 v[22:23], v79 offset:0
  v_mfma_f32_16x16x32_bf16 v[204:207], v[34:37], v[70:73], v[204:207]
  ds_read_b64_tr_b16 v[24:25], v79 offset:2048
  v_mfma_f32_16x16x32_bf16 v[208:211], v[38:41], v[58:61], v[208:211]
  s_add_u32 s72, s72, 9216
  s_add_u32 m0, s73, 14336
  s_nop 0
  buffer_load_dwordx4 v74, s[28:31], s72 offen lds
  v_mfma_f32_16x16x32_bf16 v[212:215], v[38:41], v[62:65], v[212:215]
  v_mfma_f32_16x16x32_bf16 v[216:219], v[38:41], v[66:69], v[216:219]
  s_add_u32 s72, s72, 9216
  s_add_u32 m0, s73, 15360
  s_nop 0
  buffer_load_dwordx4 v74, s[28:31], s72 offen lds
  v_mfma_f32_16x16x32_bf16 v[220:223], v[38:41], v[70:73], v[220:223]
  s_waitcnt lgkmcnt(0)
  s_waitcnt vmcnt(6)
  s_waitcnt vmcnt(18)
  v_readfirstlane_b32 s6, v2
  s_nop 3
  s_and_b32 s7, s6, 0x0f0f0f0f
  s_lshr_b32 s85, s6, 4
  s_and_b32 s85, s85, 0x0f0f0f0f
  s_add_u32 s7, s7, s85
  s_mul_i32 s7, s7, 0x01010101
  s_lshr_b32 s7, s7, 24
  s_cmp_ge_u32 s7, 8
  s_cselect_b32 s88, 1, 0
  v_mfma_f32_16x16x32_bf16 v[96:99], v[10:13], v[42:45], v[96:99]
  ds_read_b64_tr_b16 v[26:27], v76 offset:4096
  v_mfma_f32_16x16x32_bf16 v[100:103], v[10:13], v[46:49], v[100:103]
  ds_read_b64_tr_b16 v[28:29], v76 offset:6144
  v_mfma_f32_16x16x32_bf16 v[104:107], v[10:13], v[50:53], v[104:107]
  ds_read_b64_tr_b16 v[30:31], v77 offset:4096
  v_mfma_f32_16x16x32_bf16 v[108:111], v[10:13], v[54:57], v[108:111]
  ds_read_b64_tr_b16 v[32:33], v77 offset:6144
  v_mfma_f32_16x16x32_bf16 v[112:115], v[14:17], v[42:45], v[112:115]
  ds_read_b64_tr_b16 v[34:35], v78 offset:4096
  v_mfma_f32_16x16x32_bf16 v[116:119], v[14:17], v[46:49], v[116:119]
  ds_read_b64_tr_b16 v[36:37], v78 offset:6144
  v_mfma_f32_16x16x32_bf16 v[120:123], v[14:17], v[50:53], v[120:123]
  ds_read_b64_tr_b16 v[38:39], v79 offset:4096
  v_mfma_f32_16x16x32_bf16 v[124:127], v[14:17], v[54:57], v[124:127]
  ds_read_b64_tr_b16 v[40:41], v79 offset:6144
  v_mfma_f32_16x16x32_bf16 v[128:131], v[18:21], v[42:45], v[128:131]
  s_add_u32 s72, s76, s78
  s_add_u32 s72, s72, 553088
  s_sub_u32 s72, s72, s83
  s_add_u32 m0, s73, 0
  s_nop 0
  buffer_load_dwordx4 v74, s[28:31], s72 offen lds
  v_mfma_f32_16x16x32_bf16 v[132:135], v[18:21], v[46:49], v[132:135]
  v_mfma_f32_16x16x32_bf16 v[136:139], v[18:21], v[50:53], v[136:139]
  s_add_u32 s72, s72, 9216
  s_add_u32 m0, s73, 1024
  s_nop 0
  buffer_load_dwordx4 v74, s[28:31], s72 offen lds
  v_mfma_f32_16x16x32_bf16 v[140:143], v[18:21], v[54:57], v[140:143]
  v_mfma_f32_16x16x32_bf16 v[144:147], v[22:25], v[42:45], v[144:147]
  s_add_u32 s72, s72, 9216
  s_add_u32 m0, s73, 2048
  s_nop 0
  buffer_load_dwordx4 v74, s[28:31], s72 offen lds
  v_mfma_f32_16x16x32_bf16 v[148:151], v[22:25], v[46:49], v[148:151]
  v_mfma_f32_16x16x32_bf16 v[152:155], v[22:25], v[50:53], v[152:155]
  s_add_u32 s72, s72, 9216
  s_add_u32 m0, s73, 3072
  s_nop 0
  buffer_load_dwordx4 v74, s[28:31], s72 offen lds
  v_mfma_f32_16x16x32_bf16 v[156:159], v[22:25], v[54:57], v[156:159]
  s_waitcnt lgkmcnt(0)
  s_waitcnt vmcnt(8)
  v_mfma_f32_16x16x32_bf16 v[160:163], v[26:29], v[42:45], v[160:163]
  ds_read_b64_tr_b16 v[10:11], v80 offset:8192
  v_mfma_f32_16x16x32_bf16 v[164:167], v[26:29], v[46:49], v[164:167]
  ds_read_b64_tr_b16 v[12:13], v80 offset:9216
  v_mfma_f32_16x16x32_bf16 v[168:171], v[26:29], v[50:53], v[168:171]
  ds_read_b64_tr_b16 v[14:15], v81 offset:8192
  v_mfma_f32_16x16x32_bf16 v[172:175], v[26:29], v[54:57], v[172:175]
  ds_read_b64_tr_b16 v[16:17], v81 offset:9216
  v_mfma_f32_16x16x32_bf16 v[176:179], v[30:33], v[42:45], v[176:179]
  v_mfma_f32_16x16x32_bf16 v[180:183], v[30:33], v[46:49], v[180:183]
  v_mfma_f32_16x16x32_bf16 v[184:187], v[30:33], v[50:53], v[184:187]
  v_mfma_f32_16x16x32_bf16 v[188:191], v[30:33], v[54:57], v[188:191]
  v_mfma_f32_16x16x32_bf16 v[192:195], v[34:37], v[42:45], v[192:195]
  s_add_u32 s72, s76, s78
  s_add_u32 s72, s72, 589824
  s_add_u32 s72, s72, s83
  s_add_u32 m0, s73, 4096
  s_nop 0
  buffer_load_dwordx4 v74, s[28:31], s72 offen lds
  v_mfma_f32_16x16x32_bf16 v[196:199], v[34:37], v[46:49], v[196:199]
  v_mfma_f32_16x16x32_bf16 v[200:203], v[34:37], v[50:53], v[200:203]
  s_add_u32 s72, s72, 9216
  s_add_u32 m0, s73, 5120
  s_nop 0
  buffer_load_dwordx4 v74, s[28:31], s72 offen lds
  v_mfma_f32_16x16x32_bf16 v[204:207], v[34:37], v[54:57], v[204:207]
  v_mfma_f32_16x16x32_bf16 v[208:211], v[38:41], v[42:45], v[208:211]
  s_add_u32 s72, s72, 9216
  s_add_u32 m0, s73, 6144
  s_nop 0
  buffer_load_dwordx4 v74, s[28:31], s72 offen lds
  v_mfma_f32_16x16x32_bf16 v[212:215], v[38:41], v[46:49], v[212:215]
  v_mfma_f32_16x16x32_bf16 v[216:219], v[38:41], v[50:53], v[216:219]
  s_add_u32 s72, s72, 9216
  s_add_u32 m0, s73, 7168
  s_nop 0
  buffer_load_dwordx4 v74, s[28:31], s72 offen lds
  v_mfma_f32_16x16x32_bf16 v[220:223], v[38:41], v[54:57], v[220:223]
  s_waitcnt lgkmcnt(0)
  s_waitcnt vmcnt(8)
  v_mfma_f32_16x16x32_bf16 v[224:227], v[10:13], v[42:45], v[224:227]
  s_add_u32 s72, s76, s78
  s_add_u32 s72, s72, 589952
  s_add_u32 s72, s72, s83
  s_add_u32 m0, s73, 8192
  s_nop 0
  buffer_load_dwordx4 v74, s[28:31], s72 offen lds
  ds_read_b128 v[58:61], v83 offset:24576
  ds_read_b128 v[62:65], v83 offset:25600
  ds_read_b128 v[66:69], v83 offset:26624
  v_mfma_f32_16x16x32_bf16 v[228:231], v[10:13], v[46:49], v[228:231]
  ds_read_b128 v[70:73], v83 offset:27648
  ds_read_b64_tr_b16 v[26:27], v76 offset:12288
  ds_read_b64_tr_b16 v[28:29], v76 offset:14336
  v_mfma_f32_16x16x32_bf16 v[232:235], v[10:13], v[50:53], v[232:235]
  s_add_u32 s72, s72, 9216
  s_add_u32 m0, s73, 9216
  s_nop 0
  buffer_load_dwordx4 v74, s[28:31], s72 offen lds
  ds_read_b64_tr_b16 v[30:31], v77 offset:12288
  ds_read_b64_tr_b16 v[32:33], v77 offset:14336
  ds_read_b64_tr_b16 v[34:35], v78 offset:12288
  v_mfma_f32_16x16x32_bf16 v[236:239], v[10:13], v[54:57], v[236:239]
  ds_read_b64_tr_b16 v[36:37], v78 offset:14336
  ds_read_b64_tr_b16 v[38:39], v79 offset:12288
  ds_read_b64_tr_b16 v[40:41], v79 offset:14336
  v_mfma_f32_16x16x32_bf16 v[240:243], v[14:17], v[42:45], v[240:243]
  s_add_u32 s72, s72, 9216
  s_add_u32 m0, s73, 10240
  s_nop 0
  buffer_load_dwordx4 v74, s[28:31], s72 offen lds
  v_mfma_f32_16x16x32_bf16 v[244:247], v[14:17], v[46:49], v[244:247]
  v_mfma_f32_16x16x32_bf16 v[248:251], v[14:17], v[50:53], v[248:251]
  s_add_u32 s72, s72, 9216
  s_add_u32 m0, s73, 11264
  s_nop 0
  buffer_load_dwordx4 v74, s[28:31], s72 offen lds
  v_mfma_f32_16x16x32_bf16 v[252:255], v[14:17], v[54:57], v[252:255]
  s_waitcnt lgkmcnt(0)
  s_waitcnt vmcnt(8)
  v_mfma_f32_16x16x32_bf16 v[96:99], v[26:29], v[58:61], v[96:99]
  ds_read_b64_tr_b16 v[10:11], v76 offset:0
  v_mfma_f32_16x16x32_bf16 v[100:103], v[26:29], v[62:65], v[100:103]
  ds_read_b64_tr_b16 v[12:13], v76 offset:2048
  v_mfma_f32_16x16x32_bf16 v[104:107], v[26:29], v[66:69], v[104:107]
  ds_read_b64_tr_b16 v[14:15], v77 offset:0
  v_mfma_f32_16x16x32_bf16 v[108:111], v[26:29], v[70:73], v[108:111]
  ds_read_b64_tr_b16 v[16:17], v77 offset:2048
  v_mfma_f32_16x16x32_bf16 v[112:115], v[30:33], v[58:61], v[112:115]
  ds_read_b64_tr_b16 v[18:19], v78 offset:0
  v_mfma_f32_16x16x32_bf16 v[116:119], v[30:33], v[62:65], v[116:119]
  ds_read_b64_tr_b16 v[20:21], v78 offset:2048
  v_mfma_f32_16x16x32_bf16 v[120:123], v[30:33], v[66:69], v[120:123]
  ds_read_b64_tr_b16 v[22:23], v79 offset:0
  v_mfma_f32_16x16x32_bf16 v[124:127], v[30:33], v[70:73], v[124:127]
  ds_read_b64_tr_b16 v[24:25], v79 offset:2048
  v_mfma_f32_16x16x32_bf16 v[128:131], v[34:37], v[58:61], v[128:131]
  v_mfma_f32_16x16x32_bf16 v[132:135], v[34:37], v[62:65], v[132:135]
  v_mfma_f32_16x16x32_bf16 v[136:139], v[34:37], v[66:69], v[136:139]
  v_mfma_f32_16x16x32_bf16 v[140:143], v[34:37], v[70:73], v[140:143]
  v_mfma_f32_16x16x32_bf16 v[144:147], v[38:41], v[58:61], v[144:147]
  s_add_u32 s72, s76, s79
  s_add_u32 s72, s72, 589824
  s_add_u32 s72, s72, s83
  s_add_u32 m0, s73, 12288
  s_nop 0
  buffer_load_dwordx4 v87, s[28:31], s72 offen lds
  v_mfma_f32_16x16x32_bf16 v[148:151], v[38:41], v[62:65], v[148:151]
  v_mfma_f32_16x16x32_bf16 v[152:155], v[38:41], v[66:69], v[152:155]
  s_add_u32 s72, s72, 18432
  s_add_u32 m0, s73, 13312
  s_nop 0
  buffer_load_dwordx4 v87, s[28:31], s72 offen lds
  v_mfma_f32_16x16x32_bf16 v[156:159], v[38:41], v[70:73], v[156:159]
  s_waitcnt lgkmcnt(0)
  s_waitcnt vmcnt(6)
  v_add_u32 v82, 32768, v82
  v_mfma_f32_16x16x32_bf16 v[160:163], v[10:13], v[58:61], v[160:163]
  ds_read_b128 v[42:45], v82 offset:0
  v_mfma_f32_16x16x32_bf16 v[164:167], v[10:13], v[62:65], v[164:167]
  ds_read_b128 v[46:49], v82 offset:1024
  v_mfma_f32_16x16x32_bf16 v[168:171], v[10:13], v[66:69], v[168:171]
  ds_read_b128 v[50:53], v82 offset:2048
  v_mfma_f32_16x16x32_bf16 v[172:175], v[10:13], v[70:73], v[172:175]
  ds_read_b128 v[54:57], v82 offset:3072
  v_mfma_f32_16x16x32_bf16 v[176:179], v[14:17], v[58:61], v[176:179]
  ds_read_b64_tr_b16 v[26:27], v76 offset:4096
  v_mfma_f32_16x16x32_bf16 v[180:183], v[14:17], v[62:65], v[180:183]
  ds_read_b64_tr_b16 v[28:29], v76 offset:6144
  v_mfma_f32_16x16x32_bf16 v[184:187], v[14:17], v[66:69], v[184:187]
  ds_read_b64_tr_b16 v[30:31], v77 offset:4096
  v_mfma_f32_16x16x32_bf16 v[188:191], v[14:17], v[70:73], v[188:191]
  ds_read_b64_tr_b16 v[32:33], v77 offset:6144
  v_mfma_f32_16x16x32_bf16 v[192:195], v[18:21], v[58:61], v[192:195]
  s_add_u32 s72, s76, s78
  s_add_u32 s72, s72, 626688
  s_sub_u32 s72, s72, s83
  s_add_u32 m0, s73, 0
  s_nop 0
  buffer_load_dwordx4 v74, s[28:31], s72 offen lds
  ds_read_b64_tr_b16 v[34:35], v78 offset:4096
  v_mfma_f32_16x16x32_bf16 v[196:199], v[18:21], v[62:65], v[196:199]
  ds_read_b64_tr_b16 v[36:37], v78 offset:6144
  v_mfma_f32_16x16x32_bf16 v[200:203], v[18:21], v[66:69], v[200:203]
  s_add_u32 s72, s72, 9216
  s_add_u32 m0, s73, 1024
  s_nop 0
  buffer_load_dwordx4 v74, s[28:31], s72 offen lds
  ds_read_b64_tr_b16 v[38:39], v79 offset:4096
  v_mfma_f32_16x16x32_bf16 v[204:207], v[18:21], v[70:73], v[204:207]
  ds_read_b64_tr_b16 v[40:41], v79 offset:6144
  v_mfma_f32_16x16x32_bf16 v[208:211], v[22:25], v[58:61], v[208:211]
  s_add_u32 s72, s72, 9216
  s_add_u32 m0, s73, 2048
  s_nop 0
  buffer_load_dwordx4 v74, s[28:31], s72 offen lds
  v_mfma_f32_16x16x32_bf16 v[212:215], v[22:25], v[62:65], v[212:215]
  v_mfma_f32_16x16x32_bf16 v[216:219], v[22:25], v[66:69], v[216:219]
  s_add_u32 s72, s72, 9216
  s_add_u32 m0, s73, 3072
  s_nop 0
  buffer_load_dwordx4 v74, s[28:31], s72 offen lds
  v_mfma_f32_16x16x32_bf16 v[220:223], v[22:25], v[70:73], v[220:223]
  s_waitcnt lgkmcnt(0)
  s_waitcnt vmcnt(6)
  v_mfma_f32_16x16x32_bf16 v[96:99], v[26:29], v[42:45], v[96:99]
  ds_read_b64_tr_b16 v[10:11], v76 offset:8192
  v_mfma_f32_16x16x32_bf16 v[100:103], v[26:29], v[46:49], v[100:103]
  ds_read_b64_tr_b16 v[12:13], v76 offset:10240
  v_mfma_f32_16x16x32_bf16 v[104:107], v[26:29], v[50:53], v[104:107]
  ds_read_b64_tr_b16 v[14:15], v77 offset:8192
  v_mfma_f32_16x16x32_bf16 v[108:111], v[26:29], v[54:57], v[108:111]
  ds_read_b64_tr_b16 v[16:17], v77 offset:10240
  v_mfma_f32_16x16x32_bf16 v[112:115], v[30:33], v[42:45], v[112:115]
  ds_read_b64_tr_b16 v[18:19], v78 offset:8192
  v_mfma_f32_16x16x32_bf16 v[116:119], v[30:33], v[46:49], v[116:119]
  ds_read_b64_tr_b16 v[20:21], v78 offset:10240
  v_mfma_f32_16x16x32_bf16 v[120:123], v[30:33], v[50:53], v[120:123]
  ds_read_b64_tr_b16 v[22:23], v79 offset:8192
  v_mfma_f32_16x16x32_bf16 v[124:127], v[30:33], v[54:57], v[124:127]
  ds_read_b64_tr_b16 v[24:25], v79 offset:10240
  v_mfma_f32_16x16x32_bf16 v[128:131], v[34:37], v[42:45], v[128:131]
  s_add_u32 s72, s76, s78
  s_add_u32 s72, s72, 626816
  s_sub_u32 s72, s72, s83
  s_add_u32 m0, s73, 4096
  s_nop 0
  buffer_load_dwordx4 v74, s[28:31], s72 offen lds
  v_mfma_f32_16x16x32_bf16 v[132:135], v[34:37], v[46:49], v[132:135]
  v_mfma_f32_16x16x32_bf16 v[136:139], v[34:37], v[50:53], v[136:139]
  s_add_u32 s72, s72, 9216
  s_add_u32 m0, s73, 5120
  s_nop 0
  buffer_load_dwordx4 v74, s[28:31], s72 offen lds
  v_mfma_f32_16x16x32_bf16 v[140:143], v[34:37], v[54:57], v[140:143]
  v_mfma_f32_16x16x32_bf16 v[144:147], v[38:41], v[42:45], v[144:147]
  s_add_u32 s72, s72, 9216
  s_add_u32 m0, s73, 6144
  s_nop 0
  buffer_load_dwordx4 v74, s[28:31], s72 offen lds
  v_mfma_f32_16x16x32_bf16 v[148:151], v[38:41], v[46:49], v[148:151]
  v_mfma_f32_16x16x32_bf16 v[152:155], v[38:41], v[50:53], v[152:155]
  s_add_u32 s72, s72, 9216
  s_add_u32 m0, s73, 7168
  s_nop 0
  buffer_load_dwordx4 v74, s[28:31], s72 offen lds
  v_mfma_f32_16x16x32_bf16 v[156:159], v[38:41], v[54:57], v[156:159]
  s_waitcnt lgkmcnt(0)
  s_waitcnt vmcnt(8)
  v_mfma_f32_16x16x32_bf16 v[160:163], v[10:13], v[42:45], v[160:163]
  ds_read_b64_tr_b16 v[26:27], v80 offset:12288
  v_mfma_f32_16x16x32_bf16 v[164:167], v[10:13], v[46:49], v[164:167]
  ds_read_b64_tr_b16 v[28:29], v80 offset:13312
  v_mfma_f32_16x16x32_bf16 v[168:171], v[10:13], v[50:53], v[168:171]
  ds_read_b64_tr_b16 v[30:31], v81 offset:12288
  v_mfma_f32_16x16x32_bf16 v[172:175], v[10:13], v[54:57], v[172:175]
  ds_read_b64_tr_b16 v[32:33], v81 offset:13312
  v_mfma_f32_16x16x32_bf16 v[176:179], v[14:17], v[42:45], v[176:179]
  v_mfma_f32_16x16x32_bf16 v[180:183], v[14:17], v[46:49], v[180:183]
  v_mfma_f32_16x16x32_bf16 v[184:187], v[14:17], v[50:53], v[184:187]
  v_mfma_f32_16x16x32_bf16 v[188:191], v[14:17], v[54:57], v[188:191]
  v_mfma_f32_16x16x32_bf16 v[192:195], v[18:21], v[42:45], v[192:195]
  s_add_u32 s72, s77, s78
  s_add_u32 s72, s72, 0
  s_add_u32 s72, s72, s84
  s_add_u32 m0, s73, 8192
  s_nop 0
  buffer_load_dwordx4 v74, s[20:23], s72 offen lds
  v_mfma_f32_16x16x32_bf16 v[196:199], v[18:21], v[46:49], v[196:199]
  v_mfma_f32_16x16x32_bf16 v[200:203], v[18:21], v[50:53], v[200:203]
  s_add_u32 s72, s72, 9216
  s_add_u32 m0, s73, 9216
  s_nop 0
  buffer_load_dwordx4 v74, s[20:23], s72 offen lds
  v_mfma_f32_16x16x32_bf16 v[204:207], v[18:21], v[54:57], v[204:207]
  v_mfma_f32_16x16x32_bf16 v[208:211], v[22:25], v[42:45], v[208:211]
  s_add_u32 s72, s72, 11520
  s_add_u32 m0, s73, 10240
  s_nop 0
  buffer_load_dwordx4 v74, s[20:23], s72 offen lds
  v_mfma_f32_16x16x32_bf16 v[212:215], v[22:25], v[46:49], v[212:215]
  v_mfma_f32_16x16x32_bf16 v[216:219], v[22:25], v[50:53], v[216:219]
  s_add_u32 s72, s72, 9216
  s_add_u32 m0, s73, 11264
  s_nop 0
  buffer_load_dwordx4 v74, s[20:23], s72 offen lds
  v_mfma_f32_16x16x32_bf16 v[220:223], v[22:25], v[54:57], v[220:223]
  s_waitcnt lgkmcnt(0)
  s_waitcnt vmcnt(8)
  v_add_u32 v83, 32768, v83
  v_mfma_f32_16x16x32_bf16 v[224:227], v[26:29], v[42:45], v[224:227]
  s_add_u32 s72, s77, s78
  s_add_u32 s72, s72, 128
  s_add_u32 s72, s72, s84
  s_add_u32 m0, s73, 12288
  s_nop 0
  buffer_load_dwordx4 v74, s[20:23], s72 offen lds
  ds_read_b128 v[58:61], v83 offset:0
  ds_read_b128 v[62:65], v83 offset:1024
  ds_read_b128 v[66:69], v83 offset:2048
  v_mfma_f32_16x16x32_bf16 v[228:231], v[26:29], v[46:49], v[228:231]
  ds_read_b128 v[70:73], v83 offset:3072
  ds_read_b64_tr_b16 v[10:11], v76 offset:0
  ds_read_b64_tr_b16 v[12:13], v76 offset:2048
  v_mfma_f32_16x16x32_bf16 v[232:235], v[26:29], v[50:53], v[232:235]
  s_add_u32 s72, s72, 9216
  s_add_u32 m0, s73, 13312
  s_nop 0
  buffer_load_dwordx4 v74, s[20:23], s72 offen lds
  ds_read_b64_tr_b16 v[14:15], v77 offset:0
  ds_read_b64_tr_b16 v[16:17], v77 offset:2048
  ds_read_b64_tr_b16 v[18:19], v78 offset:0
  v_mfma_f32_16x16x32_bf16 v[236:239], v[26:29], v[54:57], v[236:239]
  ds_read_b64_tr_b16 v[20:21], v78 offset:2048
  ds_read_b64_tr_b16 v[22:23], v79 offset:0
  ds_read_b64_tr_b16 v[24:25], v79 offset:2048
  v_mfma_f32_16x16x32_bf16 v[240:243], v[30:33], v[42:45], v[240:243]
  s_add_u32 s72, s72, 11520
  s_add_u32 m0, s73, 14336
  s_nop 0
  buffer_load_dwordx4 v74, s[20:23], s72 offen lds
  v_mfma_f32_16x16x32_bf16 v[244:247], v[30:33], v[46:49], v[244:247]
  v_mfma_f32_16x16x32_bf16 v[248:251], v[30:33], v[50:53], v[248:251]
  s_add_u32 s72, s72, 9216
  s_add_u32 m0, s73, 15360
  s_nop 0
  buffer_load_dwordx4 v74, s[20:23], s72 offen lds
  v_mfma_f32_16x16x32_bf16 v[252:255], v[30:33], v[54:57], v[252:255]
  s_waitcnt lgkmcnt(0)
  s_waitcnt vmcnt(8)
  v_mfma_f32_16x16x32_bf16 v[96:99], v[10:13], v[58:61], v[96:99]
  ds_read_b64_tr_b16 v[26:27], v76 offset:4096
  v_mfma_f32_16x16x32_bf16 v[100:103], v[10:13], v[62:65], v[100:103]
  ds_read_b64_tr_b16 v[28:29], v76 offset:6144
  v_mfma_f32_16x16x32_bf16 v[104:107], v[10:13], v[66:69], v[104:107]
  ds_read_b64_tr_b16 v[30:31], v77 offset:4096
  v_mfma_f32_16x16x32_bf16 v[108:111], v[10:13], v[70:73], v[108:111]
  ds_read_b64_tr_b16 v[32:33], v77 offset:6144
  v_mfma_f32_16x16x32_bf16 v[112:115], v[14:17], v[58:61], v[112:115]
  ds_read_b64_tr_b16 v[34:35], v78 offset:4096
  v_mfma_f32_16x16x32_bf16 v[116:119], v[14:17], v[62:65], v[116:119]
  ds_read_b64_tr_b16 v[36:37], v78 offset:6144
  v_mfma_f32_16x16x32_bf16 v[120:123], v[14:17], v[66:69], v[120:123]
  ds_read_b64_tr_b16 v[38:39], v79 offset:4096
  v_mfma_f32_16x16x32_bf16 v[124:127], v[14:17], v[70:73], v[124:127]
  ds_read_b64_tr_b16 v[40:41], v79 offset:6144
  v_mfma_f32_16x16x32_bf16 v[128:131], v[18:21], v[58:61], v[128:131]
  v_mfma_f32_16x16x32_bf16 v[132:135], v[18:21], v[62:65], v[132:135]
  v_mfma_f32_16x16x32_bf16 v[136:139], v[18:21], v[66:69], v[136:139]
  v_mfma_f32_16x16x32_bf16 v[140:143], v[18:21], v[70:73], v[140:143]
  v_mfma_f32_16x16x32_bf16 v[144:147], v[22:25], v[58:61], v[144:147]
  s_add_u32 s72, s77, s79
  s_add_u32 s72, s72, 0
  s_add_u32 s72, s72, s84
  s_add_u32 m0, s73, 0
  s_nop 0
  buffer_load_dwordx4 v87, s[20:23], s72 offen lds
  v_mfma_f32_16x16x32_bf16 v[148:151], v[22:25], v[62:65], v[148:151]
  v_mfma_f32_16x16x32_bf16 v[152:155], v[22:25], v[66:69], v[152:155]
  s_add_u32 s72, s72, 20736
  s_add_u32 m0, s73, 1024
  s_nop 0
  buffer_load_dwordx4 v87, s[20:23], s72 offen lds
  v_mfma_f32_16x16x32_bf16 v[156:159], v[22:25], v[70:73], v[156:159]
  s_waitcnt lgkmcnt(0)
  v_mfma_f32_16x16x32_bf16 v[160:163], v[26:29], v[58:61], v[160:163]
  v_mfma_f32_16x16x32_bf16 v[164:167], v[26:29], v[62:65], v[164:167]
  v_mfma_f32_16x16x32_bf16 v[168:171], v[26:29], v[66:69], v[168:171]
  v_mfma_f32_16x16x32_bf16 v[172:175], v[26:29], v[70:73], v[172:175]
  v_mfma_f32_16x16x32_bf16 v[176:179], v[30:33], v[58:61], v[176:179]
  v_mfma_f32_16x16x32_bf16 v[180:183], v[30:33], v[62:65], v[180:183]
  v_mfma_f32_16x16x32_bf16 v[184:187], v[30:33], v[66:69], v[184:187]
  v_mfma_f32_16x16x32_bf16 v[188:191], v[30:33], v[70:73], v[188:191]
  v_mfma_f32_16x16x32_bf16 v[192:195], v[34:37], v[58:61], v[192:195]
  s_add_u32 s72, s77, s78
  s_add_u32 s72, s72, 41472
  s_sub_u32 s72, s72, s84
  s_add_u32 m0, s73, 4096
  s_nop 0
  buffer_load_dwordx4 v74, s[20:23], s72 offen lds
  v_mfma_f32_16x16x32_bf16 v[196:199], v[34:37], v[62:65], v[196:199]
  v_mfma_f32_16x16x32_bf16 v[200:203], v[34:37], v[66:69], v[200:203]
  s_add_u32 s72, s72, 9216
  s_add_u32 m0, s73, 5120
  s_nop 0
  buffer_load_dwordx4 v74, s[20:23], s72 offen lds
  v_mfma_f32_16x16x32_bf16 v[204:207], v[34:37], v[70:73], v[204:207]
  v_mfma_f32_16x16x32_bf16 v[208:211], v[38:41], v[58:61], v[208:211]
  s_add_u32 s72, s72, 11520
  s_add_u32 m0, s73, 6144
  s_nop 0
  buffer_load_dwordx4 v74, s[20:23], s72 offen lds
  v_mfma_f32_16x16x32_bf16 v[212:215], v[38:41], v[62:65], v[212:215]
  v_mfma_f32_16x16x32_bf16 v[216:219], v[38:41], v[66:69], v[216:219]
  s_add_u32 s72, s72, 9216
  s_add_u32 m0, s73, 7168
  s_nop 0
  buffer_load_dwordx4 v74, s[20:23], s72 offen lds
  v_mfma_f32_16x16x32_bf16 v[220:223], v[38:41], v[70:73], v[220:223]
  v_lshlrev_b32 v3, 4, v0
  s_lshl_b32 s85, s80, 12
  s_add_u32 s86, s85, 139264
  v_add_u32 v82, s86, v3
  s_sub_u32 s86, 143360, s85
  v_add_u32 v83, s86, v3
  v_add_u32 v94, 147456, v3
  s_mov_b32 s95, 400000
W_95:
  ds_read_b32 v3, v84 offset:32
  s_waitcnt lgkmcnt(0)
  v_readfirstlane_b32 s6, v3
  s_nop 3
  s_cmp_ge_u32 s6, 4
  s_cbranch_scc1 WD_96
  s_sleep 1
  s_sub_u32 s95, s95, 1
  s_cmp_lg_u32 s95, 0
  s_cbranch_scc1 W_95
WD_96:
  s_waitcnt vmcnt(10)
  ds_read_b128 v[42:45], v82 offset:0
  ds_read_b128 v[46:49], v82 offset:1024
  ds_read_b128 v[50:53], v82 offset:2048
  ds_read_b128 v[54:57], v82 offset:3072
  ds_read_b64_tr_b16 v[10:11], v76 offset:8192
  ds_read_b64_tr_b16 v[12:13], v76 offset:10240
  ds_read_b64_tr_b16 v[14:15], v77 offset:8192
  ds_read_b64_tr_b16 v[16:17], v77 offset:10240
  ds_read_b64_tr_b16 v[18:19], v78 offset:8192
  ds_read_b64_tr_b16 v[20:21], v78 offset:10240
  ds_read_b64_tr_b16 v[22:23], v79 offset:8192
  ds_read_b64_tr_b16 v[24:25], v79 offset:10240
  s_waitcnt lgkmcnt(0)
  s_waitcnt vmcnt(6)
  v_mfma_f32_16x16x32_bf16 v[96:99], v[10:13], v[42:45], v[96:99]
  ds_read_b64_tr_b16 v[26:27], v76 offset:12288
  v_mfma_f32_16x16x32_bf16 v[100:103], v[10:13], v[46:49], v[100:103]
  ds_read_b64_tr_b16 v[28:29], v76 offset:14336
  v_mfma_f32_16x16x32_bf16 v[104:107], v[10:13], v[50:53], v[104:107]
  ds_read_b64_tr_b16 v[30:31], v77 offset:12288
  v_mfma_f32_16x16x32_bf16 v[108:111], v[10:13], v[54:57], v[108:111]
  ds_read_b64_tr_b16 v[32:33], v77 offset:14336
  v_mfma_f32_16x16x32_bf16 v[112:115], v[14:17], v[42:45], v[112:115]
  ds_read_b64_tr_b16 v[34:35], v78 offset:12288
  v_mfma_f32_16x16x32_bf16 v[116:119], v[14:17], v[46:49], v[116:119]
  ds_read_b64_tr_b16 v[36:37], v78 offset:14336
  v_mfma_f32_16x16x32_bf16 v[120:123], v[14:17], v[50:53], v[120:123]
  ds_read_b64_tr_b16 v[38:39], v79 offset:12288
  v_mfma_f32_16x16x32_bf16 v[124:127], v[14:17], v[54:57], v[124:127]
  ds_read_b64_tr_b16 v[40:41], v79 offset:14336
  v_mfma_f32_16x16x32_bf16 v[128:131], v[18:21], v[42:45], v[128:131]
  s_add_u32 s72, s77, s78
  s_add_u32 s72, s72, 41600
  s_sub_u32 s72, s72, s84
  s_add_u32 m0, s73, 8192
  s_nop 0
  buffer_load_dwordx4 v74, s[20:23], s72 offen lds
  v_mfma_f32_16x16x32_bf16 v[132:135], v[18:21], v[46:49], v[132:135]
  v_mfma_f32_16x16x32_bf16 v[136:139], v[18:21], v[50:53], v[136:139]
  s_add_u32 s72, s72, 9216
  s_add_u32 m0, s73, 9216
  s_nop 0
  buffer_load_dwordx4 v74, s[20:23], s72 offen lds
  v_mfma_f32_16x16x32_bf16 v[140:143], v[18:21], v[54:57], v[140:143]
  v_mfma_f32_16x16x32_bf16 v[144:147], v[22:25], v[42:45], v[144:147]
  s_add_u32 s72, s72, 11520
  s_add_u32 m0, s73, 10240
  s_nop 0
  buffer_load_dwordx4 v74, s[20:23], s72 offen lds
  v_mfma_f32_16x16x32_bf16 v[148:151], v[22:25], v[46:49], v[148:151]
  v_mfma_f32_16x16x32_bf16 v[152:155], v[22:25], v[50:53], v[152:155]
  s_add_u32 s72, s72, 9216
  s_add_u32 m0, s73, 11264
  s_nop 0
  buffer_load_dwordx4 v74, s[20:23], s72 offen lds
  v_mfma_f32_16x16x32_bf16 v[156:159], v[22:25], v[54:57], v[156:159]
  s_waitcnt lgkmcnt(0)
  s_waitcnt vmcnt(8)
  v_mov_b32 v92, 268435456
  v_lshrrev_b32 v3, 3, v0
  v_lshrrev_b32 v4, 1, v3
  v_mul_u32_u24 v4, 18, v4
  v_and_b32 v5, 1, v3
  v_add_u32 v4, v4, v5
  v_add_u32 v4, 16, v4
  v_mul_u32_u24 v4, 1152, v4
  v_and_b32 v5, 7, v0
  v_lshrrev_b32 v6, 4, v0
  v_lshlrev_b32 v6, 1, v6
  v_xor_b32 v5, v5, v6
  v_lshlrev_b32 v5, 4, v5
  v_add_u32 v4, v4, v5
  v_cmp_gt_u32 vcc, 4, v3
  v_lshrrev_b32 v3, 2, v0
  v_lshrrev_b32 v5, 1, v3
  v_cndmask_b32 v75, v92, v4, vcc
  v_mul_u32_u24 v5, 18, v5
  v_and_b32 v6, 1, v3
  v_add_u32 v5, v5, v6
  v_add_u32 v5, 16, v5
  v_mul_u32_u24 v5, 1152, v5
  v_and_b32 v6, 3, v0
  v_lshrrev_b32 v7, 4, v0
  v_and_b32 v7, 1, v7
  v_lshlrev_b32 v7, 1, v7
  v_xor_b32 v6, v6, v7
  v_lshlrev_b32 v6, 4, v6
  v_add_u32 v5, v5, v6
  s_cmp_eq_u32 s80, 0
  s_cselect_b32 s6, 4, 0
  v_cmp_gt_u32 vcc, s6, v3
  s_nop 1
  v_cndmask_b32 v87, v92, v5, vcc
  v_mfma_f32_16x16x32_bf16 v[160:163], v[26:29], v[42:45], v[160:163]
  ds_read_b64_tr_b16 v[10:11], v80 offset:0
  v_mfma_f32_16x16x32_bf16 v[164:167], v[26:29], v[46:49], v[164:167]
  ds_read_b64_tr_b16 v[12:13], v80 offset:1024
  v_mfma_f32_16x16x32_bf16 v[168:171], v[26:29], v[50:53], v[168:171]
  ds_read_b64_tr_b16 v[14:15], v81 offset:0
  v_mfma_f32_16x16x32_bf16 v[172:175], v[26:29], v[54:57], v[172:175]
  ds_read_b64_tr_b16 v[16:17], v81 offset:1024
  v_mfma_f32_16x16x32_bf16 v[176:179], v[30:33], v[42:45], v[176:179]
  v_mfma_f32_16x16x32_bf16 v[180:183], v[30:33], v[46:49], v[180:183]
  v_mfma_f32_16x16x32_bf16 v[184:187], v[30:33], v[50:53], v[184:187]
  v_mfma_f32_16x16x32_bf16 v[188:191], v[30:33], v[54:57], v[188:191]
  v_mfma_f32_16x16x32_bf16 v[192:195], v[34:37], v[42:45], v[192:195]
  s_add_u32 s72, s77, s78
  s_add_u32 s72, s72, 0
  s_add_u32 m0, s73, 12288
  s_nop 0
  buffer_load_dwordx4 v75, s[20:23], s72 offen lds
  v_mfma_f32_16x16x32_bf16 v[196:199], v[34:37], v[46:49], v[196:199]
  v_mfma_f32_16x16x32_bf16 v[200:203], v[34:37], v[50:53], v[200:203]
  s_add_u32 s72, s77, s78
  s_add_u32 s72, s72, 0
  s_add_u32 m0, s73, 13312
  s_nop 0
  buffer_load_dwordx4 v92, s[20:23], s72 offen lds
  v_mfma_f32_16x16x32_bf16 v[204:207], v[34:37], v[54:57], v[204:207]
  v_mfma_f32_16x16x32_bf16 v[208:211], v[38:41], v[42:45], v[208:211]
  s_add_u32 s72, s77, s78
  s_add_u32 s72, s72, 41472
  s_add_u32 m0, s73, 14336
  s_nop 0
  buffer_load_dwordx4 v75, s[20:23], s72 offen lds
  v_mfma_f32_16x16x32_bf16 v[212:215], v[38:41], v[46:49], v[212:215]
  v_mfma_f32_16x16x32_bf16 v[216:219], v[38:41], v[50:53], v[216:219]
  s_add_u32 s72, s77, s78
  s_add_u32 s72, s72, 0
  s_add_u32 m0, s73, 15360
  s_nop 0
  buffer_load_dwordx4 v92, s[20:23], s72 offen lds
  v_mfma_f32_16x16x32_bf16 v[220:223], v[38:41], v[54:57], v[220:223]
  s_waitcnt lgkmcnt(0)
  s_waitcnt vmcnt(8)
  v_mfma_f32_16x16x32_bf16 v[224:227], v[10:13], v[42:45], v[224:227]
  s_add_u32 s72, s77, s78
  s_add_u32 s72, s72, 128
  s_add_u32 m0, s73, 0
  s_nop 0
  buffer_load_dwordx4 v75, s[20:23], s72 offen lds
  ds_read_b128 v[58:61], v83 offset:0
  ds_read_b128 v[62:65], v83 offset:1024
  ds_read_b128 v[66:69], v83 offset:2048
  v_mfma_f32_16x16x32_bf16 v[228:231], v[10:13], v[46:49], v[228:231]
  ds_read_b128 v[70:73], v83 offset:3072
  ds_read_b64_tr_b16 v[26:27], v76 offset:4096
  ds_read_b64_tr_b16 v[28:29], v76 offset:6144
  v_mfma_f32_16x16x32_bf16 v[232:235], v[10:13], v[50:53], v[232:235]
  s_add_u32 s72, s77, s78
  s_add_u32 s72, s72, 128
  s_add_u32 m0, s73, 1024
  s_nop 0
  buffer_load_dwordx4 v92, s[20:23], s72 offen lds
  ds_read_b64_tr_b16 v[30:31], v77 offset:4096
  ds_read_b64_tr_b16 v[32:33], v77 offset:6144
  ds_read_b64_tr_b16 v[34:35], v78 offset:4096
  v_mfma_f32_16x16x32_bf16 v[236:239], v[10:13], v[54:57], v[236:239]
  ds_read_b64_tr_b16 v[36:37], v78 offset:6144
  ds_read_b64_tr_b16 v[38:39], v79 offset:4096
  ds_read_b64_tr_b16 v[40:41], v79 offset:6144
  v_mfma_f32_16x16x32_bf16 v[240:243], v[14:17], v[42:45], v[240:243]
  s_add_u32 s72, s77, s78
  s_add_u32 s72, s72, 41600
  s_add_u32 m0, s73, 2048
  s_nop 0
  buffer_load_dwordx4 v75, s[20:23], s72 offen lds
  v_mfma_f32_16x16x32_bf16 v[244:247], v[14:17], v[46:49], v[244:247]
  v_mfma_f32_16x16x32_bf16 v[248:251], v[14:17], v[50:53], v[248:251]
  s_add_u32 s72, s77, s78
  s_add_u32 s72, s72, 128
  s_add_u32 m0, s73, 3072
  s_nop 0
  buffer_load_dwordx4 v92, s[20:23], s72 offen lds
  v_mfma_f32_16x16x32_bf16 v[252:255], v[14:17], v[54:57], v[252:255]
  s_waitcnt lgkmcnt(0)
  s_waitcnt vmcnt(8)
  v_mfma_f32_16x16x32_bf16 v[96:99], v[26:29], v[58:61], v[96:99]
  ds_read_b64_tr_b16 v[10:11], v76 offset:8192
  v_mfma_f32_16x16x32_bf16 v[100:103], v[26:29], v[62:65], v[100:103]
  ds_read_b64_tr_b16 v[12:13], v76 offset:10240
  v_mfma_f32_16x16x32_bf16 v[104:107], v[26:29], v[66:69], v[104:107]
  ds_read_b64_tr_b16 v[14:15], v77 offset:8192
  v_mfma_f32_16x16x32_bf16 v[108:111], v[26:29], v[70:73], v[108:111]
  ds_read_b64_tr_b16 v[16:17], v77 offset:10240
  v_mfma_f32_16x16x32_bf16 v[112:115], v[30:33], v[58:61], v[112:115]
  ds_read_b64_tr_b16 v[18:19], v78 offset:8192
  v_mfma_f32_16x16x32_bf16 v[116:119], v[30:33], v[62:65], v[116:119]
  ds_read_b64_tr_b16 v[20:21], v78 offset:10240
  v_mfma_f32_16x16x32_bf16 v[120:123], v[30:33], v[66:69], v[120:123]
  ds_read_b64_tr_b16 v[22:23], v79 offset:8192
  v_mfma_f32_16x16x32_bf16 v[124:127], v[30:33], v[70:73], v[124:127]
  ds_read_b64_tr_b16 v[24:25], v79 offset:10240
  v_mfma_f32_16x16x32_bf16 v[128:131], v[34:37], v[58:61], v[128:131]
  v_mfma_f32_16x16x32_bf16 v[132:135], v[34:37], v[62:65], v[132:135]
  v_mfma_f32_16x16x32_bf16 v[136:139], v[34:37], v[66:69], v[136:139]
  v_mfma_f32_16x16x32_bf16 v[140:143], v[34:37], v[70:73], v[140:143]
  v_mfma_f32_16x16x32_bf16 v[144:147], v[38:41], v[58:61], v[144:147]
  s_add_u32 s72, s77, s79
  s_add_u32 s72, s72, 0
  s_add_u32 m0, s73, 4096
  s_nop 0
  buffer_load_dwordx4 v87, s[20:23], s72 offen lds
  v_mfma_f32_16x16x32_bf16 v[148:151], v[38:41], v[62:65], v[148:151]
  v_mfma_f32_16x16x32_bf16 v[152:155], v[38:41], v[66:69], v[152:155]
  s_add_u32 s72, s77, s79
  s_add_u32 s72, s72, 41472
  s_add_u32 m0, s73, 5120
  s_nop 0
  buffer_load_dwordx4 v87, s[20:23], s72 offen lds
  v_mfma_f32_16x16x32_bf16 v[156:159], v[38:41], v[70:73], v[156:159]
  s_waitcnt lgkmcnt(0)
  s_waitcnt vmcnt(6)
  v_mfma_f32_16x16x32_bf16 v[160:163], v[10:13], v[58:61], v[160:163]
  ds_read_b128 v[42:45], v94 offset:0
  v_mfma_f32_16x16x32_bf16 v[164:167], v[10:13], v[62:65], v[164:167]
  ds_read_b128 v[46:49], v94 offset:1024
  v_mfma_f32_16x16x32_bf16 v[168:171], v[10:13], v[66:69], v[168:171]
  ds_read_b128 v[50:53], v94 offset:2048
  v_mfma_f32_16x16x32_bf16 v[172:175], v[10:13], v[70:73], v[172:175]
  ds_read_b128 v[54:57], v94 offset:3072
  v_mfma_f32_16x16x32_bf16 v[176:179], v[14:17], v[58:61], v[176:179]
  ds_read_b64_tr_b16 v[26:27], v76 offset:12288
  v_mfma_f32_16x16x32_bf16 v[180:183], v[14:17], v[62:65], v[180:183]
  ds_read_b64_tr_b16 v[28:29], v76 offset:14336
  v_mfma_f32_16x16x32_bf16 v[184:187], v[14:17], v[66:69], v[184:187]
  ds_read_b64_tr_b16 v[30:31], v77 offset:12288
  v_mfma_f32_16x16x32_bf16 v[188:191], v[14:17], v[70:73], v[188:191]
  ds_read_b64_tr_b16 v[32:33], v77 offset:14336
  v_mfma_f32_16x16x32_bf16 v[192:195], v[18:21], v[58:61], v[192:195]
  ds_read_b64_tr_b16 v[34:35], v78 offset:12288
  v_mfma_f32_16x16x32_bf16 v[196:199], v[18:21], v[62:65], v[196:199]
  ds_read_b64_tr_b16 v[36:37], v78 offset:14336
  v_mfma_f32_16x16x32_bf16 v[200:203], v[18:21], v[66:69], v[200:203]
  ds_read_b64_tr_b16 v[38:39], v79 offset:12288
  v_mfma_f32_16x16x32_bf16 v[204:207], v[18:21], v[70:73], v[204:207]
  ds_read_b64_tr_b16 v[40:41], v79 offset:14336
  v_mfma_f32_16x16x32_bf16 v[208:211], v[22:25], v[58:61], v[208:211]
  v_mfma_f32_16x16x32_bf16 v[212:215], v[22:25], v[62:65], v[212:215]
  v_mfma_f32_16x16x32_bf16 v[216:219], v[22:25], v[66:69], v[216:219]
  v_mfma_f32_16x16x32_bf16 v[220:223], v[22:25], v[70:73], v[220:223]
  s_waitcnt lgkmcnt(0)
  s_waitcnt vmcnt(2)
  v_mfma_f32_16x16x32_bf16 v[96:99], v[26:29], v[42:45], v[96:99]
  ds_read_b64_tr_b16 v[10:11], v76 offset:0
  v_mfma_f32_16x16x32_bf16 v[100:103], v[26:29], v[46:49], v[100:103]
  ds_read_b64_tr_b16 v[12:13], v76 offset:2048
  v_mfma_f32_16x16x32_bf16 v[104:107], v[26:29], v[50:53], v[104:107]
  ds_read_b64_tr_b16 v[14:15], v77 offset:0
  v_mfma_f32_16x16x32_bf16 v[108:111], v[26:29], v[54:57], v[108:111]
  ds_read_b64_tr_b16 v[16:17], v77 offset:2048
  v_mfma_f32_16x16x32_bf16 v[112:115], v[30:33], v[42:45], v[112:115]
  ds_read_b64_tr_b16 v[18:19], v78 offset:0
  v_mfma_f32_16x16x32_bf16 v[116:119], v[30:33], v[46:49], v[116:119]
  ds_read_b64_tr_b16 v[20:21], v78 offset:2048
  v_mfma_f32_16x16x32_bf16 v[120:123], v[30:33], v[50:53], v[120:123]
  ds_read_b64_tr_b16 v[22:23], v79 offset:0
  v_mfma_f32_16x16x32_bf16 v[124:127], v[30:33], v[54:57], v[124:127]
  ds_read_b64_tr_b16 v[24:25], v79 offset:2048
  v_mfma_f32_16x16x32_bf16 v[128:131], v[34:37], v[42:45], v[128:131]
  v_mfma_f32_16x16x32_bf16 v[132:135], v[34:37], v[46:49], v[132:135]
  v_mfma_f32_16x16x32_bf16 v[136:139], v[34:37], v[50:53], v[136:139]
  v_mfma_f32_16x16x32_bf16 v[140:143], v[34:37], v[54:57], v[140:143]
  v_mfma_f32_16x16x32_bf16 v[144:147], v[38:41], v[42:45], v[144:147]
  v_mfma_f32_16x16x32_bf16 v[148:151], v[38:41], v[46:49], v[148:151]
  v_mfma_f32_16x16x32_bf16 v[152:155], v[38:41], v[50:53], v[152:155]
  v_mfma_f32_16x16x32_bf16 v[156:159], v[38:41], v[54:57], v[156:159]
  s_waitcnt lgkmcnt(0)
  s_waitcnt vmcnt(0)
  v_mfma_f32_16x16x32_bf16 v[160:163], v[10:13], v[42:45], v[160:163]
  ds_read_b64_tr_b16 v[26:27], v80 offset:4096
  v_mfma_f32_16x16x32_bf16 v[164:167], v[10:13], v[46:49], v[164:167]
  ds_read_b64_tr_b16 v[28:29], v80 offset:5120
  v_mfma_f32_16x16x32_bf16 v[168:171], v[10:13], v[50:53], v[168:171]
  ds_read_b64_tr_b16 v[30:31], v81 offset:4096
  v_mfma_f32_16x16x32_bf16 v[172:175], v[10:13], v[54:57], v[172:175]
  ds_read_b64_tr_b16 v[32:33], v81 offset:5120
  v_mfma_f32_16x16x32_bf16 v[176:179], v[14:17], v[42:45], v[176:179]
  v_mfma_f32_16x16x32_bf16 v[180:183], v[14:17], v[46:49], v[180:183]
  v_mfma_f32_16x16x32_bf16 v[184:187], v[14:17], v[50:53], v[184:187]
  v_mfma_f32_16x16x32_bf16 v[188:191], v[14:17], v[54:57], v[188:191]
  v_mfma_f32_16x16x32_bf16 v[192:195], v[18:21], v[42:45], v[192:195]
  v_mfma_f32_16x16x32_bf16 v[196:199], v[18:21], v[46:49], v[196:199]
  v_mfma_f32_16x16x32_bf16 v[200:203], v[18:21], v[50:53], v[200:203]
  v_mfma_f32_16x16x32_bf16 v[204:207], v[18:21], v[54:57], v[204:207]
  v_mfma_f32_16x16x32_bf16 v[208:211], v[22:25], v[42:45], v[208:211]
  v_mfma_f32_16x16x32_bf16 v[212:215], v[22:25], v[46:49], v[212:215]
  v_mfma_f32_16x16x32_bf16 v[216:219], v[22:25], v[50:53], v[216:219]
  v_mfma_f32_16x16x32_bf16 v[220:223], v[22:25], v[54:57], v[220:223]
  s_waitcnt lgkmcnt(0)
  v_mfma_f32_16x16x32_bf16 v[224:227], v[26:29], v[42:45], v[224:227]
  v_mfma_f32_16x16x32_bf16 v[228:231], v[26:29], v[46:49], v[228:231]
  v_mfma_f32_16x16x32_bf16 v[232:235], v[26:29], v[50:53], v[232:235]
  v_mfma_f32_16x16x32_bf16 v[236:239], v[26:29], v[54:57], v[236:239]
  v_mfma_f32_16x16x32_bf16 v[240:243], v[30:33], v[42:45], v[240:243]
  v_mfma_f32_16x16x32_bf16 v[244:247], v[30:33], v[46:49], v[244:247]
  v_mfma_f32_16x16x32_bf16 v[248:251], v[30:33], v[50:53], v[248:251]
  v_mfma_f32_16x16x32_bf16 v[252:255], v[30:33], v[54:57], v[252:255]
  s_setprio 3
  s_xor_b32 s86, s3, 1
  s_mul_i32 s86, s86, 16384
  s_add_u32 s86, s86, 73728
  s_nop 7
  s_cmp_eq_u32 s80, 0
  s_cbranch_scc1 PS_97
  v_swap_b32 v224, v232
  v_swap_b32 v225, v233
  v_swap_b32 v226, v234
  v_swap_b32 v227, v235
  v_swap_b32 v228, v236
  v_swap_b32 v229, v237
  v_swap_b32 v230, v238
  v_swap_b32 v231, v239
  v_swap_b32 v240, v248
  v_swap_b32 v241, v249
  v_swap_b32 v242, v250
  v_swap_b32 v243, v251
  v_swap_b32 v244, v252
  v_swap_b32 v245, v253
  v_swap_b32 v246, v254
  v_swap_b32 v247, v255
PS_97:
  v_lshlrev_b32 v3, 4, v0
  v_add_u32 v4, s73, v3
  v_add_u32 v86, s86, v3
  ds_write_b128 v4, v[232:235] offset:0
  ds_write_b128 v4, v[236:239] offset:1024
  ds_write_b128 v4, v[248:251] offset:2048
  ds_write_b128 v4, v[252:255] offset:3072
  s_waitcnt lgkmcnt(0)
  s_mov_b64 s[92:93], exec
  s_mov_b64 exec, 1
  ds_add_u32 v84, v85 offset:52
  s_mov_b64 exec, s[92:93]
  v_and_b32 v3, 15, v0
  v_lshrrev_b32 v4, 4, v0
  v_lshrrev_b32 v5, 3, v3
  v_mul_u32_u24 v5, 73728, v5
  v_and_b32 v6, 7, v3
  v_lshlrev_b32 v6, 5, v6
  v_add_u32 v5, v5, v6
  v_and_b32 v6, 1, v4
  v_lshlrev_b32 v6, 8, v6
  v_add_u32 v5, v5, v6
  v_lshrrev_b32 v4, 1, v4
  v_lshlrev_b32 v4, 4, v4
  v_add_u32 v94, v5, v4
  s_mul_i32 s85, s4, 589824
  s_mul_i32 s86, s5, 9216
  s_add_u32 s85, s85, s86
  s_add_u32 s85, s85, 524288
  s_lshl_b32 s86, s3, 11
  s_add_u32 s86, s86, s85
  s_lshl_b32 s87, s81, 9
  s_add_u32 s87, s87, 8192
  s_add_u32 s87, s87, s85
  s_mul_i32 s85, s80, 294912
  s_add_u32 s87, s87, s85
  s_cmp_lg_u32 s88, 0
  s_cbranch_scc1 L_G_HAVE
  s_lshl_b32 s70, s4, 2
  s_add_u32 s70, s70, 128
  s_mov_b32 s95, 100000
L_GPOLL:
  buffer_load_dword v2, v1, s[40:43], s70 offen sc1
  s_waitcnt vmcnt(0)
  v_readfirstlane_b32 s6, v2
  s_nop 3
  s_and_b32 s7, s6, 0x0f0f0f0f
  s_lshr_b32 s85, s6, 4
  s_and_b32 s85, s85, 0x0f0f0f0f
  s_add_u32 s7, s7, s85
  s_mul_i32 s7, s7, 0x01010101
  s_lshr_b32 s7, s7, 24
  s_cmp_ge_u32 s7, 8
  s_cselect_b32 s88, 1, 0
  s_cmp_lg_u32 s88, 0
  s_cbranch_scc1 L_G_HAVE
  s_sleep 16
  s_sub_u32 s95, s95, 1
  s_cmp_lg_u32 s95, 0
  s_cbranch_scc1 L_GPOLL
L_G_HAVE:
  s_waitcnt lgkmcnt(0)
  s_mov_b64 s[92:93], exec
  s_mov_b64 exec, 1
  ds_add_u32 v84, v85 offset:56
  s_mov_b64 exec, s[92:93]
  v_cvt_pk_bf16_f32 v96, v96, v97
  v_cvt_pk_bf16_f32 v97, v98, v99
  v_cvt_pk_bf16_f32 v98, v112, v113
  v_cvt_pk_bf16_f32 v99, v114, v115
  s_nop 1
  v_permlane16_swap_b32 v96, v98
  v_permlane16_swap_b32 v97, v99
  buffer_store_dwordx4 v[96:99], v94, s[44:47], s86 offen offset:0 sc1
  v_cvt_pk_bf16_f32 v128, v128, v129
  v_cvt_pk_bf16_f32 v129, v130, v131
  v_cvt_pk_bf16_f32 v130, v144, v145
  v_cvt_pk_bf16_f32 v131, v146, v147
  s_nop 1
  v_permlane16_swap_b32 v128, v130
  v_permlane16_swap_b32 v129, v131
  buffer_store_dwordx4 v[128:131], v94, s[44:47], s86 offen offset:512 sc1
  v_cvt_pk_bf16_f32 v160, v160, v161
  v_cvt_pk_bf16_f32 v161, v162, v163
  v_cvt_pk_bf16_f32 v162, v176, v177
  v_cvt_pk_bf16_f32 v163, v178, v179
  s_nop 1
  v_permlane16_swap_b32 v160, v162
  v_permlane16_swap_b32 v161, v163
  buffer_store_dwordx4 v[160:163], v94, s[44:47], s86 offen offset:1024 sc1
  v_cvt_pk_bf16_f32 v192, v192, v193
  v_cvt_pk_bf16_f32 v193, v194, v195
  v_cvt_pk_bf16_f32 v194, v208, v209
  v_cvt_pk_bf16_f32 v195, v210, v211
  s_nop 1
  v_permlane16_swap_b32 v192, v194
  v_permlane16_swap_b32 v193, v195
  buffer_store_dwordx4 v[192:195], v94, s[44:47], s86 offen offset:1536 sc1
  s_add_u32 s86, s86, 147456
  v_cvt_pk_bf16_f32 v100, v100, v101
  v_cvt_pk_bf16_f32 v101, v102, v103
  v_cvt_pk_bf16_f32 v102, v116, v117
  v_cvt_pk_bf16_f32 v103, v118, v119
  s_nop 1
  v_permlane16_swap_b32 v100, v102
  v_permlane16_swap_b32 v101, v103
  buffer_store_dwordx4 v[100:103], v94, s[44:47], s86 offen offset:0 sc1
  v_cvt_pk_bf16_f32 v132, v132, v133
  v_cvt_pk_bf16_f32 v133, v134, v135
  v_cvt_pk_bf16_f32 v134, v148, v149
  v_cvt_pk_bf16_f32 v135, v150, v151
  s_nop 1
  v_permlane16_swap_b32 v132, v134
  v_permlane16_swap_b32 v133, v135
  buffer_store_dwordx4 v[132:135], v94, s[44:47], s86 offen offset:512 sc1
  v_cvt_pk_bf16_f32 v164, v164, v165
  v_cvt_pk_bf16_f32 v165, v166, v167
  v_cvt_pk_bf16_f32 v166, v180, v181
  v_cvt_pk_bf16_f32 v167, v182, v183
  s_nop 1
  v_permlane16_swap_b32 v164, v166
  v_permlane16_swap_b32 v165, v167
  buffer_store_dwordx4 v[164:167], v94, s[44:47], s86 offen offset:1024 sc1
  v_cvt_pk_bf16_f32 v196, v196, v197
  v_cvt_pk_bf16_f32 v197, v198, v199
  v_cvt_pk_bf16_f32 v198, v212, v213
  v_cvt_pk_bf16_f32 v199, v214, v215
  s_nop 1
  v_permlane16_swap_b32 v196, v198
  v_permlane16_swap_b32 v197, v199
  buffer_store_dwordx4 v[196:199], v94, s[44:47], s86 offen offset:1536 sc1
  s_add_u32 s86, s86, 147456
  v_cvt_pk_bf16_f32 v104, v104, v105
  v_cvt_pk_bf16_f32 v105, v106, v107
  v_cvt_pk_bf16_f32 v106, v120, v121
  v_cvt_pk_bf16_f32 v107, v122, v123
  s_nop 1
  v_permlane16_swap_b32 v104, v106
  v_permlane16_swap_b32 v105, v107
  buffer_store_dwordx4 v[104:107], v94, s[44:47], s86 offen offset:0 sc1
  v_cvt_pk_bf16_f32 v136, v136, v137
  v_cvt_pk_bf16_f32 v137, v138, v139
  v_cvt_pk_bf16_f32 v138, v152, v153
  v_cvt_pk_bf16_f32 v139, v154, v155
  s_nop 1
  v_permlane16_swap_b32 v136, v138
  v_permlane16_swap_b32 v137, v139
  buffer_store_dwordx4 v[136:139], v94, s[44:47], s86 offen offset:512 sc1
  v_cvt_pk_bf16_f32 v168, v168, v169
  v_cvt_pk_bf16_f32 v169, v170, v171
  v_cvt_pk_bf16_f32 v170, v184, v185
  v_cvt_pk_bf16_f32 v171, v186, v187
  s_nop 1
  v_permlane16_swap_b32 v168, v170
  v_permlane16_swap_b32 v169, v171
  buffer_store_dwordx4 v[168:171], v94, s[44:47], s86 offen offset:1024 sc1
  v_cvt_pk_bf16_f32 v200, v200, v201
  v_cvt_pk_bf16_f32 v201, v202, v203
  v_cvt_pk_bf16_f32 v202, v216, v217
  v_cvt_pk_bf16_f32 v203, v218, v219
  s_nop 1
  v_permlane16_swap_b32 v200, v202
  v_permlane16_swap_b32 v201, v203
  buffer_store_dwordx4 v[200:203], v94, s[44:47], s86 offen offset:1536 sc1
  s_add_u32 s86, s86, 147456
  v_cvt_pk_bf16_f32 v108, v108, v109
  v_cvt_pk_bf16_f32 v109, v110, v111
  v_cvt_pk_bf16_f32 v110, v124, v125
  v_cvt_pk_bf16_f32 v111, v126, v127
  s_nop 1
  v_permlane16_swap_b32 v108, v110
  v_permlane16_swap_b32 v109, v111
  buffer_store_dwordx4 v[108:111], v94, s[44:47], s86 offen offset:0 sc1
  v_cvt_pk_bf16_f32 v140, v140, v141
  v_cvt_pk_bf16_f32 v141, v142, v143
  v_cvt_pk_bf16_f32 v142, v156, v157
  v_cvt_pk_bf16_f32 v143, v158, v159
  s_nop 1
  v_permlane16_swap_b32 v140, v142
  v_permlane16_swap_b32 v141, v143
  buffer_store_dwordx4 v[140:143], v94, s[44:47], s86 offen offset:512 sc1
  v_cvt_pk_bf16_f32 v172, v172, v173
  v_cvt_pk_bf16_f32 v173, v174, v175
  v_cvt_pk_bf16_f32 v174, v188, v189
  v_cvt_pk_bf16_f32 v175, v190, v191
  s_nop 1
  v_permlane16_swap_b32 v172, v174
  v_permlane16_swap_b32 v173, v175
  buffer_store_dwordx4 v[172:175], v94, s[44:47], s86 offen offset:1024 sc1
  v_cvt_pk_bf16_f32 v204, v204, v205
  v_cvt_pk_bf16_f32 v205, v206, v207
  v_cvt_pk_bf16_f32 v206, v220, v221
  v_cvt_pk_bf16_f32 v207, v222, v223
  s_nop 1
  v_permlane16_swap_b32 v204, v206
  v_permlane16_swap_b32 v205, v207
  buffer_store_dwordx4 v[204:207], v94, s[44:47], s86 offen offset:1536 sc1
  s_mov_b32 s95, 400000
W_99:
  ds_read_b32 v3, v84 offset:52
  s_waitcnt lgkmcnt(0)
  v_readfirstlane_b32 s6, v3
  s_nop 3
  s_cmp_ge_u32 s6, 8
  s_cbranch_scc1 WD_100
  s_sleep 1
  s_sub_u32 s95, s95, 1
  s_cmp_lg_u32 s95, 0
  s_cbranch_scc1 W_99
WD_100:
  ds_read_b128 v[232:235], v86 offset:0
  ds_read_b128 v[236:239], v86 offset:1024
  ds_read_b128 v[248:251], v86 offset:2048
  ds_read_b128 v[252:255], v86 offset:3072
  s_waitcnt lgkmcnt(0)
  v_add_f32 v224, v224, v232
  v_add_f32 v225, v225, v233
  v_add_f32 v226, v226, v234
  v_add_f32 v227, v227, v235
  v_add_f32 v228, v228, v236
  v_add_f32 v229, v229, v237
  v_add_f32 v230, v230, v238
  v_add_f32 v231, v231, v239
  v_add_f32 v240, v240, v248
  v_add_f32 v241, v241, v249
  v_add_f32 v242, v242, v250
  v_add_f32 v243, v243, v251
  v_add_f32 v244, v244, v252
  v_add_f32 v245, v245, v253
  v_add_f32 v246, v246, v254
  v_add_f32 v247, v247, v255
  v_cvt_pk_bf16_f32 v224, v224, v225
  v_cvt_pk_bf16_f32 v225, v226, v227
  v_cvt_pk_bf16_f32 v226, v240, v241
  v_cvt_pk_bf16_f32 v227, v242, v243
  s_nop 1
  v_permlane16_swap_b32 v224, v226
  v_permlane16_swap_b32 v225, v227
  buffer_store_dwordx4 v[224:227], v94, s[44:47], s87 offen offset:0 sc1
  s_add_u32 s87, s87, 147456
  v_cvt_pk_bf16_f32 v228, v228, v229
  v_cvt_pk_bf16_f32 v229, v230, v231
  v_cvt_pk_bf16_f32 v230, v244, v245
  v_cvt_pk_bf16_f32 v231, v246, v247
  s_nop 1
  v_permlane16_swap_b32 v228, v230
  v_permlane16_swap_b32 v229, v231
  buffer_store_dwordx4 v[228:231], v94, s[44:47], s87 offen offset:0 sc1
  s_waitcnt vmcnt(0)
  s_mov_b64 exec, 1
  ds_add_rtn_u32 v3, v84, v85 offset:36
  s_waitcnt lgkmcnt(0)
  v_readfirstlane_b32 s6, v3
  s_mov_b64 exec, -1
  s_nop 3
  s_cmp_lg_u32 s6, 3
  s_cbranch_scc1 SK_98
  s_lshl_b32 s6, s4, 13
  s_lshl_b32 s7, s5, 7
  s_add_u32 s6, s6, s7
  s_add_u32 s6, s6, 262144
  v_lshrrev_b32 v3, 3, v0
  v_lshlrev_b32 v3, 10, v3
  v_and_b32 v5, 7, v0
  v_lshlrev_b32 v5, 4, v5
  v_add_u32 v3, v3, v5
  v_mov_b32 v4, 1
  v_mov_b32 v5, 1
  v_mov_b32 v6, 1
  v_mov_b32 v7, 1
  buffer_store_dwordx4 v[4:7], v3, s[44:47], s6 offen sc1
  s_lshl_b32 s6, s4, 3
  s_add_u32 s6, s6, s5
  s_lshl_b32 s6, s6, 10
  s_add_u32 s6, s6, 262144
  v_and_b32 v3, 7, v0
  v_lshlrev_b32 v4, 2, v3
  v_add_u32 v4, 163712, v4
  v_lshlrev_b32 v3, 7, v3
  s_mov_b32 s95, 200000
L_FPOLL1:
  buffer_load_dword v5, v3, s[44:47], s6 offen sc1
  s_waitcnt vmcnt(0)
  ds_write_b32 v4, v5
  v_cmp_ne_u32 vcc, 1, v5
  s_nop 3
  s_cmp_eq_u64 vcc, 0
  s_cbranch_scc1 SK_98
  s_sleep 2
  s_sub_u32 s95, s95, 1
  s_cmp_lg_u32 s95, 0
  s_cbranch_scc1 L_FPOLL1
SK_98:
  s_waitcnt vmcnt(0) lgkmcnt(0)
  s_branch L_END
GA_3:
  s_getreg_b32 s6, hwreg(HW_REG_XCC_ID, 0, 3)
  s_lshl_b32 s6, s6, 2
  s_lshl_b32 s6, 1, s6
  v_mov_b32 v2, s6
  s_lshl_b32 s7, s4, 2
  s_add_u32 s7, s7, 128
  v_mov_b32 v1, 0
  s_mov_b64 exec, 1
  buffer_atomic_add v2, v1, s[40:43], s7 offen sc1
  s_mov_b64 exec, -1
  s_branch GR_4
GA_8:
  s_getreg_b32 s6, hwreg(HW_REG_XCC_ID, 0, 3)
  s_lshl_b32 s6, s6, 2
  s_lshl_b32 s6, 1, s6
  v_mov_b32 v2, s6
  s_lshl_b32 s7, s4, 2
  s_add_u32 s7, s7, 128
  v_mov_b32 v1, 0
  s_mov_b64 exec, 1
  buffer_atomic_add v2, v1, s[40:43], s7 offen sc1
  s_mov_b64 exec, -1
  s_branch GR_9
GA_10:
  s_getreg_b32 s6, hwreg(HW_REG_XCC_ID, 0, 3)
  s_lshl_b32 s6, s6, 2
  s_lshl_b32 s6, 1, s6
  v_mov_b32 v2, s6
  s_lshl_b32 s7, s4, 2
  s_add_u32 s7, s7, 128
  v_mov_b32 v1, 0
  s_mov_b64 exec, 1
  buffer_atomic_add v2, v1, s[40:43], s7 offen sc1
  s_mov_b64 exec, -1
  s_branch GR_11
GA_12:
  s_getreg_b32 s6, hwreg(HW_REG_XCC_ID, 0, 3)
  s_lshl_b32 s6, s6, 2
  s_lshl_b32 s6, 1, s6
  v_mov_b32 v2, s6
  s_lshl_b32 s7, s4, 2
  s_add_u32 s7, s7, 128
  v_mov_b32 v1, 0
  s_mov_b64 exec, 1
  buffer_atomic_add v2, v1, s[40:43], s7 offen sc1
  s_mov_b64 exec, -1
  s_branch GR_13
GA_14:
  s_getreg_b32 s6, hwreg(HW_REG_XCC_ID, 0, 3)
  s_lshl_b32 s6, s6, 2
  s_lshl_b32 s6, 1, s6
  v_mov_b32 v2, s6
  s_lshl_b32 s7, s4, 2
  s_add_u32 s7, s7, 128
  v_mov_b32 v1, 0
  s_mov_b64 exec, 1
  buffer_atomic_add v2, v1, s[40:43], s7 offen sc1
  s_mov_b64 exec, -1
  s_branch GR_15
GA_16:
  s_getreg_b32 s6, hwreg(HW_REG_XCC_ID, 0, 3)
  s_lshl_b32 s6, s6, 2
  s_lshl_b32 s6, 1, s6
  v_mov_b32 v2, s6
  s_lshl_b32 s7, s4, 2
  s_add_u32 s7, s7, 128
  v_mov_b32 v1, 0
  s_mov_b64 exec, 1
  buffer_atomic_add v2, v1, s[40:43], s7 offen sc1
  s_mov_b64 exec, -1
  s_branch GR_17
GA_21:
  s_getreg_b32 s6, hwreg(HW_REG_XCC_ID, 0, 3)
  s_lshl_b32 s6, s6, 2
  s_lshl_b32 s6, 1, s6
  v_mov_b32 v2, s6
  s_lshl_b32 s7, s4, 2
  s_add_u32 s7, s7, 128
  v_mov_b32 v1, 0
  s_mov_b64 exec, 1
  buffer_atomic_add v2, v1, s[40:43], s7 offen sc1
  s_mov_b64 exec, -1
  s_branch GR_22
GA_23:
  s_getreg_b32 s6, hwreg(HW_REG_XCC_ID, 0, 3)
  s_lshl_b32 s6, s6, 2
  s_lshl_b32 s6, 1, s6
  v_mov_b32 v2, s6
  s_lshl_b32 s7, s4, 2
  s_add_u32 s7, s7, 128
  v_mov_b32 v1, 0
  s_mov_b64 exec, 1
  buffer_atomic_add v2, v1, s[40:43], s7 offen sc1
  s_mov_b64 exec, -1
  s_branch GR_24
GA_25:
  s_getreg_b32 s6, hwreg(HW_REG_XCC_ID, 0, 3)
  s_lshl_b32 s6, s6, 2
  s_lshl_b32 s6, 1, s6
  v_mov_b32 v2, s6
  s_lshl_b32 s7, s4, 2
  s_add_u32 s7, s7, 128
  v_mov_b32 v1, 0
  s_mov_b64 exec, 1
  buffer_atomic_add v2, v1, s[40:43], s7 offen sc1
  s_mov_b64 exec, -1
  s_branch GR_26
GA_27:
  s_getreg_b32 s6, hwreg(HW_REG_XCC_ID, 0, 3)
  s_lshl_b32 s6, s6, 2
  s_lshl_b32 s6, 1, s6
  v_mov_b32 v2, s6
  s_lshl_b32 s7, s4, 2
  s_add_u32 s7, s7, 128
  v_mov_b32 v1, 0
  s_mov_b64 exec, 1
  buffer_atomic_add v2, v1, s[40:43], s7 offen sc1
  s_mov_b64 exec, -1
  s_branch GR_28
GA_29:
  s_getreg_b32 s6, hwreg(HW_REG_XCC_ID, 0, 3)
  s_lshl_b32 s6, s6, 2
  s_lshl_b32 s6, 1, s6
  v_mov_b32 v2, s6
  s_lshl_b32 s7, s4, 2
  s_add_u32 s7, s7, 128
  v_mov_b32 v1, 0
  s_mov_b64 exec, 1
  buffer_atomic_add v2, v1, s[40:43], s7 offen sc1
  s_mov_b64 exec, -1
  s_branch GR_30
GA_34:
  s_getreg_b32 s6, hwreg(HW_REG_XCC_ID, 0, 3)
  s_lshl_b32 s6, s6, 2
  s_lshl_b32 s6, 1, s6
  v_mov_b32 v2, s6
  s_lshl_b32 s7, s4, 2
  s_add_u32 s7, s7, 128
  v_mov_b32 v1, 0
  s_mov_b64 exec, 1
  buffer_atomic_add v2, v1, s[40:43], s7 offen sc1
  s_mov_b64 exec, -1
  s_branch GR_35
GA_36:
  s_getreg_b32 s6, hwreg(HW_REG_XCC_ID, 0, 3)
  s_lshl_b32 s6, s6, 2
  s_lshl_b32 s6, 1, s6
  v_mov_b32 v2, s6
  s_lshl_b32 s7, s4, 2
  s_add_u32 s7, s7, 128
  v_mov_b32 v1, 0
  s_mov_b64 exec, 1
  buffer_atomic_add v2, v1, s[40:43], s7 offen sc1
  s_mov_b64 exec, -1
  s_branch GR_37
GA_38:
  s_getreg_b32 s6, hwreg(HW_REG_XCC_ID, 0, 3)
  s_lshl_b32 s6, s6, 2
  s_lshl_b32 s6, 1, s6
  v_mov_b32 v2, s6
  s_lshl_b32 s7, s4, 2
  s_add_u32 s7, s7, 128
  v_mov_b32 v1, 0
  s_mov_b64 exec, 1
  buffer_atomic_add v2, v1, s[40:43], s7 offen sc1
  s_mov_b64 exec, -1
  s_branch GR_39
GA_40:
  s_getreg_b32 s6, hwreg(HW_REG_XCC_ID, 0, 3)
  s_lshl_b32 s6, s6, 2
  s_lshl_b32 s6, 1, s6
  v_mov_b32 v2, s6
  s_lshl_b32 s7, s4, 2
  s_add_u32 s7, s7, 128
  v_mov_b32 v1, 0
  s_mov_b64 exec, 1
  buffer_atomic_add v2, v1, s[40:43], s7 offen sc1
  s_mov_b64 exec, -1
  s_branch GR_41
GA_42:
  s_getreg_b32 s6, hwreg(HW_REG_XCC_ID, 0, 3)
  s_lshl_b32 s6, s6, 2
  s_lshl_b32 s6, 1, s6
  v_mov_b32 v2, s6
  s_lshl_b32 s7, s4, 2
  s_add_u32 s7, s7, 128
  v_mov_b32 v1, 0
  s_mov_b64 exec, 1
  buffer_atomic_add v2, v1, s[40:43], s7 offen sc1
  s_mov_b64 exec, -1
  s_branch GR_43
GA_47:
  s_getreg_b32 s6, hwreg(HW_REG_XCC_ID, 0, 3)
  s_lshl_b32 s6, s6, 2
  s_lshl_b32 s6, 1, s6
  v_mov_b32 v2, s6
  s_lshl_b32 s7, s4, 2
  s_add_u32 s7, s7, 128
  v_mov_b32 v1, 0
  s_mov_b64 exec, 1
  buffer_atomic_add v2, v1, s[40:43], s7 offen sc1
  s_mov_b64 exec, -1
  s_branch GR_48
GA_49:
  s_getreg_b32 s6, hwreg(HW_REG_XCC_ID, 0, 3)
  s_lshl_b32 s6, s6, 2
  s_lshl_b32 s6, 1, s6
  v_mov_b32 v2, s6
  s_lshl_b32 s7, s4, 2
  s_add_u32 s7, s7, 128
  v_mov_b32 v1, 0
  s_mov_b64 exec, 1
  buffer_atomic_add v2, v1, s[40:43], s7 offen sc1
  s_mov_b64 exec, -1
  s_branch GR_50
GA_51:
  s_getreg_b32 s6, hwreg(HW_REG_XCC_ID, 0, 3)
  s_lshl_b32 s6, s6, 2
  s_lshl_b32 s6, 1, s6
  v_mov_b32 v2, s6
  s_lshl_b32 s7, s4, 2
  s_add_u32 s7, s7, 128
  v_mov_b32 v1, 0
  s_mov_b64 exec, 1
  buffer_atomic_add v2, v1, s[40:43], s7 offen sc1
  s_mov_b64 exec, -1
  s_branch GR_52
GA_53:
  s_getreg_b32 s6, hwreg(HW_REG_XCC_ID, 0, 3)
  s_lshl_b32 s6, s6, 2
  s_lshl_b32 s6, 1, s6
  v_mov_b32 v2, s6
  s_lshl_b32 s7, s4, 2
  s_add_u32 s7, s7, 128
  v_mov_b32 v1, 0
  s_mov_b64 exec, 1
  buffer_atomic_add v2, v1, s[40:43], s7 offen sc1
  s_mov_b64 exec, -1
  s_branch GR_54
GA_55:
  s_getreg_b32 s6, hwreg(HW_REG_XCC_ID, 0, 3)
  s_lshl_b32 s6, s6, 2
  s_lshl_b32 s6, 1, s6
  v_mov_b32 v2, s6
  s_lshl_b32 s7, s4, 2
  s_add_u32 s7, s7, 128
  v_mov_b32 v1, 0
  s_mov_b64 exec, 1
  buffer_atomic_add v2, v1, s[40:43], s7 offen sc1
  s_mov_b64 exec, -1
  s_branch GR_56
GA_60:
  s_getreg_b32 s6, hwreg(HW_REG_XCC_ID, 0, 3)
  s_lshl_b32 s6, s6, 2
  s_lshl_b32 s6, 1, s6
  v_mov_b32 v2, s6
  s_lshl_b32 s7, s4, 2
  s_add_u32 s7, s7, 128
  v_mov_b32 v1, 0
  s_mov_b64 exec, 1
  buffer_atomic_add v2, v1, s[40:43], s7 offen sc1
  s_mov_b64 exec, -1
  s_branch GR_61
GA_62:
  s_getreg_b32 s6, hwreg(HW_REG_XCC_ID, 0, 3)
  s_lshl_b32 s6, s6, 2
  s_lshl_b32 s6, 1, s6
  v_mov_b32 v2, s6
  s_lshl_b32 s7, s4, 2
  s_add_u32 s7, s7, 128
  v_mov_b32 v1, 0
  s_mov_b64 exec, 1
  buffer_atomic_add v2, v1, s[40:43], s7 offen sc1
  s_mov_b64 exec, -1
  s_branch GR_63
GA_64:
  s_getreg_b32 s6, hwreg(HW_REG_XCC_ID, 0, 3)
  s_lshl_b32 s6, s6, 2
  s_lshl_b32 s6, 1, s6
  v_mov_b32 v2, s6
  s_lshl_b32 s7, s4, 2
  s_add_u32 s7, s7, 128
  v_mov_b32 v1, 0
  s_mov_b64 exec, 1
  buffer_atomic_add v2, v1, s[40:43], s7 offen sc1
  s_mov_b64 exec, -1
  s_branch GR_65
GA_66:
  s_getreg_b32 s6, hwreg(HW_REG_XCC_ID, 0, 3)
  s_lshl_b32 s6, s6, 2
  s_lshl_b32 s6, 1, s6
  v_mov_b32 v2, s6
  s_lshl_b32 s7, s4, 2
  s_add_u32 s7, s7, 128
  v_mov_b32 v1, 0
  s_mov_b64 exec, 1
  buffer_atomic_add v2, v1, s[40:43], s7 offen sc1
  s_mov_b64 exec, -1
  s_branch GR_67
GA_68:
  s_getreg_b32 s6, hwreg(HW_REG_XCC_ID, 0, 3)
  s_lshl_b32 s6, s6, 2
  s_lshl_b32 s6, 1, s6
  v_mov_b32 v2, s6
  s_lshl_b32 s7, s4, 2
  s_add_u32 s7, s7, 128
  v_mov_b32 v1, 0
  s_mov_b64 exec, 1
  buffer_atomic_add v2, v1, s[40:43], s7 offen sc1
  s_mov_b64 exec, -1
  s_branch GR_69
GA_73:
  s_getreg_b32 s6, hwreg(HW_REG_XCC_ID, 0, 3)
  s_lshl_b32 s6, s6, 2
  s_lshl_b32 s6, 1, s6
  v_mov_b32 v2, s6
  s_lshl_b32 s7, s4, 2
  s_add_u32 s7, s7, 128
  v_mov_b32 v1, 0
  s_mov_b64 exec, 1
  buffer_atomic_add v2, v1, s[40:43], s7 offen sc1
  s_mov_b64 exec, -1
  s_branch GR_74
GA_75:
  s_getreg_b32 s6, hwreg(HW_REG_XCC_ID, 0, 3)
  s_lshl_b32 s6, s6, 2
  s_lshl_b32 s6, 1, s6
  v_mov_b32 v2, s6
  s_lshl_b32 s7, s4, 2
  s_add_u32 s7, s7, 128
  v_mov_b32 v1, 0
  s_mov_b64 exec, 1
  buffer_atomic_add v2, v1, s[40:43], s7 offen sc1
  s_mov_b64 exec, -1
  s_branch GR_76
L_AWAVE:
  s_setprio 1
  s_mov_b32 s8, s48
  s_and_b32 s9, s49, 0xffff
  s_mov_b32 s10, 2359296
  s_mov_b32 s11, 0x20000
  s_sub_u32 s78, s3, 4
  s_and_b32 s79, s78, 1
  s_lshr_b32 s80, s78, 1
  v_lshrrev_b32 v10, 3, v0
  v_mul_u32_u24 v10, 1152, v10
  v_lshrrev_b32 v11, 4, v0
  v_and_b32 v12, 7, v0
  v_xor_b32 v13, v11, v12
  v_lshlrev_b32 v13, 4, v13
  v_add_u32 v246, v10, v13
  v_add_u32 v11, 4, v11
  v_and_b32 v11, 7, v11
  v_xor_b32 v13, v11, v12
  v_lshlrev_b32 v13, 4, v13
  v_add_u32 v247, v10, v13
  s_lshl_b32 s6, s4, 2
  s_add_u32 s6, s6, s78
  s_mul_i32 s76, s6, 18432
  s_add_u32 s77, s76, 9216
  s_mul_i32 s74, s78, 18432
  v_mul_u32_u24 v248, 1152, v0
  s_mul_i32 s61, s4, 73728
  s_lshl_b32 s7, s78, 7
  s_add_u32 s61, s61, s7
  v_mov_b32 v245, 163584
  v_mov_b32 v244, 1
  s_cmp_eq_u32 s78, 3
  s_cbranch_scc1 L_A3
  s_mov_b32 s12, s50
  s_and_b32 s13, s51, 0xffff
  s_mov_b32 s14, 663552
  s_mov_b32 s15, 0x20000
  s_mov_b32 s32, s64
  s_and_b32 s33, s65, 0xffff
  s_mov_b32 s34, 1152
  s_mov_b32 s35, 0x20000
  v_lshlrev_b32 v84, 4, v0
  s_cmp_lg_u32 s78, 0
  s_cbranch_scc1 L_NOPFQ
  v_lshrrev_b32 v10, 1, v0
  s_mul_i32 s6, s4, 18
  v_add_u32 v10, s6, v10
  v_mul_u32_u24 v10, 1152, v10
  v_and_b32 v11, 1, v0
  v_lshlrev_b32 v11, 7, v11
  v_add_u32 v10, v10, v11
  v_mov_b32 v11, 268435456
  v_cmp_gt_u32 vcc, 36, v0
  s_mul_i32 s6, s5, 144
  s_and_b32 s6, s6, 0xffffff80
  v_cndmask_b32 v10, v11, v10, vcc
  buffer_load_dword v253, v10, s[12:15], s6 offen
L_NOPFQ:
  s_add_u32 m0, s74, 0
  s_nop 0
  buffer_load_dwordx4 v246, s[8:11], s76 offen offset:0 lds
  s_add_u32 m0, s74, 9216
  s_nop 0
  buffer_load_dwordx4 v247, s[8:11], s77 offen offset:0 lds
  s_add_u32 m0, s74, 896
  s_nop 0
  buffer_load_dwordx4 v246, s[8:11], s76 offen offset:128 lds
  s_add_u32 m0, s74, 10112
  s_nop 0
  buffer_load_dwordx4 v247, s[8:11], s77 offen offset:128 lds
  s_add_u32 m0, s74, 1792
  s_nop 0
  buffer_load_dwordx4 v246, s[8:11], s76 offen offset:256 lds
  s_add_u32 m0, s74, 11008
  s_nop 0
  buffer_load_dwordx4 v247, s[8:11], s77 offen offset:256 lds
  s_mov_b32 s40, s68
  s_and_b32 s41, s69, 0xffff
  s_mov_b32 s42, 256
  s_mov_b32 s43, 0x20000
  v_and_b32 v3, 31, v0
  v_lshrrev_b32 v4, 5, v0
  v_lshrrev_b32 v5, 3, v3
  v_mul_u32_u24 v5, 9216, v5
  v_and_b32 v6, 7, v3
  v_lshlrev_b32 v6, 7, v6
  v_add_u32 v5, v5, v6
  v_lshrrev_b32 v6, 1, v3
  v_and_b32 v6, 7, v6
  v_add_u32 v7, 0, v4
  v_xor_b32 v7, v7, v6
  v_lshlrev_b32 v7, 4, v7
  v_add_u32 v76, v5, v7
  v_add_u32 v7, 2, v4
  v_xor_b32 v7, v7, v6
  v_lshlrev_b32 v7, 4, v7
  v_add_u32 v77, v5, v7
  v_add_u32 v7, 4, v4
  v_xor_b32 v7, v7, v6
  v_lshlrev_b32 v7, 4, v7
  v_add_u32 v78, v5, v7
  v_add_u32 v7, 6, v4
  v_xor_b32 v7, v7, v6
  v_lshlrev_b32 v7, 4, v7
  v_add_u32 v79, v5, v7
  v_and_b32 v10, 15, v0
  v_lshrrev_b32 v11, 4, v0
  v_lshrrev_b32 v12, 1, v11
  v_lshlrev_b32 v8, 3, v12
  v_lshrrev_b32 v12, 2, v10
  v_add_u32 v8, v8, v12
  v_and_b32 v11, 1, v11
  v_lshlrev_b32 v11, 5, v11
  v_and_b32 v10, 3, v10
  v_lshlrev_b32 v10, 3, v10
  v_add_u32 v9, v10, v11
  s_lshl_b32 s83, s78, 12
  s_add_u32 s83, s83, 139264
  v_lshlrev_b32 v10, 4, v0
  v_add_u32 v80, s83, v10
  v_lshlrev_b32 v11, 6, v8
  v_add_u32 v11, v11, v9
  v_add_u32 v81, s83, v11
  v_lshlrev_b32 v11, 4, v4
  v_add_u32 v82, 156736, v11
  s_sub_u32 s6, 8, s5
  s_cmp_lt_u32 s5, 4
  s_cbranch_scc0 L_QW_HI
  s_mov_b32 s62, 0
  s_mov_b32 s63, 4
  s_cmp_eq_u32 s78, 0
  s_cbranch_scc1 L_QW_SET
  s_mov_b32 s62, 4
  s_sub_u32 s63, s6, 4
  s_cmp_eq_u32 s78, 1
  s_cbranch_scc1 L_QW_SET
  s_mov_b32 s62, s6
  s_sub_u32 s63, 9, s6
  s_branch L_QW_SET
L_QW_HI:
  s_mov_b32 s62, 0
  s_mov_b32 s63, s6
  s_cmp_eq_u32 s78, 0
  s_cbranch_scc1 L_QW_SET
  s_mov_b32 s62, s6
  s_mov_b32 s63, 4
  s_cmp_eq_u32 s78, 1
  s_cbranch_scc1 L_QW_SET
  s_add_u32 s62, s6, 4
  s_sub_u32 s63, 5, s6
L_QW_SET:
  s_mov_b32 s7, 2
  s_and_b32 s6, s5, 3
  s_cmp_ge_u32 s6, 2
  s_cselect_b32 s7, 1, s7
  s_cmp_ge_u32 s5, 6
  s_cselect_b32 s7, 0, s7
  s_cmp_eq_u32 s7, s78
  s_cselect_b32 s57, 1, 0
  v_lshrrev_b32 v11, 2, v0
  v_mul_u32_u24 v11, 1152, v11
  v_and_b32 v12, 3, v0
  v_add_u32 v13, s62, v12
  v_lshlrev_b32 v13, 4, v13
  v_add_u32 v11, v11, v13
  s_mul_i32 s84, s5, 144
  v_add_u32 v83, s84, v11
  v_cmp_le_u32 vcc, s63, v12
  v_mov_b32 v13, 268435456
  v_cmp_lt_u32 s[82:83], 15, v3
  v_cndmask_b32 v83, v83, v13, vcc
  s_nop 3
  s_cmp_eq_u32 s57, 1
  s_cselect_b64 s[82:83], s[82:83], 0
  s_mov_b32 s72, 0
  s_waitcnt vmcnt(4)
  s_mov_b64 exec, 1
  ds_add_u32 v245, v244 offset:64
  s_mov_b64 exec, -1
  s_add_u32 m0, s74, 2688
  s_nop 0
  buffer_load_dwordx4 v246, s[8:11], s76 offen offset:384 lds
  s_add_u32 m0, s74, 11904
  s_nop 0
  buffer_load_dwordx4 v247, s[8:11], s77 offen offset:384 lds
  s_waitcnt vmcnt(4)
  s_mov_b64 exec, 1
  ds_add_u32 v245, v244 offset:68
  s_mov_b64 exec, -1
  s_add_u32 m0, s74, 3584
  s_nop 0
  buffer_load_dwordx4 v246, s[8:11], s76 offen offset:512 lds
  s_add_u32 m0, s74, 12800
  s_nop 0
  buffer_load_dwordx4 v247, s[8:11], s77 offen offset:512 lds
  s_waitcnt vmcnt(4)
  s_mov_b64 exec, 1
  ds_add_u32 v245, v244 offset:72
  s_mov_b64 exec, -1
  s_add_u32 m0, s74, 4480
  s_nop 0
  buffer_load_dwordx4 v246, s[8:11], s76 offen offset:640 lds
  s_add_u32 m0, s74, 13696
  s_nop 0
  buffer_load_dwordx4 v247, s[8:11], s77 offen offset:640 lds
  s_waitcnt vmcnt(4)
  s_mov_b64 exec, 1
  ds_add_u32 v245, v244 offset:76
  s_mov_b64 exec, -1
  s_add_u32 m0, s74, 5376
  s_nop 0
  buffer_load_dwordx4 v246, s[8:11], s76 offen offset:768 lds
  s_add_u32 m0, s74, 14592
  s_nop 0
  buffer_load_dwordx4 v247, s[8:11], s77 offen offset:768 lds
  s_waitcnt vmcnt(4)
  s_mov_b64 exec, 1
  ds_add_u32 v245, v244 offset:80
  s_mov_b64 exec, -1
  s_add_u32 m0, s74, 6272
  s_nop 0
  buffer_load_dwordx4 v246, s[8:11], s76 offen offset:896 lds
  s_add_u32 m0, s74, 15488
  s_nop 0
  buffer_load_dwordx4 v247, s[8:11], s77 offen offset:896 lds
  s_waitcnt vmcnt(4)
  s_mov_b64 exec, 1
  ds_add_u32 v245, v244 offset:84
  s_mov_b64 exec, -1
  s_mov_b32 m0, 156736
  s_nop 0
  buffer_load_dwordx4 v84, s[32:35], 0 offen lds
  s_mov_b32 m0, 156736
  s_nop 0
  buffer_load_dwordx4 v84, s[32:35], 0 offen offset:1024 lds
  s_add_u32 m0, s74, 7168
  s_nop 0
  buffer_load_dwordx4 v246, s[8:11], s76 offen offset:1024 lds
  s_add_u32 m0, s74, 16384
  s_nop 0
  buffer_load_dwordx4 v247, s[8:11], s77 offen offset:1024 lds
  s_waitcnt vmcnt(6)
  s_mov_b64 exec, 1
  ds_add_u32 v245, v244 offset:88
  s_mov_b64 exec, -1
  s_waitcnt vmcnt(4)
  s_mov_b64 exec, 1
  ds_add_u32 v245, v244 offset:92
  s_mov_b64 exec, -1
  s_waitcnt vmcnt(0)
  s_mov_b64 exec, 1
  ds_add_u32 v245, v244 offset:96
  s_mov_b64 exec, -1
  buffer_load_dwordx4 v[96:99], v83, s[12:15], s72 offen
  s_add_u32 s72, s72, 18432
  buffer_load_dwordx4 v[100:103], v83, s[12:15], s72 offen
  s_add_u32 s72, s72, 18432
  buffer_load_dwordx4 v[104:107], v83, s[12:15], s72 offen
  s_add_u32 s72, s72, 18432
  buffer_load_dwordx4 v[108:111], v83, s[12:15], s72 offen
  s_add_u32 s72, s72, 18432
  buffer_load_dwordx4 v[112:115], v83, s[12:15], s72 offen
  s_add_u32 s72, s72, 18432
  buffer_load_dwordx4 v[116:119], v83, s[12:15], s72 offen
  s_add_u32 s72, s72, 18432
  buffer_load_dwordx4 v[120:123], v83, s[12:15], s72 offen
  s_add_u32 s72, s72, 18432
  buffer_load_dwordx4 v[124:127], v83, s[12:15], s72 offen
  s_add_u32 s72, s72, 18432
  buffer_load_dwordx4 v[128:131], v83, s[12:15], s72 offen
  s_add_u32 s72, s72, 18432
  buffer_load_dwordx4 v[132:135], v83, s[12:15], s72 offen
  s_add_u32 s72, s72, 18432
  buffer_load_dwordx4 v[136:139], v83, s[12:15], s72 offen
  s_add_u32 s72, s72, 18432
  buffer_load_dwordx4 v[140:143], v83, s[12:15], s72 offen
  s_add_u32 s72, s72, 18432
  s_setprio 3
  s_waitcnt vmcnt(11)
  ds_write_b128 v80, v[96:99] offset:0
  s_waitcnt vmcnt(10)
  ds_write_b128 v80, v[100:103] offset:1024
  s_waitcnt vmcnt(9)
  ds_write_b128 v80, v[104:107] offset:2048
  s_mov_b32 s95, 400000
W_101:
  ds_read_b32 v14, v245 offset:96
  s_waitcnt lgkmcnt(0)
  v_readfirstlane_b32 s6, v14
  s_nop 3
  s_cmp_ge_u32 s6, 4
  s_cbranch_scc1 WD_102
  s_sleep 1
  s_sub_u32 s95, s95, 1
  s_cmp_lg_u32 s95, 0
  s_cbranch_scc1 W_101
WD_102:
  s_cmp_eq_u32 s57, 1
  s_cbranch_scc1 L_QG
  ds_read_b64_tr_b16 v[48:49], v81 offset:0
  ds_read_b64_tr_b16 v[50:51], v81 offset:256
  ds_read_b128 v[56:59], v76 offset:0
  ds_read_b128 v[60:63], v76 offset:36864
  ds_read_b64_tr_b16 v[52:53], v81 offset:1024
  ds_read_b64_tr_b16 v[54:55], v81 offset:1280
  ds_read_b128 v[64:67], v77 offset:0
  ds_read_b128 v[68:71], v77 offset:36864
  buffer_load_dwordx4 v[144:147], v83, s[12:15], s72 offen
  s_add_u32 s72, s72, 18432
  s_waitcnt vmcnt(9)
  ds_write_b128 v80, v[108:111] offset:3072
  ds_read_b64_tr_b16 v[10:11], v81 offset:2048
  ds_read_b64_tr_b16 v[12:13], v81 offset:2304
  ds_read_b128 v[84:87], v78 offset:0
  ds_read_b128 v[88:91], v78 offset:36864
  s_waitcnt lgkmcnt(9)
  v_mfma_f32_32x32x16_bf16 v[16:31], v[48:51], v[56:59], 0
  v_mfma_f32_32x32x16_bf16 v[32:47], v[48:51], v[60:63], 0
  buffer_load_dwordx4 v[148:151], v83, s[12:15], s72 offen
  s_add_u32 s72, s72, 18432
  s_waitcnt vmcnt(9)
  ds_write_b128 v80, v[112:115] offset:0
  ds_read_b64_tr_b16 v[48:49], v81 offset:3072
  ds_read_b64_tr_b16 v[50:51], v81 offset:3328
  ds_read_b128 v[56:59], v79 offset:0
  ds_read_b128 v[60:63], v79 offset:36864
  s_waitcnt lgkmcnt(9)
  v_mfma_f32_32x32x16_bf16 v[16:31], v[52:55], v[64:67], v[16:31]
  v_mfma_f32_32x32x16_bf16 v[32:47], v[52:55], v[68:71], v[32:47]
  buffer_load_dwordx4 v[152:155], v83, s[12:15], s72 offen
  s_add_u32 s72, s72, 18432
  s_waitcnt vmcnt(9)
  ds_write_b128 v80, v[116:119] offset:1024
  ds_read_b64_tr_b16 v[52:53], v81 offset:0
  ds_read_b64_tr_b16 v[54:55], v81 offset:256
  ds_read_b128 v[64:67], v76 offset:1024
  ds_read_b128 v[68:71], v76 offset:37888
  s_waitcnt lgkmcnt(9)
  v_mfma_f32_32x32x16_bf16 v[16:31], v[10:13], v[84:87], v[16:31]
  v_mfma_f32_32x32x16_bf16 v[32:47], v[10:13], v[88:91], v[32:47]
  buffer_load_dwordx4 v[156:159], v83, s[12:15], s72 offen
  s_add_u32 s72, s72, 18432
  s_waitcnt vmcnt(9)
  ds_write_b128 v80, v[120:123] offset:2048
  ds_read_b64_tr_b16 v[10:11], v81 offset:1024
  ds_read_b64_tr_b16 v[12:13], v81 offset:1280
  ds_read_b128 v[84:87], v77 offset:1024
  ds_read_b128 v[88:91], v77 offset:37888
  s_waitcnt lgkmcnt(9)
  v_mfma_f32_32x32x16_bf16 v[16:31], v[48:51], v[56:59], v[16:31]
  v_mfma_f32_32x32x16_bf16 v[32:47], v[48:51], v[60:63], v[32:47]
  buffer_load_dwordx4 v[160:163], v83, s[12:15], s72 offen
  s_add_u32 s72, s72, 18432
  s_waitcnt vmcnt(9)
  ds_write_b128 v80, v[124:127] offset:3072
  ds_read_b64_tr_b16 v[48:49], v81 offset:2048
  ds_read_b64_tr_b16 v[50:51], v81 offset:2304
  ds_read_b128 v[56:59], v78 offset:1024
  ds_read_b128 v[60:63], v78 offset:37888
  s_waitcnt lgkmcnt(9)
  v_mfma_f32_32x32x16_bf16 v[16:31], v[52:55], v[64:67], v[16:31]
  v_mfma_f32_32x32x16_bf16 v[32:47], v[52:55], v[68:71], v[32:47]
  buffer_load_dwordx4 v[164:167], v83, s[12:15], s72 offen
  s_add_u32 s72, s72, 18432
  s_waitcnt vmcnt(9)
  ds_write_b128 v80, v[128:131] offset:0
  ds_read_b64_tr_b16 v[52:53], v81 offset:3072
  ds_read_b64_tr_b16 v[54:55], v81 offset:3328
  ds_read_b128 v[64:67], v79 offset:1024
  ds_read_b128 v[68:71], v79 offset:37888
  s_waitcnt lgkmcnt(9)
  v_mfma_f32_32x32x16_bf16 v[16:31], v[10:13], v[84:87], v[16:31]
  v_mfma_f32_32x32x16_bf16 v[32:47], v[10:13], v[88:91], v[32:47]
  buffer_load_dwordx4 v[168:171], v83, s[12:15], s72 offen
  s_add_u32 s72, s72, 18432
  s_waitcnt vmcnt(9)
  ds_write_b128 v80, v[132:135] offset:1024
  ds_read_b64_tr_b16 v[10:11], v81 offset:0
  ds_read_b64_tr_b16 v[12:13], v81 offset:256
  ds_read_b128 v[84:87], v76 offset:2048
  ds_read_b128 v[88:91], v76 offset:38912
  s_waitcnt lgkmcnt(9)
  v_mfma_f32_32x32x16_bf16 v[16:31], v[48:51], v[56:59], v[16:31]
  v_mfma_f32_32x32x16_bf16 v[32:47], v[48:51], v[60:63], v[32:47]
  buffer_load_dwordx4 v[172:175], v83, s[12:15], s72 offen
  s_add_u32 s72, s72, 18432
  s_waitcnt vmcnt(9)
  ds_write_b128 v80, v[136:139] offset:2048
  ds_read_b64_tr_b16 v[48:49], v81 offset:1024
  ds_read_b64_tr_b16 v[50:51], v81 offset:1280
  ds_read_b128 v[56:59], v77 offset:2048
  ds_read_b128 v[60:63], v77 offset:38912
  s_waitcnt lgkmcnt(9)
  v_mfma_f32_32x32x16_bf16 v[16:31], v[52:55], v[64:67], v[16:31]
  v_mfma_f32_32x32x16_bf16 v[32:47], v[52:55], v[68:71], v[32:47]
  buffer_load_dwordx4 v[176:179], v83, s[12:15], s72 offen
  s_add_u32 s72, s72, 18432
  s_waitcnt vmcnt(9)
  ds_write_b128 v80, v[140:143] offset:3072
  ds_read_b64_tr_b16 v[52:53], v81 offset:2048
  ds_read_b64_tr_b16 v[54:55], v81 offset:2304
  ds_read_b128 v[64:67], v78 offset:2048
  ds_read_b128 v[68:71], v78 offset:38912
  s_waitcnt lgkmcnt(9)
  v_mfma_f32_32x32x16_bf16 v[16:31], v[10:13], v[84:87], v[16:31]
  v_mfma_f32_32x32x16_bf16 v[32:47], v[10:13], v[88:91], v[32:47]
  buffer_load_dwordx4 v[180:183], v83, s[12:15], s72 offen
  s_add_u32 s72, s72, 18432
  s_waitcnt vmcnt(9)
  ds_write_b128 v80, v[144:147] offset:0
  ds_read_b64_tr_b16 v[10:11], v81 offset:3072
  ds_read_b64_tr_b16 v[12:13], v81 offset:3328
  ds_read_b128 v[84:87], v79 offset:2048
  ds_read_b128 v[88:91], v79 offset:38912
  s_waitcnt lgkmcnt(9)
  v_mfma_f32_32x32x16_bf16 v[16:31], v[48:51], v[56:59], v[16:31]
  v_mfma_f32_32x32x16_bf16 v[32:47], v[48:51], v[60:63], v[32:47]
  buffer_load_dwordx4 v[184:187], v83, s[12:15], s72 offen
  s_add_u32 s72, s72, 18432
  s_waitcnt vmcnt(9)
  ds_write_b128 v80, v[148:151] offset:1024
  ds_read_b64_tr_b16 v[48:49], v81 offset:0
  ds_read_b64_tr_b16 v[50:51], v81 offset:256
  ds_read_b128 v[56:59], v76 offset:3072
  ds_read_b128 v[60:63], v76 offset:39936
  s_waitcnt lgkmcnt(9)
  v_mfma_f32_32x32x16_bf16 v[16:31], v[52:55], v[64:67], v[16:31]
  v_mfma_f32_32x32x16_bf16 v[32:47], v[52:55], v[68:71], v[32:47]
  buffer_load_dwordx4 v[188:191], v83, s[12:15], s72 offen
  s_add_u32 s72, s72, 18432
  s_waitcnt vmcnt(9)
  ds_write_b128 v80, v[152:155] offset:2048
  ds_read_b64_tr_b16 v[52:53], v81 offset:1024
  ds_read_b64_tr_b16 v[54:55], v81 offset:1280
  ds_read_b128 v[64:67], v77 offset:3072
  ds_read_b128 v[68:71], v77 offset:39936
  s_waitcnt lgkmcnt(9)
  v_mfma_f32_32x32x16_bf16 v[16:31], v[10:13], v[84:87], v[16:31]
  v_mfma_f32_32x32x16_bf16 v[32:47], v[10:13], v[88:91], v[32:47]
  buffer_load_dwordx4 v[192:195], v83, s[12:15], s72 offen
  s_add_u32 s72, s72, 18432
  s_mov_b64 exec, 1
  ds_add_u32 v245, v244 offset:60
  s_mov_b64 exec, -1
  s_waitcnt vmcnt(9)
  ds_write_b128 v80, v[156:159] offset:3072
  ds_read_b64_tr_b16 v[10:11], v81 offset:2048
  ds_read_b64_tr_b16 v[12:13], v81 offset:2304
  ds_read_b128 v[84:87], v78 offset:3072
  ds_read_b128 v[88:91], v78 offset:39936
  s_waitcnt lgkmcnt(9)
  v_mfma_f32_32x32x16_bf16 v[16:31], v[48:51], v[56:59], v[16:31]
  v_mfma_f32_32x32x16_bf16 v[32:47], v[48:51], v[60:63], v[32:47]
  buffer_load_dwordx4 v[196:199], v83, s[12:15], s72 offen
  s_add_u32 s72, s72, 18432
  s_waitcnt vmcnt(9)
  ds_write_b128 v80, v[160:163] offset:0
  ds_read_b64_tr_b16 v[48:49], v81 offset:3072
  ds_read_b64_tr_b16 v[50:51], v81 offset:3328
  ds_read_b128 v[56:59], v79 offset:3072
  ds_read_b128 v[60:63], v79 offset:39936
  s_waitcnt lgkmcnt(9)
  v_mfma_f32_32x32x16_bf16 v[16:31], v[52:55], v[64:67], v[16:31]
  v_mfma_f32_32x32x16_bf16 v[32:47], v[52:55], v[68:71], v[32:47]
  buffer_load_dwordx4 v[200:203], v83, s[12:15], s72 offen
  s_add_u32 s72, s72, 18432
  s_waitcnt vmcnt(9)
  ds_write_b128 v80, v[164:167] offset:1024
  ds_read_b64_tr_b16 v[52:53], v81 offset:0
  ds_read_b64_tr_b16 v[54:55], v81 offset:256
  ds_read_b128 v[64:67], v76 offset:4096
  ds_read_b128 v[68:71], v76 offset:40960
  s_waitcnt lgkmcnt(9)
  v_mfma_f32_32x32x16_bf16 v[16:31], v[10:13], v[84:87], v[16:31]
  v_mfma_f32_32x32x16_bf16 v[32:47], v[10:13], v[88:91], v[32:47]
  buffer_load_dwordx4 v[204:207], v83, s[12:15], s72 offen
  s_add_u32 s72, s72, 18432
  s_waitcnt vmcnt(9)
  ds_write_b128 v80, v[168:171] offset:2048
  ds_read_b64_tr_b16 v[10:11], v81 offset:1024
  ds_read_b64_tr_b16 v[12:13], v81 offset:1280
  ds_read_b128 v[84:87], v77 offset:4096
  ds_read_b128 v[88:91], v77 offset:40960
  s_waitcnt lgkmcnt(9)
  v_mfma_f32_32x32x16_bf16 v[16:31], v[48:51], v[56:59], v[16:31]
  v_mfma_f32_32x32x16_bf16 v[32:47], v[48:51], v[60:63], v[32:47]
  buffer_load_dwordx4 v[208:211], v83, s[12:15], s72 offen
  s_add_u32 s72, s72, 18432
  s_waitcnt vmcnt(9)
  ds_write_b128 v80, v[172:175] offset:3072
  ds_read_b64_tr_b16 v[48:49], v81 offset:2048
  ds_read_b64_tr_b16 v[50:51], v81 offset:2304
  ds_read_b128 v[56:59], v78 offset:4096
  ds_read_b128 v[60:63], v78 offset:40960
  s_waitcnt lgkmcnt(9)
  v_mfma_f32_32x32x16_bf16 v[16:31], v[52:55], v[64:67], v[16:31]
  v_mfma_f32_32x32x16_bf16 v[32:47], v[52:55], v[68:71], v[32:47]
  buffer_load_dwordx4 v[212:215], v83, s[12:15], s72 offen
  s_add_u32 s72, s72, 18432
  s_waitcnt vmcnt(9)
  ds_write_b128 v80, v[176:179] offset:0
  ds_read_b64_tr_b16 v[52:53], v81 offset:3072
  ds_read_b64_tr_b16 v[54:55], v81 offset:3328
  ds_read_b128 v[64:67], v79 offset:4096
  ds_read_b128 v[68:71], v79 offset:40960
  s_waitcnt lgkmcnt(9)
  v_mfma_f32_32x32x16_bf16 v[16:31], v[10:13], v[84:87], v[16:31]
  v_mfma_f32_32x32x16_bf16 v[32:47], v[10:13], v[88:91], v[32:47]
  buffer_load_dwordx4 v[216:219], v83, s[12:15], s72 offen
  s_add_u32 s72, s72, 18432
  s_waitcnt vmcnt(9)
  ds_write_b128 v80, v[180:183] offset:1024
  ds_read_b64_tr_b16 v[10:11], v81 offset:0
  ds_read_b64_tr_b16 v[12:13], v81 offset:256
  ds_read_b128 v[84:87], v76 offset:5120
  ds_read_b128 v[88:91], v76 offset:41984
  s_waitcnt lgkmcnt(9)
  v_mfma_f32_32x32x16_bf16 v[16:31], v[48:51], v[56:59], v[16:31]
  v_mfma_f32_32x32x16_bf16 v[32:47], v[48:51], v[60:63], v[32:47]
  buffer_load_dwordx4 v[220:223], v83, s[12:15], s72 offen
  s_add_u32 s72, s72, 18432
  s_waitcnt vmcnt(9)
  ds_write_b128 v80, v[184:187] offset:2048
  ds_read_b64_tr_b16 v[48:49], v81 offset:1024
  ds_read_b64_tr_b16 v[50:51], v81 offset:1280
  ds_read_b128 v[56:59], v77 offset:5120
  ds_read_b128 v[60:63], v77 offset:41984
  s_waitcnt lgkmcnt(9)
  v_mfma_f32_32x32x16_bf16 v[16:31], v[52:55], v[64:67], v[16:31]
  v_mfma_f32_32x32x16_bf16 v[32:47], v[52:55], v[68:71], v[32:47]
  buffer_load_dwordx4 v[224:227], v83, s[12:15], s72 offen
  s_add_u32 s72, s72, 18432
  s_waitcnt vmcnt(9)
  ds_write_b128 v80, v[188:191] offset:3072
  ds_read_b64_tr_b16 v[52:53], v81 offset:2048
  ds_read_b64_tr_b16 v[54:55], v81 offset:2304
  ds_read_b128 v[64:67], v78 offset:5120
  ds_read_b128 v[68:71], v78 offset:41984
  s_waitcnt lgkmcnt(9)
  v_mfma_f32_32x32x16_bf16 v[16:31], v[10:13], v[84:87], v[16:31]
  v_mfma_f32_32x32x16_bf16 v[32:47], v[10:13], v[88:91], v[32:47]
  buffer_load_dwordx4 v[228:231], v83, s[12:15], s72 offen
  s_add_u32 s72, s72, 18432
  s_waitcnt vmcnt(9)
  ds_write_b128 v80, v[192:195] offset:0
  ds_read_b64_tr_b16 v[10:11], v81 offset:3072
  ds_read_b64_tr_b16 v[12:13], v81 offset:3328
  ds_read_b128 v[84:87], v79 offset:5120
  ds_read_b128 v[88:91], v79 offset:41984
  s_waitcnt lgkmcnt(9)
  v_mfma_f32_32x32x16_bf16 v[16:31], v[48:51], v[56:59], v[16:31]
  v_mfma_f32_32x32x16_bf16 v[32:47], v[48:51], v[60:63], v[32:47]
  buffer_load_dwordx4 v[232:235], v83, s[12:15], s72 offen
  s_add_u32 s72, s72, 18432
  s_waitcnt vmcnt(9)
  ds_write_b128 v80, v[196:199] offset:1024
  ds_read_b64_tr_b16 v[48:49], v81 offset:0
  ds_read_b64_tr_b16 v[50:51], v81 offset:256
  ds_read_b128 v[56:59], v76 offset:6144
  ds_read_b128 v[60:63], v76 offset:43008
  s_waitcnt lgkmcnt(9)
  v_mfma_f32_32x32x16_bf16 v[16:31], v[52:55], v[64:67], v[16:31]
  v_mfma_f32_32x32x16_bf16 v[32:47], v[52:55], v[68:71], v[32:47]
  buffer_load_dwordx4 v[236:239], v83, s[12:15], s72 offen
  s_waitcnt vmcnt(9)
  ds_write_b128 v80, v[200:203] offset:2048
  ds_read_b64_tr_b16 v[52:53], v81 offset:1024
  ds_read_b64_tr_b16 v[54:55], v81 offset:1280
  ds_read_b128 v[64:67], v77 offset:6144
  ds_read_b128 v[68:71], v77 offset:43008
  s_waitcnt lgkmcnt(9)
  v_mfma_f32_32x32x16_bf16 v[16:31], v[10:13], v[84:87], v[16:31]
  v_mfma_f32_32x32x16_bf16 v[32:47], v[10:13], v[88:91], v[32:47]
  s_waitcnt vmcnt(8)
  ds_write_b128 v80, v[204:207] offset:3072
  ds_read_b64_tr_b16 v[10:11], v81 offset:2048
  ds_read_b64_tr_b16 v[12:13], v81 offset:2304
  ds_read_b128 v[84:87], v78 offset:6144
  ds_read_b128 v[88:91], v78 offset:43008
  s_waitcnt lgkmcnt(9)
  v_mfma_f32_32x32x16_bf16 v[16:31], v[48:51], v[56:59], v[16:31]
  v_mfma_f32_32x32x16_bf16 v[32:47], v[48:51], v[60:63], v[32:47]
  s_waitcnt vmcnt(7)
  ds_write_b128 v80, v[208:211] offset:0
  ds_read_b64_tr_b16 v[48:49], v81 offset:3072
  ds_read_b64_tr_b16 v[50:51], v81 offset:3328
  ds_read_b128 v[56:59], v79 offset:6144
  ds_read_b128 v[60:63], v79 offset:43008
  s_waitcnt lgkmcnt(9)
  v_mfma_f32_32x32x16_bf16 v[16:31], v[52:55], v[64:67], v[16:31]
  v_mfma_f32_32x32x16_bf16 v[32:47], v[52:55], v[68:71], v[32:47]
  s_waitcnt vmcnt(6)
  ds_write_b128 v80, v[212:215] offset:1024
  ds_read_b64_tr_b16 v[52:53], v81 offset:0
  ds_read_b64_tr_b16 v[54:55], v81 offset:256
  ds_read_b128 v[64:67], v76 offset:7168
  ds_read_b128 v[68:71], v76 offset:44032
  s_waitcnt lgkmcnt(9)
  v_mfma_f32_32x32x16_bf16 v[16:31], v[10:13], v[84:87], v[16:31]
  v_mfma_f32_32x32x16_bf16 v[32:47], v[10:13], v[88:91], v[32:47]
  s_waitcnt vmcnt(5)
  ds_write_b128 v80, v[216:219] offset:2048
  ds_read_b64_tr_b16 v[10:11], v81 offset:1024
  ds_read_b64_tr_b16 v[12:13], v81 offset:1280
  ds_read_b128 v[84:87], v77 offset:7168
  ds_read_b128 v[88:91], v77 offset:44032
  s_waitcnt lgkmcnt(9)
  v_mfma_f32_32x32x16_bf16 v[16:31], v[48:51], v[56:59], v[16:31]
  v_mfma_f32_32x32x16_bf16 v[32:47], v[48:51], v[60:63], v[32:47]
  s_waitcnt vmcnt(4)
  ds_write_b128 v80, v[220:223] offset:3072
  ds_read_b64_tr_b16 v[48:49], v81 offset:2048
  ds_read_b64_tr_b16 v[50:51], v81 offset:2304
  ds_read_b128 v[56:59], v78 offset:7168
  ds_read_b128 v[60:63], v78 offset:44032
  s_waitcnt lgkmcnt(9)
  v_mfma_f32_32x32x16_bf16 v[16:31], v[52:55], v[64:67], v[16:31]
  v_mfma_f32_32x32x16_bf16 v[32:47], v[52:55], v[68:71], v[32:47]
  s_waitcnt vmcnt(3)
  ds_write_b128 v80, v[224:227] offset:0
  ds_read_b64_tr_b16 v[52:53], v81 offset:3072
  ds_read_b64_tr_b16 v[54:55], v81 offset:3328
  ds_read_b128 v[64:67], v79 offset:7168
  ds_read_b128 v[68:71], v79 offset:44032
  s_waitcnt lgkmcnt(9)
  v_mfma_f32_32x32x16_bf16 v[16:31], v[10:13], v[84:87], v[16:31]
  v_mfma_f32_32x32x16_bf16 v[32:47], v[10:13], v[88:91], v[32:47]
  s_waitcnt vmcnt(2)
  ds_write_b128 v80, v[228:231] offset:1024
  ds_read_b64_tr_b16 v[10:11], v81 offset:0
  ds_read_b64_tr_b16 v[12:13], v81 offset:256
  ds_read_b128 v[84:87], v76 offset:8192
  ds_read_b128 v[88:91], v76 offset:45056
  s_waitcnt lgkmcnt(9)
  v_mfma_f32_32x32x16_bf16 v[16:31], v[48:51], v[56:59], v[16:31]
  v_mfma_f32_32x32x16_bf16 v[32:47], v[48:51], v[60:63], v[32:47]
  s_waitcnt vmcnt(1)
  ds_write_b128 v80, v[232:235] offset:2048
  ds_read_b64_tr_b16 v[48:49], v81 offset:1024
  ds_read_b64_tr_b16 v[50:51], v81 offset:1280
  ds_read_b128 v[56:59], v77 offset:8192
  ds_read_b128 v[60:63], v77 offset:45056
  s_waitcnt lgkmcnt(9)
  v_mfma_f32_32x32x16_bf16 v[16:31], v[52:55], v[64:67], v[16:31]
  v_mfma_f32_32x32x16_bf16 v[32:47], v[52:55], v[68:71], v[32:47]
  s_waitcnt vmcnt(0)
  ds_write_b128 v80, v[236:239] offset:3072
  ds_read_b64_tr_b16 v[52:53], v81 offset:2048
  ds_read_b64_tr_b16 v[54:55], v81 offset:2304
  ds_read_b128 v[64:67], v78 offset:8192
  ds_read_b128 v[68:71], v78 offset:45056
  s_waitcnt lgkmcnt(9)
  v_mfma_f32_32x32x16_bf16 v[16:31], v[10:13], v[84:87], v[16:31]
  v_mfma_f32_32x32x16_bf16 v[32:47], v[10:13], v[88:91], v[32:47]
  ds_read_b64_tr_b16 v[10:11], v81 offset:3072
  ds_read_b64_tr_b16 v[12:13], v81 offset:3328
  ds_read_b128 v[84:87], v79 offset:8192
  ds_read_b128 v[88:91], v79 offset:45056
  s_waitcnt lgkmcnt(8)
  v_mfma_f32_32x32x16_bf16 v[16:31], v[48:51], v[56:59], v[16:31]
  v_mfma_f32_32x32x16_bf16 v[32:47], v[48:51], v[60:63], v[32:47]
  s_waitcnt lgkmcnt(4)
  v_mfma_f32_32x32x16_bf16 v[16:31], v[52:55], v[64:67], v[16:31]
  v_mfma_f32_32x32x16_bf16 v[32:47], v[52:55], v[68:71], v[32:47]
  s_waitcnt lgkmcnt(0)
  v_mfma_f32_32x32x16_bf16 v[16:31], v[10:13], v[84:87], v[16:31]
  v_mfma_f32_32x32x16_bf16 v[32:47], v[10:13], v[88:91], v[32:47]
  s_branch L_QE
L_QG:
  s_mov_b32 s72, 221184
  ds_read_b64_tr_b16 v[48:49], v81 offset:0
  ds_read_b64_tr_b16 v[50:51], v81 offset:256
  ds_read_b128 v[56:59], v76 offset:0
  ds_read_b128 v[60:63], v76 offset:36864
  ds_read_b128 v[72:75], v82 offset:0
  ds_read_b64_tr_b16 v[52:53], v81 offset:1024
  ds_read_b64_tr_b16 v[54:55], v81 offset:1280
  ds_read_b128 v[64:67], v77 offset:0
  ds_read_b128 v[68:71], v77 offset:36864
  ds_read_b128 v[240:243], v82 offset:32
  buffer_load_dwordx4 v[144:147], v83, s[12:15], s72 offen
  s_add_u32 s72, s72, 18432
  s_waitcnt vmcnt(9)
  ds_write_b128 v80, v[108:111] offset:3072
  ds_read_b64_tr_b16 v[10:11], v81 offset:2048
  ds_read_b64_tr_b16 v[12:13], v81 offset:2304
  ds_read_b128 v[84:87], v78 offset:0
  ds_read_b128 v[88:91], v78 offset:36864
  ds_read_b128 v[92:95], v82 offset:64
  s_waitcnt lgkmcnt(11)
  v_cndmask_b32 v48, v48, v72, s[82:83]
  v_cndmask_b32 v49, v49, v73, s[82:83]
  v_cndmask_b32 v50, v50, v74, s[82:83]
  v_cndmask_b32 v51, v51, v75, s[82:83]
  s_nop 1
  v_mfma_f32_32x32x16_bf16 v[16:31], v[48:51], v[56:59], 0
  v_mfma_f32_32x32x16_bf16 v[32:47], v[48:51], v[60:63], 0
  buffer_load_dwordx4 v[148:151], v83, s[12:15], s72 offen
  s_add_u32 s72, s72, 18432
  s_waitcnt vmcnt(9)
  ds_write_b128 v80, v[112:115] offset:0
  ds_read_b64_tr_b16 v[48:49], v81 offset:3072
  ds_read_b64_tr_b16 v[50:51], v81 offset:3328
  ds_read_b128 v[56:59], v79 offset:0
  ds_read_b128 v[60:63], v79 offset:36864
  ds_read_b128 v[72:75], v82 offset:96
  s_waitcnt lgkmcnt(11)
  v_cndmask_b32 v52, v52, v240, s[82:83]
  v_cndmask_b32 v53, v53, v241, s[82:83]
  v_cndmask_b32 v54, v54, v242, s[82:83]
  v_cndmask_b32 v55, v55, v243, s[82:83]
  s_nop 1
  v_mfma_f32_32x32x16_bf16 v[16:31], v[52:55], v[64:67], v[16:31]
  v_mfma_f32_32x32x16_bf16 v[32:47], v[52:55], v[68:71], v[32:47]
  buffer_load_dwordx4 v[152:155], v83, s[12:15], s72 offen
  s_add_u32 s72, s72, 18432
  s_waitcnt vmcnt(9)
  ds_write_b128 v80, v[116:119] offset:1024
  ds_read_b64_tr_b16 v[52:53], v81 offset:0
  ds_read_b64_tr_b16 v[54:55], v81 offset:256
  ds_read_b128 v[64:67], v76 offset:1024
  ds_read_b128 v[68:71], v76 offset:37888
  ds_read_b128 v[240:243], v82 offset:128
  s_waitcnt lgkmcnt(11)
  v_cndmask_b32 v10, v10, v92, s[82:83]
  v_cndmask_b32 v11, v11, v93, s[82:83]
  v_cndmask_b32 v12, v12, v94, s[82:83]
  v_cndmask_b32 v13, v13, v95, s[82:83]
  s_nop 1
  v_mfma_f32_32x32x16_bf16 v[16:31], v[10:13], v[84:87], v[16:31]
  v_mfma_f32_32x32x16_bf16 v[32:47], v[10:13], v[88:91], v[32:47]
  buffer_load_dwordx4 v[156:159], v83, s[12:15], s72 offen
  s_add_u32 s72, s72, 18432
  s_waitcnt vmcnt(9)
  ds_write_b128 v80, v[120:123] offset:2048
  ds_read_b64_tr_b16 v[10:11], v81 offset:1024
  ds_read_b64_tr_b16 v[12:13], v81 offset:1280
  ds_read_b128 v[84:87], v77 offset:1024
  ds_read_b128 v[88:91], v77 offset:37888
  ds_read_b128 v[92:95], v82 offset:160
  s_waitcnt lgkmcnt(11)
  v_cndmask_b32 v48, v48, v72, s[82:83]
  v_cndmask_b32 v49, v49, v73, s[82:83]
  v_cndmask_b32 v50, v50, v74, s[82:83]
  v_cndmask_b32 v51, v51, v75, s[82:83]
  s_nop 1
  v_mfma_f32_32x32x16_bf16 v[16:31], v[48:51], v[56:59], v[16:31]
  v_mfma_f32_32x32x16_bf16 v[32:47], v[48:51], v[60:63], v[32:47]
  buffer_load_dwordx4 v[160:163], v83, s[12:15], s72 offen
  s_add_u32 s72, s72, 18432
  s_waitcnt vmcnt(9)
  ds_write_b128 v80, v[124:127] offset:3072
  ds_read_b64_tr_b16 v[48:49], v81 offset:2048
  ds_read_b64_tr_b16 v[50:51], v81 offset:2304
  ds_read_b128 v[56:59], v78 offset:1024
  ds_read_b128 v[60:63], v78 offset:37888
  ds_read_b128 v[72:75], v82 offset:192
  s_waitcnt lgkmcnt(11)
  v_cndmask_b32 v52, v52, v240, s[82:83]
  v_cndmask_b32 v53, v53, v241, s[82:83]
  v_cndmask_b32 v54, v54, v242, s[82:83]
  v_cndmask_b32 v55, v55, v243, s[82:83]
  s_nop 1
  v_mfma_f32_32x32x16_bf16 v[16:31], v[52:55], v[64:67], v[16:31]
  v_mfma_f32_32x32x16_bf16 v[32:47], v[52:55], v[68:71], v[32:47]
  buffer_load_dwordx4 v[164:167], v83, s[12:15], s72 offen
  s_add_u32 s72, s72, 18432
  s_waitcnt vmcnt(9)
  ds_write_b128 v80, v[128:131] offset:0
  ds_read_b64_tr_b16 v[52:53], v81 offset:3072
  ds_read_b64_tr_b16 v[54:55], v81 offset:3328
  ds_read_b128 v[64:67], v79 offset:1024
  ds_read_b128 v[68:71], v79 offset:37888
  ds_read_b128 v[240:243], v82 offset:224
  s_waitcnt lgkmcnt(11)
  v_cndmask_b32 v10, v10, v92, s[82:83]
  v_cndmask_b32 v11, v11, v93, s[82:83]
  v_cndmask_b32 v12, v12, v94, s[82:83]
  v_cndmask_b32 v13, v13, v95, s[82:83]
  s_nop 1
  v_mfma_f32_32x32x16_bf16 v[16:31], v[10:13], v[84:87], v[16:31]
  v_mfma_f32_32x32x16_bf16 v[32:47], v[10:13], v[88:91], v[32:47]
  buffer_load_dwordx4 v[168:171], v83, s[12:15], s72 offen
  s_add_u32 s72, s72, 18432
  s_waitcnt vmcnt(9)
  ds_write_b128 v80, v[132:135] offset:1024
  ds_read_b64_tr_b16 v[10:11], v81 offset:0
  ds_read_b64_tr_b16 v[12:13], v81 offset:256
  ds_read_b128 v[84:87], v76 offset:2048
  ds_read_b128 v[88:91], v76 offset:38912
  ds_read_b128 v[92:95], v82 offset:256
  s_waitcnt lgkmcnt(11)
  v_cndmask_b32 v48, v48, v72, s[82:83]
  v_cndmask_b32 v49, v49, v73, s[82:83]
  v_cndmask_b32 v50, v50, v74, s[82:83]
  v_cndmask_b32 v51, v51, v75, s[82:83]
  s_nop 1
  v_mfma_f32_32x32x16_bf16 v[16:31], v[48:51], v[56:59], v[16:31]
  v_mfma_f32_32x32x16_bf16 v[32:47], v[48:51], v[60:63], v[32:47]
  buffer_load_dwordx4 v[172:175], v83, s[12:15], s72 offen
  s_add_u32 s72, s72, 18432
  s_waitcnt vmcnt(9)
  ds_write_b128 v80, v[136:139] offset:2048
  ds_read_b64_tr_b16 v[48:49], v81 offset:1024
  ds_read_b64_tr_b16 v[50:51], v81 offset:1280
  ds_read_b128 v[56:59], v77 offset:2048
  ds_read_b128 v[60:63], v77 offset:38912
  ds_read_b128 v[72:75], v82 offset:288
  s_waitcnt lgkmcnt(11)
  v_cndmask_b32 v52, v52, v240, s[82:83]
  v_cndmask_b32 v53, v53, v241, s[82:83]
  v_cndmask_b32 v54, v54, v242, s[82:83]
  v_cndmask_b32 v55, v55, v243, s[82:83]
  s_nop 1
  v_mfma_f32_32x32x16_bf16 v[16:31], v[52:55], v[64:67], v[16:31]
  v_mfma_f32_32x32x16_bf16 v[32:47], v[52:55], v[68:71], v[32:47]
  buffer_load_dwordx4 v[176:179], v83, s[12:15], s72 offen
  s_add_u32 s72, s72, 18432
  s_waitcnt vmcnt(9)
  ds_write_b128 v80, v[140:143] offset:3072
  ds_read_b64_tr_b16 v[52:53], v81 offset:2048
  ds_read_b64_tr_b16 v[54:55], v81 offset:2304
  ds_read_b128 v[64:67], v78 offset:2048
  ds_read_b128 v[68:71], v78 offset:38912
  ds_read_b128 v[240:243], v82 offset:320
  s_waitcnt lgkmcnt(11)
  v_cndmask_b32 v10, v10, v92, s[82:83]
  v_cndmask_b32 v11, v11, v93, s[82:83]
  v_cndmask_b32 v12, v12, v94, s[82:83]
  v_cndmask_b32 v13, v13, v95, s[82:83]
  s_nop 1
  v_mfma_f32_32x32x16_bf16 v[16:31], v[10:13], v[84:87], v[16:31]
  v_mfma_f32_32x32x16_bf16 v[32:47], v[10:13], v[88:91], v[32:47]
  buffer_load_dwordx4 v[180:183], v83, s[12:15], s72 offen
  s_add_u32 s72, s72, 18432
  s_waitcnt vmcnt(9)
  ds_write_b128 v80, v[144:147] offset:0
  ds_read_b64_tr_b16 v[10:11], v81 offset:3072
  ds_read_b64_tr_b16 v[12:13], v81 offset:3328
  ds_read_b128 v[84:87], v79 offset:2048
  ds_read_b128 v[88:91], v79 offset:38912
  ds_read_b128 v[92:95], v82 offset:352
  s_waitcnt lgkmcnt(11)
  v_cndmask_b32 v48, v48, v72, s[82:83]
  v_cndmask_b32 v49, v49, v73, s[82:83]
  v_cndmask_b32 v50, v50, v74, s[82:83]
  v_cndmask_b32 v51, v51, v75, s[82:83]
  s_nop 1
  v_mfma_f32_32x32x16_bf16 v[16:31], v[48:51], v[56:59], v[16:31]
  v_mfma_f32_32x32x16_bf16 v[32:47], v[48:51], v[60:63], v[32:47]
  buffer_load_dwordx4 v[184:187], v83, s[12:15], s72 offen
  s_add_u32 s72, s72, 18432
  s_waitcnt vmcnt(9)
  ds_write_b128 v80, v[148:151] offset:1024
  ds_read_b64_tr_b16 v[48:49], v81 offset:0
  ds_read_b64_tr_b16 v[50:51], v81 offset:256
  ds_read_b128 v[56:59], v76 offset:3072
  ds_read_b128 v[60:63], v76 offset:39936
  ds_read_b128 v[72:75], v82 offset:384
  s_waitcnt lgkmcnt(11)
  v_cndmask_b32 v52, v52, v240, s[82:83]
  v_cndmask_b32 v53, v53, v241, s[82:83]
  v_cndmask_b32 v54, v54, v242, s[82:83]
  v_cndmask_b32 v55, v55, v243, s[82:83]
  s_nop 1
  v_mfma_f32_32x32x16_bf16 v[16:31], v[52:55], v[64:67], v[16:31]
  v_mfma_f32_32x32x16_bf16 v[32:47], v[52:55], v[68:71], v[32:47]
  buffer_load_dwordx4 v[188:191], v83, s[12:15], s72 offen
  s_add_u32 s72, s72, 18432
  s_waitcnt vmcnt(9)
  ds_write_b128 v80, v[152:155] offset:2048
  ds_read_b64_tr_b16 v[52:53], v81 offset:1024
  ds_read_b64_tr_b16 v[54:55], v81 offset:1280
  ds_read_b128 v[64:67], v77 offset:3072
  ds_read_b128 v[68:71], v77 offset:39936
  ds_read_b128 v[240:243], v82 offset:416
  s_waitcnt lgkmcnt(11)
  v_cndmask_b32 v10, v10, v92, s[82:83]
  v_cndmask_b32 v11, v11, v93, s[82:83]
  v_cndmask_b32 v12, v12, v94, s[82:83]
  v_cndmask_b32 v13, v13, v95, s[82:83]
  s_nop 1
  v_mfma_f32_32x32x16_bf16 v[16:31], v[10:13], v[84:87], v[16:31]
  v_mfma_f32_32x32x16_bf16 v[32:47], v[10:13], v[88:91], v[32:47]
  buffer_load_dwordx4 v[192:195], v83, s[12:15], s72 offen
  s_add_u32 s72, s72, 18432
  s_mov_b64 exec, 1
  ds_add_u32 v245, v244 offset:60
  s_mov_b64 exec, -1
  s_waitcnt vmcnt(9)
  ds_write_b128 v80, v[156:159] offset:3072
  ds_read_b64_tr_b16 v[10:11], v81 offset:2048
  ds_read_b64_tr_b16 v[12:13], v81 offset:2304
  ds_read_b128 v[84:87], v78 offset:3072
  ds_read_b128 v[88:91], v78 offset:39936
  ds_read_b128 v[92:95], v82 offset:448
  s_waitcnt lgkmcnt(11)
  v_cndmask_b32 v48, v48, v72, s[82:83]
  v_cndmask_b32 v49, v49, v73, s[82:83]
  v_cndmask_b32 v50, v50, v74, s[82:83]
  v_cndmask_b32 v51, v51, v75, s[82:83]
  s_nop 1
  v_mfma_f32_32x32x16_bf16 v[16:31], v[48:51], v[56:59], v[16:31]
  v_mfma_f32_32x32x16_bf16 v[32:47], v[48:51], v[60:63], v[32:47]
  buffer_load_dwordx4 v[196:199], v83, s[12:15], s72 offen
  s_add_u32 s72, s72, 18432
  s_waitcnt vmcnt(9)
  ds_write_b128 v80, v[160:163] offset:0
  ds_read_b64_tr_b16 v[48:49], v81 offset:3072
  ds_read_b64_tr_b16 v[50:51], v81 offset:3328
  ds_read_b128 v[56:59], v79 offset:3072
  ds_read_b128 v[60:63], v79 offset:39936
  ds_read_b128 v[72:75], v82 offset:480
  s_waitcnt lgkmcnt(11)
  v_cndmask_b32 v52, v52, v240, s[82:83]
  v_cndmask_b32 v53, v53, v241, s[82:83]
  v_cndmask_b32 v54, v54, v242, s[82:83]
  v_cndmask_b32 v55, v55, v243, s[82:83]
  s_nop 1
  v_mfma_f32_32x32x16_bf16 v[16:31], v[52:55], v[64:67], v[16:31]
  v_mfma_f32_32x32x16_bf16 v[32:47], v[52:55], v[68:71], v[32:47]
  buffer_load_dwordx4 v[200:203], v83, s[12:15], s72 offen
  s_add_u32 s72, s72, 18432
  s_waitcnt vmcnt(9)
  ds_write_b128 v80, v[164:167] offset:1024
  ds_read_b64_tr_b16 v[52:53], v81 offset:0
  ds_read_b64_tr_b16 v[54:55], v81 offset:256
  ds_read_b128 v[64:67], v76 offset:4096
  ds_read_b128 v[68:71], v76 offset:40960
  ds_read_b128 v[240:243], v82 offset:512
  s_waitcnt lgkmcnt(11)
  v_cndmask_b32 v10, v10, v92, s[82:83]
  v_cndmask_b32 v11, v11, v93, s[82:83]
  v_cndmask_b32 v12, v12, v94, s[82:83]
  v_cndmask_b32 v13, v13, v95, s[82:83]
  s_nop 1
  v_mfma_f32_32x32x16_bf16 v[16:31], v[10:13], v[84:87], v[16:31]
  v_mfma_f32_32x32x16_bf16 v[32:47], v[10:13], v[88:91], v[32:47]
  buffer_load_dwordx4 v[204:207], v83, s[12:15], s72 offen
  s_add_u32 s72, s72, 18432
  s_waitcnt vmcnt(9)
  ds_write_b128 v80, v[168:171] offset:2048
  ds_read_b64_tr_b16 v[10:11], v81 offset:1024
  ds_read_b64_tr_b16 v[12:13], v81 offset:1280
  ds_read_b128 v[84:87], v77 offset:4096
  ds_read_b128 v[88:91], v77 offset:40960
  ds_read_b128 v[92:95], v82 offset:544
  s_waitcnt lgkmcnt(11)
  v_cndmask_b32 v48, v48, v72, s[82:83]
  v_cndmask_b32 v49, v49, v73, s[82:83]
  v_cndmask_b32 v50, v50, v74, s[82:83]
  v_cndmask_b32 v51, v51, v75, s[82:83]
  s_nop 1
  v_mfma_f32_32x32x16_bf16 v[16:31], v[48:51], v[56:59], v[16:31]
  v_mfma_f32_32x32x16_bf16 v[32:47], v[48:51], v[60:63], v[32:47]
  buffer_load_dwordx4 v[208:211], v83, s[12:15], s72 offen
  s_add_u32 s72, s72, 18432
  s_waitcnt vmcnt(9)
  ds_write_b128 v80, v[172:175] offset:3072
  ds_read_b64_tr_b16 v[48:49], v81 offset:2048
  ds_read_b64_tr_b16 v[50:51], v81 offset:2304
  ds_read_b128 v[56:59], v78 offset:4096
  ds_read_b128 v[60:63], v78 offset:40960
  ds_read_b128 v[72:75], v82 offset:576
  s_waitcnt lgkmcnt(11)
  v_cndmask_b32 v52, v52, v240, s[82:83]
  v_cndmask_b32 v53, v53, v241, s[82:83]
  v_cndmask_b32 v54, v54, v242, s[82:83]
  v_cndmask_b32 v55, v55, v243, s[82:83]
  s_nop 1
  v_mfma_f32_32x32x16_bf16 v[16:31], v[52:55], v[64:67], v[16:31]
  v_mfma_f32_32x32x16_bf16 v[32:47], v[52:55], v[68:71], v[32:47]
  buffer_load_dwordx4 v[212:215], v83, s[12:15], s72 offen
  s_add_u32 s72, s72, 18432
  s_waitcnt vmcnt(9)
  ds_write_b128 v80, v[176:179] offset:0
  ds_read_b64_tr_b16 v[52:53], v81 offset:3072
  ds_read_b64_tr_b16 v[54:55], v81 offset:3328
  ds_read_b128 v[64:67], v79 offset:4096
  ds_read_b128 v[68:71], v79 offset:40960
  ds_read_b128 v[240:243], v82 offset:608
  s_waitcnt lgkmcnt(11)
  v_cndmask_b32 v10, v10, v92, s[82:83]
  v_cndmask_b32 v11, v11, v93, s[82:83]
  v_cndmask_b32 v12, v12, v94, s[82:83]
  v_cndmask_b32 v13, v13, v95, s[82:83]
  s_nop 1
  v_mfma_f32_32x32x16_bf16 v[16:31], v[10:13], v[84:87], v[16:31]
  v_mfma_f32_32x32x16_bf16 v[32:47], v[10:13], v[88:91], v[32:47]
  buffer_load_dwordx4 v[216:219], v83, s[12:15], s72 offen
  s_add_u32 s72, s72, 18432
  s_waitcnt vmcnt(9)
  ds_write_b128 v80, v[180:183] offset:1024
  ds_read_b64_tr_b16 v[10:11], v81 offset:0
  ds_read_b64_tr_b16 v[12:13], v81 offset:256
  ds_read_b128 v[84:87], v76 offset:5120
  ds_read_b128 v[88:91], v76 offset:41984
  ds_read_b128 v[92:95], v82 offset:640
  s_waitcnt lgkmcnt(11)
  v_cndmask_b32 v48, v48, v72, s[82:83]
  v_cndmask_b32 v49, v49, v73, s[82:83]
  v_cndmask_b32 v50, v50, v74, s[82:83]
  v_cndmask_b32 v51, v51, v75, s[82:83]
  s_nop 1
  v_mfma_f32_32x32x16_bf16 v[16:31], v[48:51], v[56:59], v[16:31]
  v_mfma_f32_32x32x16_bf16 v[32:47], v[48:51], v[60:63], v[32:47]
  buffer_load_dwordx4 v[220:223], v83, s[12:15], s72 offen
  s_add_u32 s72, s72, 18432
  s_waitcnt vmcnt(9)
  ds_write_b128 v80, v[184:187] offset:2048
  ds_read_b64_tr_b16 v[48:49], v81 offset:1024
  ds_read_b64_tr_b16 v[50:51], v81 offset:1280
  ds_read_b128 v[56:59], v77 offset:5120
  ds_read_b128 v[60:63], v77 offset:41984
  ds_read_b128 v[72:75], v82 offset:672
  s_waitcnt lgkmcnt(11)
  v_cndmask_b32 v52, v52, v240, s[82:83]
  v_cndmask_b32 v53, v53, v241, s[82:83]
  v_cndmask_b32 v54, v54, v242, s[82:83]
  v_cndmask_b32 v55, v55, v243, s[82:83]
  s_nop 1
  v_mfma_f32_32x32x16_bf16 v[16:31], v[52:55], v[64:67], v[16:31]
  v_mfma_f32_32x32x16_bf16 v[32:47], v[52:55], v[68:71], v[32:47]
  buffer_load_dwordx4 v[224:227], v83, s[12:15], s72 offen
  s_add_u32 s72, s72, 18432
  s_waitcnt vmcnt(9)
  ds_write_b128 v80, v[188:191] offset:3072
  ds_read_b64_tr_b16 v[52:53], v81 offset:2048
  ds_read_b64_tr_b16 v[54:55], v81 offset:2304
  ds_read_b128 v[64:67], v78 offset:5120
  ds_read_b128 v[68:71], v78 offset:41984
  ds_read_b128 v[240:243], v82 offset:704
  s_waitcnt lgkmcnt(11)
  v_cndmask_b32 v10, v10, v92, s[82:83]
  v_cndmask_b32 v11, v11, v93, s[82:83]
  v_cndmask_b32 v12, v12, v94, s[82:83]
  v_cndmask_b32 v13, v13, v95, s[82:83]
  s_nop 1
  v_mfma_f32_32x32x16_bf16 v[16:31], v[10:13], v[84:87], v[16:31]
  v_mfma_f32_32x32x16_bf16 v[32:47], v[10:13], v[88:91], v[32:47]
  buffer_load_dwordx4 v[228:231], v83, s[12:15], s72 offen
  s_add_u32 s72, s72, 18432
  s_waitcnt vmcnt(9)
  ds_write_b128 v80, v[192:195] offset:0
  ds_read_b64_tr_b16 v[10:11], v81 offset:3072
  ds_read_b64_tr_b16 v[12:13], v81 offset:3328
  ds_read_b128 v[84:87], v79 offset:5120
  ds_read_b128 v[88:91], v79 offset:41984
  ds_read_b128 v[92:95], v82 offset:736
  s_waitcnt lgkmcnt(11)
  v_cndmask_b32 v48, v48, v72, s[82:83]
  v_cndmask_b32 v49, v49, v73, s[82:83]
  v_cndmask_b32 v50, v50, v74, s[82:83]
  v_cndmask_b32 v51, v51, v75, s[82:83]
  s_nop 1
  v_mfma_f32_32x32x16_bf16 v[16:31], v[48:51], v[56:59], v[16:31]
  v_mfma_f32_32x32x16_bf16 v[32:47], v[48:51], v[60:63], v[32:47]
  buffer_load_dwordx4 v[232:235], v83, s[12:15], s72 offen
  s_add_u32 s72, s72, 18432
  s_waitcnt vmcnt(9)
  ds_write_b128 v80, v[196:199] offset:1024
  ds_read_b64_tr_b16 v[48:49], v81 offset:0
  ds_read_b64_tr_b16 v[50:51], v81 offset:256
  ds_read_b128 v[56:59], v76 offset:6144
  ds_read_b128 v[60:63], v76 offset:43008
  ds_read_b128 v[72:75], v82 offset:768
  s_waitcnt lgkmcnt(11)
  v_cndmask_b32 v52, v52, v240, s[82:83]
  v_cndmask_b32 v53, v53, v241, s[82:83]
  v_cndmask_b32 v54, v54, v242, s[82:83]
  v_cndmask_b32 v55, v55, v243, s[82:83]
  s_nop 1
  v_mfma_f32_32x32x16_bf16 v[16:31], v[52:55], v[64:67], v[16:31]
  v_mfma_f32_32x32x16_bf16 v[32:47], v[52:55], v[68:71], v[32:47]
  buffer_load_dwordx4 v[236:239], v83, s[12:15], s72 offen
  s_waitcnt vmcnt(9)
  ds_write_b128 v80, v[200:203] offset:2048
  ds_read_b64_tr_b16 v[52:53], v81 offset:1024
  ds_read_b64_tr_b16 v[54:55], v81 offset:1280
  ds_read_b128 v[64:67], v77 offset:6144
  ds_read_b128 v[68:71], v77 offset:43008
  ds_read_b128 v[240:243], v82 offset:800
  s_waitcnt lgkmcnt(11)
  v_cndmask_b32 v10, v10, v92, s[82:83]
  v_cndmask_b32 v11, v11, v93, s[82:83]
  v_cndmask_b32 v12, v12, v94, s[82:83]
  v_cndmask_b32 v13, v13, v95, s[82:83]
  s_nop 1
  v_mfma_f32_32x32x16_bf16 v[16:31], v[10:13], v[84:87], v[16:31]
  v_mfma_f32_32x32x16_bf16 v[32:47], v[10:13], v[88:91], v[32:47]
  s_waitcnt vmcnt(8)
  ds_write_b128 v80, v[204:207] offset:3072
  ds_read_b64_tr_b16 v[10:11], v81 offset:2048
  ds_read_b64_tr_b16 v[12:13], v81 offset:2304
  ds_read_b128 v[84:87], v78 offset:6144
  ds_read_b128 v[88:91], v78 offset:43008
  ds_read_b128 v[92:95], v82 offset:832
  s_waitcnt lgkmcnt(11)
  v_cndmask_b32 v48, v48, v72, s[82:83]
  v_cndmask_b32 v49, v49, v73, s[82:83]
  v_cndmask_b32 v50, v50, v74, s[82:83]
  v_cndmask_b32 v51, v51, v75, s[82:83]
  s_nop 1
  v_mfma_f32_32x32x16_bf16 v[16:31], v[48:51], v[56:59], v[16:31]
  v_mfma_f32_32x32x16_bf16 v[32:47], v[48:51], v[60:63], v[32:47]
  s_waitcnt vmcnt(7)
  ds_write_b128 v80, v[208:211] offset:0
  ds_read_b64_tr_b16 v[48:49], v81 offset:3072
  ds_read_b64_tr_b16 v[50:51], v81 offset:3328
  ds_read_b128 v[56:59], v79 offset:6144
  ds_read_b128 v[60:63], v79 offset:43008
  ds_read_b128 v[72:75], v82 offset:864
  s_waitcnt lgkmcnt(11)
  v_cndmask_b32 v52, v52, v240, s[82:83]
  v_cndmask_b32 v53, v53, v241, s[82:83]
  v_cndmask_b32 v54, v54, v242, s[82:83]
  v_cndmask_b32 v55, v55, v243, s[82:83]
  s_nop 1
  v_mfma_f32_32x32x16_bf16 v[16:31], v[52:55], v[64:67], v[16:31]
  v_mfma_f32_32x32x16_bf16 v[32:47], v[52:55], v[68:71], v[32:47]
  s_waitcnt vmcnt(6)
  ds_write_b128 v80, v[212:215] offset:1024
  ds_read_b64_tr_b16 v[52:53], v81 offset:0
  ds_read_b64_tr_b16 v[54:55], v81 offset:256
  ds_read_b128 v[64:67], v76 offset:7168
  ds_read_b128 v[68:71], v76 offset:44032
  ds_read_b128 v[240:243], v82 offset:896
  s_waitcnt lgkmcnt(11)
  v_cndmask_b32 v10, v10, v92, s[82:83]
  v_cndmask_b32 v11, v11, v93, s[82:83]
  v_cndmask_b32 v12, v12, v94, s[82:83]
  v_cndmask_b32 v13, v13, v95, s[82:83]
  s_nop 1
  v_mfma_f32_32x32x16_bf16 v[16:31], v[10:13], v[84:87], v[16:31]
  v_mfma_f32_32x32x16_bf16 v[32:47], v[10:13], v[88:91], v[32:47]
  s_waitcnt vmcnt(5)
  ds_write_b128 v80, v[216:219] offset:2048
  ds_read_b64_tr_b16 v[10:11], v81 offset:1024
  ds_read_b64_tr_b16 v[12:13], v81 offset:1280
  ds_read_b128 v[84:87], v77 offset:7168
  ds_read_b128 v[88:91], v77 offset:44032
  ds_read_b128 v[92:95], v82 offset:928
  s_waitcnt lgkmcnt(11)
  v_cndmask_b32 v48, v48, v72, s[82:83]
  v_cndmask_b32 v49, v49, v73, s[82:83]
  v_cndmask_b32 v50, v50, v74, s[82:83]
  v_cndmask_b32 v51, v51, v75, s[82:83]
  s_nop 1
  v_mfma_f32_32x32x16_bf16 v[16:31], v[48:51], v[56:59], v[16:31]
  v_mfma_f32_32x32x16_bf16 v[32:47], v[48:51], v[60:63], v[32:47]
  s_waitcnt vmcnt(4)
  ds_write_b128 v80, v[220:223] offset:3072
  ds_read_b64_tr_b16 v[48:49], v81 offset:2048
  ds_read_b64_tr_b16 v[50:51], v81 offset:2304
  ds_read_b128 v[56:59], v78 offset:7168
  ds_read_b128 v[60:63], v78 offset:44032
  ds_read_b128 v[72:75], v82 offset:960
  s_waitcnt lgkmcnt(11)
  v_cndmask_b32 v52, v52, v240, s[82:83]
  v_cndmask_b32 v53, v53, v241, s[82:83]
  v_cndmask_b32 v54, v54, v242, s[82:83]
  v_cndmask_b32 v55, v55, v243, s[82:83]
  s_nop 1
  v_mfma_f32_32x32x16_bf16 v[16:31], v[52:55], v[64:67], v[16:31]
  v_mfma_f32_32x32x16_bf16 v[32:47], v[52:55], v[68:71], v[32:47]
  s_waitcnt vmcnt(3)
  ds_write_b128 v80, v[224:227] offset:0
  ds_read_b64_tr_b16 v[52:53], v81 offset:3072
  ds_read_b64_tr_b16 v[54:55], v81 offset:3328
  ds_read_b128 v[64:67], v79 offset:7168
  ds_read_b128 v[68:71], v79 offset:44032
  ds_read_b128 v[240:243], v82 offset:992
  s_waitcnt lgkmcnt(11)
  v_cndmask_b32 v10, v10, v92, s[82:83]
  v_cndmask_b32 v11, v11, v93, s[82:83]
  v_cndmask_b32 v12, v12, v94, s[82:83]
  v_cndmask_b32 v13, v13, v95, s[82:83]
  s_nop 1
  v_mfma_f32_32x32x16_bf16 v[16:31], v[10:13], v[84:87], v[16:31]
  v_mfma_f32_32x32x16_bf16 v[32:47], v[10:13], v[88:91], v[32:47]
  s_waitcnt vmcnt(2)
  ds_write_b128 v80, v[228:231] offset:1024
  ds_read_b64_tr_b16 v[10:11], v81 offset:0
  ds_read_b64_tr_b16 v[12:13], v81 offset:256
  ds_read_b128 v[84:87], v76 offset:8192
  ds_read_b128 v[88:91], v76 offset:45056
  ds_read_b128 v[92:95], v82 offset:1024
  s_waitcnt lgkmcnt(11)
  v_cndmask_b32 v48, v48, v72, s[82:83]
  v_cndmask_b32 v49, v49, v73, s[82:83]
  v_cndmask_b32 v50, v50, v74, s[82:83]
  v_cndmask_b32 v51, v51, v75, s[82:83]
  s_nop 1
  v_mfma_f32_32x32x16_bf16 v[16:31], v[48:51], v[56:59], v[16:31]
  v_mfma_f32_32x32x16_bf16 v[32:47], v[48:51], v[60:63], v[32:47]
  s_waitcnt vmcnt(1)
  ds_write_b128 v80, v[232:235] offset:2048
  ds_read_b64_tr_b16 v[48:49], v81 offset:1024
  ds_read_b64_tr_b16 v[50:51], v81 offset:1280
  ds_read_b128 v[56:59], v77 offset:8192
  ds_read_b128 v[60:63], v77 offset:45056
  ds_read_b128 v[72:75], v82 offset:1056
  s_waitcnt lgkmcnt(11)
  v_cndmask_b32 v52, v52, v240, s[82:83]
  v_cndmask_b32 v53, v53, v241, s[82:83]
  v_cndmask_b32 v54, v54, v242, s[82:83]
  v_cndmask_b32 v55, v55, v243, s[82:83]
  s_nop 1
  v_mfma_f32_32x32x16_bf16 v[16:31], v[52:55], v[64:67], v[16:31]
  v_mfma_f32_32x32x16_bf16 v[32:47], v[52:55], v[68:71], v[32:47]
  s_waitcnt vmcnt(0)
  ds_write_b128 v80, v[236:239] offset:3072
  ds_read_b64_tr_b16 v[52:53], v81 offset:2048
  ds_read_b64_tr_b16 v[54:55], v81 offset:2304
  ds_read_b128 v[64:67], v78 offset:8192
  ds_read_b128 v[68:71], v78 offset:45056
  ds_read_b128 v[240:243], v82 offset:1088
  s_waitcnt lgkmcnt(11)
  v_cndmask_b32 v10, v10, v92, s[82:83]
  v_cndmask_b32 v11, v11, v93, s[82:83]
  v_cndmask_b32 v12, v12, v94, s[82:83]
  v_cndmask_b32 v13, v13, v95, s[82:83]
  s_nop 1
  v_mfma_f32_32x32x16_bf16 v[16:31], v[10:13], v[84:87], v[16:31]
  v_mfma_f32_32x32x16_bf16 v[32:47], v[10:13], v[88:91], v[32:47]
  ds_read_b64_tr_b16 v[10:11], v81 offset:3072
  ds_read_b64_tr_b16 v[12:13], v81 offset:3328
  ds_read_b128 v[84:87], v79 offset:8192
  ds_read_b128 v[88:91], v79 offset:45056
  ds_read_b128 v[92:95], v82 offset:1120
  s_waitcnt lgkmcnt(10)
  v_cndmask_b32 v48, v48, v72, s[82:83]
  v_cndmask_b32 v49, v49, v73, s[82:83]
  v_cndmask_b32 v50, v50, v74, s[82:83]
  v_cndmask_b32 v51, v51, v75, s[82:83]
  s_nop 1
  v_mfma_f32_32x32x16_bf16 v[16:31], v[48:51], v[56:59], v[16:31]
  v_mfma_f32_32x32x16_bf16 v[32:47], v[48:51], v[60:63], v[32:47]
  s_waitcnt lgkmcnt(5)
  v_cndmask_b32 v52, v52, v240, s[82:83]
  v_cndmask_b32 v53, v53, v241, s[82:83]
  v_cndmask_b32 v54, v54, v242, s[82:83]
  v_cndmask_b32 v55, v55, v243, s[82:83]
  s_nop 1
  v_mfma_f32_32x32x16_bf16 v[16:31], v[52:55], v[64:67], v[16:31]
  v_mfma_f32_32x32x16_bf16 v[32:47], v[52:55], v[68:71], v[32:47]
  s_waitcnt lgkmcnt(0)
  v_cndmask_b32 v10, v10, v92, s[82:83]
  v_cndmask_b32 v11, v11, v93, s[82:83]
  v_cndmask_b32 v12, v12, v94, s[82:83]
  v_cndmask_b32 v13, v13, v95, s[82:83]
  s_nop 1
  v_mfma_f32_32x32x16_bf16 v[16:31], v[10:13], v[84:87], v[16:31]
  v_mfma_f32_32x32x16_bf16 v[32:47], v[10:13], v[88:91], v[32:47]
L_QE:
  s_waitcnt lgkmcnt(0)
  s_mov_b64 s[92:93], exec
  s_mov_b64 exec, 1
  ds_add_u32 v245, v244 offset:8
  s_mov_b64 exec, s[92:93]
  v_and_b32 v3, 31, v0
  v_lshrrev_b32 v4, 5, v0
  v_cmp_gt_u32 s[84:85], 32, v0
  v_lshlrev_b32 v176, 4, v0
  v_lshlrev_b32 v177, 2, v3
  v_add_u32 v177, 1024, v177
  v_mul_u32_u24 v12, 288, v4
  v_lshlrev_b32 v13, 4, v3
  v_add_u32 v12, v12, v13
  v_add_u32 v190, 1152, v12
  v_cmp_gt_u32 s[60:61], 18, v3
  v_cmp_eq_u32 vcc, 18, v3
  v_mov_b32 v13, 0x3f803f80
  v_mov_b32 v149, 0x3f803f80
  v_mov_b32 v165, 0x3f803f80
  v_mov_b32 v189, 0x3f803f80
  s_mov_b32 s88, 0
  v_cndmask_b32 v152, 0, v13, vcc
  v_cndmask_b32 v153, 0, v13, vcc
  v_cndmask_b32 v154, 0, v13, vcc
  v_cndmask_b32 v155, 0, v13, vcc
  v_cndmask_b32 v156, 0, v13, vcc
  v_cndmask_b32 v157, 0, v13, vcc
  v_cndmask_b32 v158, 0, v13, vcc
  v_cndmask_b32 v159, 0, v13, vcc
  v_cndmask_b32 v168, 0, v13, vcc
  v_cndmask_b32 v169, 0, v13, vcc
  v_cndmask_b32 v170, 0, v13, vcc
  v_cndmask_b32 v171, 0, v13, vcc
  v_cndmask_b32 v172, 0, v13, vcc
  v_cndmask_b32 v173, 0, v13, vcc
  v_cndmask_b32 v174, 0, v13, vcc
  v_cndmask_b32 v175, 0, v13, vcc
  s_mov_b32 s95, 400000
W_103:
  ds_read_b32 v14, v245 offset:16
  s_waitcnt lgkmcnt(0)
  v_readfirstlane_b32 s6, v14
  s_nop 3
  s_cmp_ge_u32 s6, 1
  s_cbranch_scc1 WD_104
  s_sleep 1
  s_sub_u32 s95, s95, 1
  s_cmp_lg_u32 s95, 0
  s_cbranch_scc1 W_103
WD_104:
  s_lshl_b32 s86, s80, 5
  s_mov_b32 s87, 0
  s_mul_i32 s70, s87, 2304
  buffer_load_dwordx4 v[184:187], v176, s[44:47], s70 offen
  buffer_load_dword v188, v177, s[44:47], s70 offen
  s_mov_b64 exec, s[60:61]
  v_mov_b32 v172, 0
  v_mov_b32 v173, 0
  v_mov_b32 v174, 0
  v_mov_b32 v175, 0
  s_mov_b64 exec, -1
  s_mul_i32 s70, s86, 2304
  buffer_load_dwordx4 v[144:147], v176, s[44:47], s70 offen
  buffer_load_dword v148, v177, s[44:47], s70 offen
  s_mul_i32 s70, s86, 2304
  s_mov_b64 exec, s[60:61]
  buffer_load_dwordx4 v[152:155], v190, s[44:47], s70 offen
  buffer_load_dwordx4 v[156:159], v190, s[44:47], s70 offen offset:576
  s_mov_b64 exec, -1
  s_add_u32 s87, s86, 1
  s_mul_i32 s70, s87, 2304
  buffer_load_dwordx4 v[160:163], v176, s[44:47], s70 offen
  buffer_load_dword v164, v177, s[44:47], s70 offen
  v_mov_b32 v80, 0
  v_mov_b32 v81, 0
  v_mov_b32 v82, 0
  v_mov_b32 v83, 0
  v_mov_b32 v84, 0
  v_mov_b32 v85, 0
  v_mov_b32 v86, 0
  v_mov_b32 v87, 0
  v_mov_b32 v88, 0
  v_mov_b32 v89, 0
  v_mov_b32 v90, 0
  v_mov_b32 v91, 0
  v_mov_b32 v92, 0
  v_mov_b32 v93, 0
  v_mov_b32 v94, 0
  v_mov_b32 v95, 0
  v_mov_b32 v96, 0
  v_mov_b32 v97, 0
  v_mov_b32 v98, 0
  v_mov_b32 v99, 0
  v_mov_b32 v100, 0
  v_mov_b32 v101, 0
  v_mov_b32 v102, 0
  v_mov_b32 v103, 0
  v_mov_b32 v104, 0
  v_mov_b32 v105, 0
  v_mov_b32 v106, 0
  v_mov_b32 v107, 0
  v_mov_b32 v108, 0
  v_mov_b32 v109, 0
  v_mov_b32 v110, 0
  v_mov_b32 v111, 0
  v_mov_b32 v112, 0
  v_mov_b32 v113, 0
  v_mov_b32 v114, 0
  v_mov_b32 v115, 0
  v_mov_b32 v116, 0
  v_mov_b32 v117, 0
  v_mov_b32 v118, 0
  v_mov_b32 v119, 0
  v_mov_b32 v120, 0
  v_mov_b32 v121, 0
  v_mov_b32 v122, 0
  v_mov_b32 v123, 0
  v_mov_b32 v124, 0
  v_mov_b32 v125, 0
  v_mov_b32 v126, 0
  v_mov_b32 v127, 0
  v_mov_b32 v128, 0
  v_mov_b32 v129, 0
  v_mov_b32 v130, 0
  v_mov_b32 v131, 0
  v_mov_b32 v132, 0
  v_mov_b32 v133, 0
  v_mov_b32 v134, 0
  v_mov_b32 v135, 0
  v_mov_b32 v136, 0
  v_mov_b32 v137, 0
  v_mov_b32 v138, 0
  v_mov_b32 v139, 0
  v_mov_b32 v140, 0
  v_mov_b32 v141, 0
  v_mov_b32 v142, 0
  v_mov_b32 v143, 0
  v_mov_b32 v72, 0
  v_mov_b32 v73, 0
  v_mov_b32 v74, 0
  v_mov_b32 v75, 0
  v_mov_b32 v76, 0
  v_mov_b32 v77, 0
  v_mov_b32 v78, 0
  v_mov_b32 v79, 0
  v_mov_b32 v180, 0xff800000
  v_mov_b32 v181, 0xff800000
  v_mov_b32 v182, 0xff800000
  v_mov_b32 v183, 0xff800000
  s_waitcnt lgkmcnt(0)
  s_mov_b64 s[92:93], exec
  s_mov_b64 exec, 1
  ds_add_u32 v245, v244 offset:104
  s_mov_b64 exec, s[92:93]
  s_mov_b32 s95, 400000
W_105:
  ds_read_b32 v14, v245 offset:104
  s_waitcnt lgkmcnt(0)
  v_readfirstlane_b32 s6, v14
  s_nop 3
  s_cmp_ge_u32 s6, 3
  s_cbranch_scc1 WD_106
  s_sleep 1
  s_sub_u32 s95, s95, 1
  s_cmp_lg_u32 s95, 0
  s_cbranch_scc1 W_105
WD_106:
  s_mov_b32 s68, 0x3eae1a93
  v_mul_u32_u24 v10, 144, v3
  v_lshlrev_b32 v11, 3, v4
  v_add_u32 v10, v10, v11
  s_lshl_b32 s69, s62, 4
  s_add_u32 s69, s69, 139264
  v_add_u32 v10, s69, v10
  s_nop 7
  s_cmp_eq_u32 s57, 1
  s_cbranch_scc0 L_Q_NOGATE
  v_cvt_pk_bf16_f32 v12, v24, v40
  v_lshlrev_b32 v48, 16, v12
  v_and_b32 v49, 0xffff0000, v12
  v_mul_f32 v48, 0xbfb8aa3b, v48
  v_mul_f32 v49, 0xbfb8aa3b, v49
  v_exp_f32 v48, v48
  v_exp_f32 v49, v49
  s_nop 0
  v_add_f32 v48, 1.0, v48
  v_add_f32 v49, 1.0, v49
  v_rcp_f32 v48, v48
  v_rcp_f32 v49, v49
  s_nop 0
  v_cvt_pk_bf16_f32 v12, v48, v49
  v_lshlrev_b32 v48, 16, v12
  v_and_b32 v49, 0xffff0000, v12
  v_lshlrev_b32 v50, 2, v3
  v_add_u32 v50, 163328, v50
  ds_write_b32 v50, v48
  ds_write_b32 v50, v49 offset:128
  s_waitcnt lgkmcnt(0)
  s_mov_b64 s[92:93], exec
  s_mov_b64 exec, 1
  ds_add_u32 v245, v244 offset:0
  s_mov_b64 exec, s[92:93]
L_Q_NOGATE:
  v_mul_f32 v16, s68, v16
  v_mul_f32 v17, s68, v17
  v_mul_f32 v18, s68, v18
  v_mul_f32 v19, s68, v19
  v_cvt_pk_bf16_f32 v12, v16, v17
  v_cvt_pk_bf16_f32 v13, v18, v19
  ds_write_b64 v10, v[12:13] offset:0
  v_mul_f32 v32, s68, v32
  v_mul_f32 v33, s68, v33
  v_mul_f32 v34, s68, v34
  v_mul_f32 v35, s68, v35
  v_cvt_pk_bf16_f32 v12, v32, v33
  v_cvt_pk_bf16_f32 v13, v34, v35
  ds_write_b64 v10, v[12:13] offset:4608
  s_cmp_gt_u32 s63, 1
  s_cbranch_scc0 L_Q_DONE
  v_mul_f32 v20, s68, v20
  v_mul_f32 v21, s68, v21
  v_mul_f32 v22, s68, v22
  v_mul_f32 v23, s68, v23
  v_cvt_pk_bf16_f32 v12, v20, v21
  v_cvt_pk_bf16_f32 v13, v22, v23
  ds_write_b64 v10, v[12:13] offset:16
  v_mul_f32 v36, s68, v36
  v_mul_f32 v37, s68, v37
  v_mul_f32 v38, s68, v38
  v_mul_f32 v39, s68, v39
  v_cvt_pk_bf16_f32 v12, v36, v37
  v_cvt_pk_bf16_f32 v13, v38, v39
  ds_write_b64 v10, v[12:13] offset:4624
  s_cmp_gt_u32 s63, 2
  s_cbranch_scc0 L_Q_DONE
  v_mul_f32 v24, s68, v24
  v_mul_f32 v25, s68, v25
  v_mul_f32 v26, s68, v26
  v_mul_f32 v27, s68, v27
  v_cvt_pk_bf16_f32 v12, v24, v25
  v_cvt_pk_bf16_f32 v13, v26, v27
  ds_write_b64 v10, v[12:13] offset:32
  v_mul_f32 v40, s68, v40
  v_mul_f32 v41, s68, v41
  v_mul_f32 v42, s68, v42
  v_mul_f32 v43, s68, v43
  v_cvt_pk_bf16_f32 v12, v40, v41
  v_cvt_pk_bf16_f32 v13, v42, v43
  ds_write_b64 v10, v[12:13] offset:4640
  s_cmp_gt_u32 s63, 3
  s_cbranch_scc0 L_Q_DONE
  v_mul_f32 v28, s68, v28
  v_mul_f32 v29, s68, v29
  v_mul_f32 v30, s68, v30
  v_mul_f32 v31, s68, v31
  v_cvt_pk_bf16_f32 v12, v28, v29
  v_cvt_pk_bf16_f32 v13, v30, v31
  ds_write_b64 v10, v[12:13] offset:48
  v_mul_f32 v44, s68, v44
  v_mul_f32 v45, s68, v45
  v_mul_f32 v46, s68, v46
  v_mul_f32 v47, s68, v47
  v_cvt_pk_bf16_f32 v12, v44, v45
  v_cvt_pk_bf16_f32 v13, v46, v47
  ds_write_b64 v10, v[12:13] offset:4656
L_Q_DONE:
  s_waitcnt lgkmcnt(0)
  s_mov_b64 s[92:93], exec
  s_mov_b64 exec, 1
  ds_add_u32 v245, v244 offset:4
  s_mov_b64 exec, s[92:93]
  s_branch L_A_JOIN
L_A3:
  s_mov_b32 s40, s68
  s_and_b32 s41, s69, 0xffff
  s_mov_b32 s42, 256
  s_mov_b32 s43, 0x20000
  s_cmp_eq_u32 s59, 0
  s_cselect_b32 s16, s52, s54
  s_cselect_b32 s17, s53, s55
  s_and_b32 s17, s17, 0xffff
  s_mov_b32 s18, 20736
  s_mov_b32 s19, 0x20000
  s_cmp_lt_u32 s59, 2
  s_cbranch_scc1 L_A3_KV
  s_add_u32 m0, s74, 0
  s_nop 0
  buffer_load_dwordx4 v246, s[8:11], s76 offen offset:0 lds
  s_add_u32 m0, s74, 9216
  s_nop 0
  buffer_load_dwordx4 v247, s[8:11], s77 offen offset:0 lds
  s_add_u32 m0, s74, 896
  s_nop 0
  buffer_load_dwordx4 v246, s[8:11], s76 offen offset:128 lds
  s_add_u32 m0, s74, 10112
  s_nop 0
  buffer_load_dwordx4 v247, s[8:11], s77 offen offset:128 lds
  s_add_u32 m0, s74, 1792
  s_nop 0
  buffer_load_dwordx4 v246, s[8:11], s76 offen offset:256 lds
  s_add_u32 m0, s74, 11008
  s_nop 0
  buffer_load_dwordx4 v247, s[8:11], s77 offen offset:256 lds
  s_add_u32 m0, s74, 2688
  s_nop 0
  buffer_load_dwordx4 v246, s[8:11], s76 offen offset:384 lds
  s_add_u32 m0, s74, 11904
  s_nop 0
  buffer_load_dwordx4 v247, s[8:11], s77 offen offset:384 lds
  s_add_u32 m0, s74, 3584
  s_nop 0
  buffer_load_dwordx4 v246, s[8:11], s76 offen offset:512 lds
  s_add_u32 m0, s74, 12800
  s_nop 0
  buffer_load_dwordx4 v247, s[8:11], s77 offen offset:512 lds
  s_add_u32 m0, s74, 4480
  s_nop 0
  buffer_load_dwordx4 v246, s[8:11], s76 offen offset:640 lds
  s_add_u32 m0, s74, 13696
  s_nop 0
  buffer_load_dwordx4 v247, s[8:11], s77 offen offset:640 lds
  s_add_u32 m0, s74, 5376
  s_nop 0
  buffer_load_dwordx4 v246, s[8:11], s76 offen offset:768 lds
  s_add_u32 m0, s74, 14592
  s_nop 0
  buffer_load_dwordx4 v247, s[8:11], s77 offen offset:768 lds
  s_add_u32 m0, s74, 6272
  s_nop 0
  buffer_load_dwordx4 v246, s[8:11], s76 offen offset:896 lds
  s_add_u32 m0, s74, 15488
  s_nop 0
  buffer_load_dwordx4 v247, s[8:11], s77 offen offset:896 lds
  s_add_u32 m0, s74, 7168
  s_nop 0
  buffer_load_dwordx4 v246, s[8:11], s76 offen offset:1024 lds
  s_add_u32 m0, s74, 16384
  s_nop 0
  buffer_load_dwordx4 v247, s[8:11], s77 offen offset:1024 lds
  s_waitcnt vmcnt(16)
  s_mov_b64 exec, 1
  ds_add_u32 v245, v244 offset:64
  s_mov_b64 exec, -1
  s_waitcnt vmcnt(14)
  s_mov_b64 exec, 1
  ds_add_u32 v245, v244 offset:68
  s_mov_b64 exec, -1
  s_waitcnt vmcnt(12)
  s_mov_b64 exec, 1
  ds_add_u32 v245, v244 offset:72
  s_mov_b64 exec, -1
  s_waitcnt vmcnt(10)
  s_mov_b64 exec, 1
  ds_add_u32 v245, v244 offset:76
  s_mov_b64 exec, -1
  s_waitcnt vmcnt(8)
  s_mov_b64 exec, 1
  ds_add_u32 v245, v244 offset:80
  s_mov_b64 exec, -1
  s_waitcnt vmcnt(6)
  s_mov_b64 exec, 1
  ds_add_u32 v245, v244 offset:84
  s_mov_b64 exec, -1
  s_waitcnt vmcnt(4)
  s_mov_b64 exec, 1
  ds_add_u32 v245, v244 offset:88
  s_mov_b64 exec, -1
  s_waitcnt vmcnt(2)
  s_mov_b64 exec, 1
  ds_add_u32 v245, v244 offset:92
  s_mov_b64 exec, -1
  s_waitcnt vmcnt(0)
  s_mov_b64 exec, 1
  ds_add_u32 v245, v244 offset:96
  s_mov_b64 exec, -1
  s_waitcnt lgkmcnt(0)
  s_mov_b64 s[92:93], exec
  s_mov_b64 exec, 1
  ds_add_u32 v245, v244 offset:8
  s_mov_b64 exec, s[92:93]
  s_branch L_A3_PUB
L_A3_KV:
  v_mul_u32_u24 v11, 36, v0
  s_mov_b32 s72, 0
  s_add_u32 m0, s74, 0
  s_nop 0
  buffer_load_dwordx4 v246, s[8:11], s76 offen offset:0 lds
  s_add_u32 m0, s74, 9216
  s_nop 0
  buffer_load_dwordx4 v247, s[8:11], s77 offen offset:0 lds
  s_add_u32 m0, s74, 896
  s_nop 0
  buffer_load_dwordx4 v246, s[8:11], s76 offen offset:128 lds
  s_add_u32 m0, s74, 10112
  s_nop 0
  buffer_load_dwordx4 v247, s[8:11], s77 offen offset:128 lds
  s_add_u32 m0, s74, 1792
  s_nop 0
  buffer_load_dwordx4 v246, s[8:11], s76 offen offset:256 lds
  s_add_u32 m0, s74, 11008
  s_nop 0
  buffer_load_dwordx4 v247, s[8:11], s77 offen offset:256 lds
  s_add_u32 m0, s74, 2688
  s_nop 0
  buffer_load_dwordx4 v246, s[8:11], s76 offen offset:384 lds
  s_add_u32 m0, s74, 11904
  s_nop 0
  buffer_load_dwordx4 v247, s[8:11], s77 offen offset:384 lds
  s_add_u32 m0, s74, 3584
  s_nop 0
  buffer_load_dwordx4 v246, s[8:11], s76 offen offset:512 lds
  s_add_u32 m0, s74, 12800
  s_nop 0
  buffer_load_dwordx4 v247, s[8:11], s77 offen offset:512 lds
  s_add_u32 m0, s74, 4480
  s_nop 0
  buffer_load_dwordx4 v246, s[8:11], s76 offen offset:640 lds
  s_add_u32 m0, s74, 13696
  s_nop 0
  buffer_load_dwordx4 v247, s[8:11], s77 offen offset:640 lds
  s_add_u32 m0, s74, 5376
  s_nop 0
  buffer_load_dwordx4 v246, s[8:11], s76 offen offset:768 lds
  s_add_u32 m0, s74, 14592
  s_nop 0
  buffer_load_dwordx4 v247, s[8:11], s77 offen offset:768 lds
  s_add_u32 m0, s74, 6272
  s_nop 0
  buffer_load_dwordx4 v246, s[8:11], s76 offen offset:896 lds
  s_add_u32 m0, s74, 15488
  s_nop 0
  buffer_load_dwordx4 v247, s[8:11], s77 offen offset:896 lds
  s_add_u32 m0, s74, 7168
  s_nop 0
  buffer_load_dwordx4 v246, s[8:11], s76 offen offset:1024 lds
  s_add_u32 m0, s74, 16384
  s_nop 0
  buffer_load_dwordx4 v247, s[8:11], s77 offen offset:1024 lds
  buffer_load_dwordx4 v[96:99], v11, s[16:19], s72 offen
  buffer_load_dwordx4 v[100:103], v11, s[16:19], s72 offen offset:16
  buffer_load_dword v104, v11, s[16:19], s72 offen offset:32
  s_add_u32 s72, s72, 2304
  buffer_load_dwordx4 v[106:109], v11, s[16:19], s72 offen
  buffer_load_dwordx4 v[110:113], v11, s[16:19], s72 offen offset:16
  buffer_load_dword v114, v11, s[16:19], s72 offen offset:32
  s_add_u32 s72, s72, 2304
  buffer_load_dwordx4 v[116:119], v11, s[16:19], s72 offen
  buffer_load_dwordx4 v[120:123], v11, s[16:19], s72 offen offset:16
  buffer_load_dword v124, v11, s[16:19], s72 offen offset:32
  s_add_u32 s72, s72, 2304
  buffer_load_dwordx4 v[126:129], v11, s[16:19], s72 offen
  buffer_load_dwordx4 v[130:133], v11, s[16:19], s72 offen offset:16
  buffer_load_dword v134, v11, s[16:19], s72 offen offset:32
  s_add_u32 s72, s72, 2304
  buffer_load_dwordx4 v[136:139], v11, s[16:19], s72 offen
  buffer_load_dwordx4 v[140:143], v11, s[16:19], s72 offen offset:16
  buffer_load_dword v144, v11, s[16:19], s72 offen offset:32
  s_add_u32 s72, s72, 2304
  buffer_load_dwordx4 v[146:149], v11, s[16:19], s72 offen
  buffer_load_dwordx4 v[150:153], v11, s[16:19], s72 offen offset:16
  buffer_load_dword v154, v11, s[16:19], s72 offen offset:32
  s_add_u32 s72, s72, 2304
  buffer_load_dwordx4 v[156:159], v11, s[16:19], s72 offen
  buffer_load_dwordx4 v[160:163], v11, s[16:19], s72 offen offset:16
  buffer_load_dword v164, v11, s[16:19], s72 offen offset:32
  s_add_u32 s72, s72, 2304
  buffer_load_dwordx4 v[166:169], v11, s[16:19], s72 offen
  buffer_load_dwordx4 v[170:173], v11, s[16:19], s72 offen offset:16
  buffer_load_dword v174, v11, s[16:19], s72 offen offset:32
  s_add_u32 s72, s72, 2304
  buffer_load_dwordx4 v[176:179], v11, s[16:19], s72 offen
  buffer_load_dwordx4 v[180:183], v11, s[16:19], s72 offen offset:16
  buffer_load_dword v184, v11, s[16:19], s72 offen offset:32
  v_and_b32 v3, 31, v0
  v_lshrrev_b32 v4, 5, v0
  v_lshrrev_b32 v5, 3, v3
  v_mul_u32_u24 v5, 9216, v5
  v_and_b32 v6, 7, v3
  v_lshlrev_b32 v6, 7, v6
  v_add_u32 v5, v5, v6
  v_lshrrev_b32 v6, 1, v3
  v_and_b32 v6, 7, v6
  v_add_u32 v7, 0, v4
  v_xor_b32 v7, v7, v6
  v_lshlrev_b32 v7, 4, v7
  v_add_u32 v76, v5, v7
  v_add_u32 v7, 2, v4
  v_xor_b32 v7, v7, v6
  v_lshlrev_b32 v7, 4, v7
  v_add_u32 v77, v5, v7
  v_add_u32 v7, 4, v4
  v_xor_b32 v7, v7, v6
  v_lshlrev_b32 v7, 4, v7
  v_add_u32 v78, v5, v7
  v_add_u32 v7, 6, v4
  v_xor_b32 v7, v7, v6
  v_lshlrev_b32 v7, 4, v7
  v_add_u32 v79, v5, v7
  v_and_b32 v10, 15, v0
  v_lshrrev_b32 v11, 4, v0
  v_lshrrev_b32 v12, 1, v11
  v_lshlrev_b32 v8, 3, v12
  v_lshrrev_b32 v12, 2, v10
  v_add_u32 v8, v8, v12
  v_and_b32 v11, 1, v11
  v_lshlrev_b32 v11, 5, v11
  v_and_b32 v10, 3, v10
  v_lshlrev_b32 v10, 3, v10
  v_add_u32 v9, v10, v11
  v_mul_u32_u24 v80, 40, v0
  v_add_u32 v80, 151552, v80
  v_mul_u32_u24 v81, 40, v8
  v_add_u32 v81, v81, v9
  v_add_u32 v81, 151552, v81
  s_cmp_eq_u32 s59, 1
  s_cbranch_scc1 L_A3_V
  s_waitcnt vmcnt(43)
  s_mov_b64 exec, 1
  ds_add_u32 v245, v244 offset:64
  s_mov_b64 exec, -1
  s_waitcnt vmcnt(24)
  ds_write_b64 v80, v[96:97] offset:0
  ds_write_b64 v80, v[98:99] offset:8
  ds_write_b64 v80, v[100:101] offset:16
  ds_write_b64 v80, v[102:103] offset:24
  ds_write_b32 v80, v104 offset:32
  s_mov_b32 s95, 400000
W_107:
  ds_read_b32 v12, v245 offset:64
  s_waitcnt lgkmcnt(0)
  v_readfirstlane_b32 s6, v12
  s_nop 3
  s_cmp_ge_u32 s6, 4
  s_cbranch_scc1 WD_108
  s_sleep 1
  s_sub_u32 s95, s95, 1
  s_cmp_lg_u32 s95, 0
  s_cbranch_scc1 W_107
WD_108:
  ds_read_b64_tr_b16 v[48:49], v81 offset:0
  ds_read_b64_tr_b16 v[50:51], v81 offset:160
  ds_read_b128 v[56:59], v76 offset:0
  ds_read_b128 v[60:63], v76 offset:36864
  s_waitcnt vmcnt(21)
  ds_write_b64 v80, v[106:107] offset:2560
  ds_write_b64 v80, v[108:109] offset:2568
  ds_write_b64 v80, v[110:111] offset:2576
  ds_write_b64 v80, v[112:113] offset:2584
  ds_write_b32 v80, v114 offset:2592
  ds_read_b64_tr_b16 v[52:53], v81 offset:640
  ds_read_b64_tr_b16 v[54:55], v81 offset:800
  ds_read_b128 v[64:67], v77 offset:0
  ds_read_b128 v[68:71], v77 offset:36864
  s_waitcnt lgkmcnt(9)
  v_mfma_f32_32x32x16_bf16 v[16:31], v[48:51], v[56:59], 0
  v_mfma_f32_32x32x16_bf16 v[32:47], v[48:51], v[60:63], 0
  ds_read_b64_tr_b16 v[48:49], v81 offset:1280
  ds_read_b64_tr_b16 v[50:51], v81 offset:1440
  ds_read_b128 v[56:59], v78 offset:0
  ds_read_b128 v[60:63], v78 offset:36864
  s_waitcnt lgkmcnt(4)
  v_mfma_f32_32x32x16_bf16 v[16:31], v[52:55], v[64:67], v[16:31]
  v_mfma_f32_32x32x16_bf16 v[32:47], v[52:55], v[68:71], v[32:47]
  ds_read_b64_tr_b16 v[52:53], v81 offset:1920
  ds_read_b64_tr_b16 v[54:55], v81 offset:2080
  ds_read_b128 v[64:67], v79 offset:0
  ds_read_b128 v[68:71], v79 offset:36864
  s_waitcnt lgkmcnt(4)
  v_mfma_f32_32x32x16_bf16 v[16:31], v[48:51], v[56:59], v[16:31]
  v_mfma_f32_32x32x16_bf16 v[32:47], v[48:51], v[60:63], v[32:47]
  s_waitcnt vmcnt(41)
  s_mov_b64 exec, 1
  ds_add_u32 v245, v244 offset:68
  s_mov_b64 exec, -1
  s_mov_b32 s95, 400000
W_109:
  ds_read_b32 v12, v245 offset:68
  s_waitcnt lgkmcnt(0)
  v_readfirstlane_b32 s6, v12
  s_nop 3
  s_cmp_ge_u32 s6, 4
  s_cbranch_scc1 WD_110
  s_sleep 1
  s_sub_u32 s95, s95, 1
  s_cmp_lg_u32 s95, 0
  s_cbranch_scc1 W_109
WD_110:
  ds_read_b64_tr_b16 v[48:49], v81 offset:2560
  ds_read_b64_tr_b16 v[50:51], v81 offset:2720
  ds_read_b128 v[56:59], v76 offset:1024
  ds_read_b128 v[60:63], v76 offset:37888
  s_waitcnt lgkmcnt(4)
  v_mfma_f32_32x32x16_bf16 v[16:31], v[52:55], v[64:67], v[16:31]
  v_mfma_f32_32x32x16_bf16 v[32:47], v[52:55], v[68:71], v[32:47]
  s_waitcnt vmcnt(18)
  ds_write_b64 v80, v[116:117] offset:0
  ds_write_b64 v80, v[118:119] offset:8
  ds_write_b64 v80, v[120:121] offset:16
  ds_write_b64 v80, v[122:123] offset:24
  ds_write_b32 v80, v124 offset:32
  ds_read_b64_tr_b16 v[52:53], v81 offset:3200
  ds_read_b64_tr_b16 v[54:55], v81 offset:3360
  ds_read_b128 v[64:67], v77 offset:1024
  ds_read_b128 v[68:71], v77 offset:37888
  s_waitcnt lgkmcnt(9)
  v_mfma_f32_32x32x16_bf16 v[16:31], v[48:51], v[56:59], v[16:31]
  v_mfma_f32_32x32x16_bf16 v[32:47], v[48:51], v[60:63], v[32:47]
  ds_read_b64_tr_b16 v[48:49], v81 offset:3840
  ds_read_b64_tr_b16 v[50:51], v81 offset:4000
  ds_read_b128 v[56:59], v78 offset:1024
  ds_read_b128 v[60:63], v78 offset:37888
  s_waitcnt lgkmcnt(4)
  v_mfma_f32_32x32x16_bf16 v[16:31], v[52:55], v[64:67], v[16:31]
  v_mfma_f32_32x32x16_bf16 v[32:47], v[52:55], v[68:71], v[32:47]
  ds_read_b64_tr_b16 v[52:53], v81 offset:4480
  ds_read_b64_tr_b16 v[54:55], v81 offset:4640
  ds_read_b128 v[64:67], v79 offset:1024
  ds_read_b128 v[68:71], v79 offset:37888
  s_waitcnt lgkmcnt(4)
  v_mfma_f32_32x32x16_bf16 v[16:31], v[48:51], v[56:59], v[16:31]
  v_mfma_f32_32x32x16_bf16 v[32:47], v[48:51], v[60:63], v[32:47]
  s_waitcnt vmcnt(39)
  s_mov_b64 exec, 1
  ds_add_u32 v245, v244 offset:72
  s_mov_b64 exec, -1
  s_mov_b32 s95, 400000
W_111:
  ds_read_b32 v12, v245 offset:72
  s_waitcnt lgkmcnt(0)
  v_readfirstlane_b32 s6, v12
  s_nop 3
  s_cmp_ge_u32 s6, 4
  s_cbranch_scc1 WD_112
  s_sleep 1
  s_sub_u32 s95, s95, 1
  s_cmp_lg_u32 s95, 0
  s_cbranch_scc1 W_111
WD_112:
  ds_read_b64_tr_b16 v[48:49], v81 offset:0
  ds_read_b64_tr_b16 v[50:51], v81 offset:160
  ds_read_b128 v[56:59], v76 offset:2048
  ds_read_b128 v[60:63], v76 offset:38912
  s_waitcnt lgkmcnt(4)
  v_mfma_f32_32x32x16_bf16 v[16:31], v[52:55], v[64:67], v[16:31]
  v_mfma_f32_32x32x16_bf16 v[32:47], v[52:55], v[68:71], v[32:47]
  s_waitcnt vmcnt(15)
  ds_write_b64 v80, v[126:127] offset:2560
  ds_write_b64 v80, v[128:129] offset:2568
  ds_write_b64 v80, v[130:131] offset:2576
  ds_write_b64 v80, v[132:133] offset:2584
  ds_write_b32 v80, v134 offset:2592
  ds_read_b64_tr_b16 v[52:53], v81 offset:640
  ds_read_b64_tr_b16 v[54:55], v81 offset:800
  ds_read_b128 v[64:67], v77 offset:2048
  ds_read_b128 v[68:71], v77 offset:38912
  s_waitcnt lgkmcnt(9)
  v_mfma_f32_32x32x16_bf16 v[16:31], v[48:51], v[56:59], v[16:31]
  v_mfma_f32_32x32x16_bf16 v[32:47], v[48:51], v[60:63], v[32:47]
  ds_read_b64_tr_b16 v[48:49], v81 offset:1280
  ds_read_b64_tr_b16 v[50:51], v81 offset:1440
  ds_read_b128 v[56:59], v78 offset:2048
  ds_read_b128 v[60:63], v78 offset:38912
  s_waitcnt lgkmcnt(4)
  v_mfma_f32_32x32x16_bf16 v[16:31], v[52:55], v[64:67], v[16:31]
  v_mfma_f32_32x32x16_bf16 v[32:47], v[52:55], v[68:71], v[32:47]
  ds_read_b64_tr_b16 v[52:53], v81 offset:1920
  ds_read_b64_tr_b16 v[54:55], v81 offset:2080
  ds_read_b128 v[64:67], v79 offset:2048
  ds_read_b128 v[68:71], v79 offset:38912
  s_waitcnt lgkmcnt(4)
  v_mfma_f32_32x32x16_bf16 v[16:31], v[48:51], v[56:59], v[16:31]
  v_mfma_f32_32x32x16_bf16 v[32:47], v[48:51], v[60:63], v[32:47]
  s_waitcnt vmcnt(37)
  s_mov_b64 exec, 1
  ds_add_u32 v245, v244 offset:76
  s_mov_b64 exec, -1
  s_mov_b32 s95, 400000
W_113:
  ds_read_b32 v12, v245 offset:76
  s_waitcnt lgkmcnt(0)
  v_readfirstlane_b32 s6, v12
  s_nop 3
  s_cmp_ge_u32 s6, 4
  s_cbranch_scc1 WD_114
  s_sleep 1
  s_sub_u32 s95, s95, 1
  s_cmp_lg_u32 s95, 0
  s_cbranch_scc1 W_113
WD_114:
  ds_read_b64_tr_b16 v[48:49], v81 offset:2560
  ds_read_b64_tr_b16 v[50:51], v81 offset:2720
  ds_read_b128 v[56:59], v76 offset:3072
  ds_read_b128 v[60:63], v76 offset:39936
  s_waitcnt lgkmcnt(4)
  v_mfma_f32_32x32x16_bf16 v[16:31], v[52:55], v[64:67], v[16:31]
  v_mfma_f32_32x32x16_bf16 v[32:47], v[52:55], v[68:71], v[32:47]
  s_waitcnt vmcnt(12)
  ds_write_b64 v80, v[136:137] offset:0
  ds_write_b64 v80, v[138:139] offset:8
  ds_write_b64 v80, v[140:141] offset:16
  ds_write_b64 v80, v[142:143] offset:24
  ds_write_b32 v80, v144 offset:32
  ds_read_b64_tr_b16 v[52:53], v81 offset:3200
  ds_read_b64_tr_b16 v[54:55], v81 offset:3360
  ds_read_b128 v[64:67], v77 offset:3072
  ds_read_b128 v[68:71], v77 offset:39936
  s_waitcnt lgkmcnt(9)
  v_mfma_f32_32x32x16_bf16 v[16:31], v[48:51], v[56:59], v[16:31]
  v_mfma_f32_32x32x16_bf16 v[32:47], v[48:51], v[60:63], v[32:47]
  ds_read_b64_tr_b16 v[48:49], v81 offset:3840
  ds_read_b64_tr_b16 v[50:51], v81 offset:4000
  ds_read_b128 v[56:59], v78 offset:3072
  ds_read_b128 v[60:63], v78 offset:39936
  s_waitcnt lgkmcnt(4)
  v_mfma_f32_32x32x16_bf16 v[16:31], v[52:55], v[64:67], v[16:31]
  v_mfma_f32_32x32x16_bf16 v[32:47], v[52:55], v[68:71], v[32:47]
  ds_read_b64_tr_b16 v[52:53], v81 offset:4480
  ds_read_b64_tr_b16 v[54:55], v81 offset:4640
  ds_read_b128 v[64:67], v79 offset:3072
  ds_read_b128 v[68:71], v79 offset:39936
  s_waitcnt lgkmcnt(4)
  v_mfma_f32_32x32x16_bf16 v[16:31], v[48:51], v[56:59], v[16:31]
  v_mfma_f32_32x32x16_bf16 v[32:47], v[48:51], v[60:63], v[32:47]
  s_waitcnt vmcnt(35)
  s_mov_b64 exec, 1
  ds_add_u32 v245, v244 offset:80
  s_mov_b64 exec, -1
  s_mov_b32 s95, 400000
W_115:
  ds_read_b32 v12, v245 offset:80
  s_waitcnt lgkmcnt(0)
  v_readfirstlane_b32 s6, v12
  s_nop 3
  s_cmp_ge_u32 s6, 4
  s_cbranch_scc1 WD_116
  s_sleep 1
  s_sub_u32 s95, s95, 1
  s_cmp_lg_u32 s95, 0
  s_cbranch_scc1 W_115
WD_116:
  ds_read_b64_tr_b16 v[48:49], v81 offset:0
  ds_read_b64_tr_b16 v[50:51], v81 offset:160
  ds_read_b128 v[56:59], v76 offset:4096
  ds_read_b128 v[60:63], v76 offset:40960
  s_waitcnt lgkmcnt(4)
  v_mfma_f32_32x32x16_bf16 v[16:31], v[52:55], v[64:67], v[16:31]
  v_mfma_f32_32x32x16_bf16 v[32:47], v[52:55], v[68:71], v[32:47]
  s_waitcnt vmcnt(9)
  ds_write_b64 v80, v[146:147] offset:2560
  ds_write_b64 v80, v[148:149] offset:2568
  ds_write_b64 v80, v[150:151] offset:2576
  ds_write_b64 v80, v[152:153] offset:2584
  ds_write_b32 v80, v154 offset:2592
  ds_read_b64_tr_b16 v[52:53], v81 offset:640
  ds_read_b64_tr_b16 v[54:55], v81 offset:800
  ds_read_b128 v[64:67], v77 offset:4096
  ds_read_b128 v[68:71], v77 offset:40960
  s_waitcnt lgkmcnt(9)
  v_mfma_f32_32x32x16_bf16 v[16:31], v[48:51], v[56:59], v[16:31]
  v_mfma_f32_32x32x16_bf16 v[32:47], v[48:51], v[60:63], v[32:47]
  ds_read_b64_tr_b16 v[48:49], v81 offset:1280
  ds_read_b64_tr_b16 v[50:51], v81 offset:1440
  ds_read_b128 v[56:59], v78 offset:4096
  ds_read_b128 v[60:63], v78 offset:40960
  s_waitcnt lgkmcnt(4)
  v_mfma_f32_32x32x16_bf16 v[16:31], v[52:55], v[64:67], v[16:31]
  v_mfma_f32_32x32x16_bf16 v[32:47], v[52:55], v[68:71], v[32:47]
  ds_read_b64_tr_b16 v[52:53], v81 offset:1920
  ds_read_b64_tr_b16 v[54:55], v81 offset:2080
  ds_read_b128 v[64:67], v79 offset:4096
  ds_read_b128 v[68:71], v79 offset:40960
  s_waitcnt lgkmcnt(4)
  v_mfma_f32_32x32x16_bf16 v[16:31], v[48:51], v[56:59], v[16:31]
  v_mfma_f32_32x32x16_bf16 v[32:47], v[48:51], v[60:63], v[32:47]
  s_waitcnt vmcnt(33)
  s_mov_b64 exec, 1
  ds_add_u32 v245, v244 offset:84
  s_mov_b64 exec, -1
  s_mov_b32 s95, 400000
W_117:
  ds_read_b32 v12, v245 offset:84
  s_waitcnt lgkmcnt(0)
  v_readfirstlane_b32 s6, v12
  s_nop 3
  s_cmp_ge_u32 s6, 4
  s_cbranch_scc1 WD_118
  s_sleep 1
  s_sub_u32 s95, s95, 1
  s_cmp_lg_u32 s95, 0
  s_cbranch_scc1 W_117
WD_118:
  ds_read_b64_tr_b16 v[48:49], v81 offset:2560
  ds_read_b64_tr_b16 v[50:51], v81 offset:2720
  ds_read_b128 v[56:59], v76 offset:5120
  ds_read_b128 v[60:63], v76 offset:41984
  s_waitcnt lgkmcnt(4)
  v_mfma_f32_32x32x16_bf16 v[16:31], v[52:55], v[64:67], v[16:31]
  v_mfma_f32_32x32x16_bf16 v[32:47], v[52:55], v[68:71], v[32:47]
  s_waitcnt vmcnt(6)
  ds_write_b64 v80, v[156:157] offset:0
  ds_write_b64 v80, v[158:159] offset:8
  ds_write_b64 v80, v[160:161] offset:16
  ds_write_b64 v80, v[162:163] offset:24
  ds_write_b32 v80, v164 offset:32
  ds_read_b64_tr_b16 v[52:53], v81 offset:3200
  ds_read_b64_tr_b16 v[54:55], v81 offset:3360
  ds_read_b128 v[64:67], v77 offset:5120
  ds_read_b128 v[68:71], v77 offset:41984
  s_waitcnt lgkmcnt(9)
  v_mfma_f32_32x32x16_bf16 v[16:31], v[48:51], v[56:59], v[16:31]
  v_mfma_f32_32x32x16_bf16 v[32:47], v[48:51], v[60:63], v[32:47]
  ds_read_b64_tr_b16 v[48:49], v81 offset:3840
  ds_read_b64_tr_b16 v[50:51], v81 offset:4000
  ds_read_b128 v[56:59], v78 offset:5120
  ds_read_b128 v[60:63], v78 offset:41984
  s_waitcnt lgkmcnt(4)
  v_mfma_f32_32x32x16_bf16 v[16:31], v[52:55], v[64:67], v[16:31]
  v_mfma_f32_32x32x16_bf16 v[32:47], v[52:55], v[68:71], v[32:47]
  ds_read_b64_tr_b16 v[52:53], v81 offset:4480
  ds_read_b64_tr_b16 v[54:55], v81 offset:4640
  ds_read_b128 v[64:67], v79 offset:5120
  ds_read_b128 v[68:71], v79 offset:41984
  s_waitcnt lgkmcnt(4)
  v_mfma_f32_32x32x16_bf16 v[16:31], v[48:51], v[56:59], v[16:31]
  v_mfma_f32_32x32x16_bf16 v[32:47], v[48:51], v[60:63], v[32:47]
  s_waitcnt vmcnt(31)
  s_mov_b64 exec, 1
  ds_add_u32 v245, v244 offset:88
  s_mov_b64 exec, -1
  s_mov_b32 s95, 400000
W_119:
  ds_read_b32 v12, v245 offset:88
  s_waitcnt lgkmcnt(0)
  v_readfirstlane_b32 s6, v12
  s_nop 3
  s_cmp_ge_u32 s6, 4
  s_cbranch_scc1 WD_120
  s_sleep 1
  s_sub_u32 s95, s95, 1
  s_cmp_lg_u32 s95, 0
  s_cbranch_scc1 W_119
WD_120:
  ds_read_b64_tr_b16 v[48:49], v81 offset:0
  ds_read_b64_tr_b16 v[50:51], v81 offset:160
  ds_read_b128 v[56:59], v76 offset:6144
  ds_read_b128 v[60:63], v76 offset:43008
  s_waitcnt lgkmcnt(4)
  v_mfma_f32_32x32x16_bf16 v[16:31], v[52:55], v[64:67], v[16:31]
  v_mfma_f32_32x32x16_bf16 v[32:47], v[52:55], v[68:71], v[32:47]
  s_waitcnt vmcnt(3)
  ds_write_b64 v80, v[166:167] offset:2560
  ds_write_b64 v80, v[168:169] offset:2568
  ds_write_b64 v80, v[170:171] offset:2576
  ds_write_b64 v80, v[172:173] offset:2584
  ds_write_b32 v80, v174 offset:2592
  ds_read_b64_tr_b16 v[52:53], v81 offset:640
  ds_read_b64_tr_b16 v[54:55], v81 offset:800
  ds_read_b128 v[64:67], v77 offset:6144
  ds_read_b128 v[68:71], v77 offset:43008
  s_waitcnt lgkmcnt(9)
  v_mfma_f32_32x32x16_bf16 v[16:31], v[48:51], v[56:59], v[16:31]
  v_mfma_f32_32x32x16_bf16 v[32:47], v[48:51], v[60:63], v[32:47]
  ds_read_b64_tr_b16 v[48:49], v81 offset:1280
  ds_read_b64_tr_b16 v[50:51], v81 offset:1440
  ds_read_b128 v[56:59], v78 offset:6144
  ds_read_b128 v[60:63], v78 offset:43008
  s_waitcnt lgkmcnt(4)
  v_mfma_f32_32x32x16_bf16 v[16:31], v[52:55], v[64:67], v[16:31]
  v_mfma_f32_32x32x16_bf16 v[32:47], v[52:55], v[68:71], v[32:47]
  ds_read_b64_tr_b16 v[52:53], v81 offset:1920
  ds_read_b64_tr_b16 v[54:55], v81 offset:2080
  ds_read_b128 v[64:67], v79 offset:6144
  ds_read_b128 v[68:71], v79 offset:43008
  s_waitcnt lgkmcnt(4)
  v_mfma_f32_32x32x16_bf16 v[16:31], v[48:51], v[56:59], v[16:31]
  v_mfma_f32_32x32x16_bf16 v[32:47], v[48:51], v[60:63], v[32:47]
  s_waitcnt vmcnt(29)
  s_mov_b64 exec, 1
  ds_add_u32 v245, v244 offset:92
  s_mov_b64 exec, -1
  s_mov_b32 s95, 400000
W_121:
  ds_read_b32 v12, v245 offset:92
  s_waitcnt lgkmcnt(0)
  v_readfirstlane_b32 s6, v12
  s_nop 3
  s_cmp_ge_u32 s6, 4
  s_cbranch_scc1 WD_122
  s_sleep 1
  s_sub_u32 s95, s95, 1
  s_cmp_lg_u32 s95, 0
  s_cbranch_scc1 W_121
WD_122:
  ds_read_b64_tr_b16 v[48:49], v81 offset:2560
  ds_read_b64_tr_b16 v[50:51], v81 offset:2720
  ds_read_b128 v[56:59], v76 offset:7168
  ds_read_b128 v[60:63], v76 offset:44032
  s_waitcnt lgkmcnt(4)
  v_mfma_f32_32x32x16_bf16 v[16:31], v[52:55], v[64:67], v[16:31]
  v_mfma_f32_32x32x16_bf16 v[32:47], v[52:55], v[68:71], v[32:47]
  s_waitcnt vmcnt(0)
  ds_write_b64 v80, v[176:177] offset:0
  ds_write_b64 v80, v[178:179] offset:8
  ds_write_b64 v80, v[180:181] offset:16
  ds_write_b64 v80, v[182:183] offset:24
  ds_write_b32 v80, v184 offset:32
  ds_read_b64_tr_b16 v[52:53], v81 offset:3200
  ds_read_b64_tr_b16 v[54:55], v81 offset:3360
  ds_read_b128 v[64:67], v77 offset:7168
  ds_read_b128 v[68:71], v77 offset:44032
  s_waitcnt lgkmcnt(9)
  v_mfma_f32_32x32x16_bf16 v[16:31], v[48:51], v[56:59], v[16:31]
  v_mfma_f32_32x32x16_bf16 v[32:47], v[48:51], v[60:63], v[32:47]
  ds_read_b64_tr_b16 v[48:49], v81 offset:3840
  ds_read_b64_tr_b16 v[50:51], v81 offset:4000
  ds_read_b128 v[56:59], v78 offset:7168
  ds_read_b128 v[60:63], v78 offset:44032
  s_waitcnt lgkmcnt(4)
  v_mfma_f32_32x32x16_bf16 v[16:31], v[52:55], v[64:67], v[16:31]
  v_mfma_f32_32x32x16_bf16 v[32:47], v[52:55], v[68:71], v[32:47]
  ds_read_b64_tr_b16 v[52:53], v81 offset:4480
  ds_read_b64_tr_b16 v[54:55], v81 offset:4640
  ds_read_b128 v[64:67], v79 offset:7168
  ds_read_b128 v[68:71], v79 offset:44032
  s_waitcnt lgkmcnt(4)
  v_mfma_f32_32x32x16_bf16 v[16:31], v[48:51], v[56:59], v[16:31]
  v_mfma_f32_32x32x16_bf16 v[32:47], v[48:51], v[60:63], v[32:47]
  s_waitcnt vmcnt(27)
  s_mov_b64 exec, 1
  ds_add_u32 v245, v244 offset:96
  s_mov_b64 exec, -1
  s_mov_b32 s95, 400000
W_123:
  ds_read_b32 v12, v245 offset:96
  s_waitcnt lgkmcnt(0)
  v_readfirstlane_b32 s6, v12
  s_nop 3
  s_cmp_ge_u32 s6, 4
  s_cbranch_scc1 WD_124
  s_sleep 1
  s_sub_u32 s95, s95, 1
  s_cmp_lg_u32 s95, 0
  s_cbranch_scc1 W_123
WD_124:
  ds_read_b64_tr_b16 v[48:49], v81 offset:0
  ds_read_b64_tr_b16 v[50:51], v81 offset:160
  ds_read_b128 v[56:59], v76 offset:8192
  ds_read_b128 v[60:63], v76 offset:45056
  s_waitcnt lgkmcnt(4)
  v_mfma_f32_32x32x16_bf16 v[16:31], v[52:55], v[64:67], v[16:31]
  v_mfma_f32_32x32x16_bf16 v[32:47], v[52:55], v[68:71], v[32:47]
  ds_read_b64_tr_b16 v[52:53], v81 offset:640
  ds_read_b64_tr_b16 v[54:55], v81 offset:800
  ds_read_b128 v[64:67], v77 offset:8192
  ds_read_b128 v[68:71], v77 offset:45056
  s_waitcnt lgkmcnt(4)
  v_mfma_f32_32x32x16_bf16 v[16:31], v[48:51], v[56:59], v[16:31]
  v_mfma_f32_32x32x16_bf16 v[32:47], v[48:51], v[60:63], v[32:47]
  ds_read_b64_tr_b16 v[48:49], v81 offset:1280
  ds_read_b64_tr_b16 v[50:51], v81 offset:1440
  ds_read_b128 v[56:59], v78 offset:8192
  ds_read_b128 v[60:63], v78 offset:45056
  s_waitcnt lgkmcnt(4)
  v_mfma_f32_32x32x16_bf16 v[16:31], v[52:55], v[64:67], v[16:31]
  v_mfma_f32_32x32x16_bf16 v[32:47], v[52:55], v[68:71], v[32:47]
  ds_read_b64_tr_b16 v[52:53], v81 offset:1920
  ds_read_b64_tr_b16 v[54:55], v81 offset:2080
  ds_read_b128 v[64:67], v79 offset:8192
  ds_read_b128 v[68:71], v79 offset:45056
  s_waitcnt lgkmcnt(4)
  v_mfma_f32_32x32x16_bf16 v[16:31], v[48:51], v[56:59], v[16:31]
  v_mfma_f32_32x32x16_bf16 v[32:47], v[48:51], v[60:63], v[32:47]
  s_waitcnt lgkmcnt(0)
  v_mfma_f32_32x32x16_bf16 v[16:31], v[52:55], v[64:67], v[16:31]
  v_mfma_f32_32x32x16_bf16 v[32:47], v[52:55], v[68:71], v[32:47]
  s_waitcnt lgkmcnt(0)
  s_mov_b64 s[92:93], exec
  s_mov_b64 exec, 1
  ds_add_u32 v245, v244 offset:8
  s_mov_b64 exec, s[92:93]
  s_mul_i32 s84, s4, 4608
  v_lshlrev_b32 v10, 4, v0
  v_lshlrev_b32 v11, 2, v3
  v_add_u32 v11, 1024, v11
  v_mov_b32 v12, 268435456
  v_cmp_lt_u32 vcc, 31, v0
  s_nop 7
  v_cndmask_b32 v11, v11, v12, vcc
  v_cvt_pk_bf16_f32 v48, v16, v17
  v_cvt_pk_bf16_f32 v49, v18, v19
  v_cvt_pk_bf16_f32 v50, v20, v21
  v_cvt_pk_bf16_f32 v51, v22, v23
  v_cvt_pk_bf16_f32 v56, v24, v25
  buffer_store_dwordx4 v[48:51], v10, s[44:47], s84 offen offset:0 sc1
  buffer_store_dword v56, v11, s[44:47], s84 offen offset:0 sc1
  v_cvt_pk_bf16_f32 v52, v32, v33
  v_cvt_pk_bf16_f32 v53, v34, v35
  v_cvt_pk_bf16_f32 v54, v36, v37
  v_cvt_pk_bf16_f32 v55, v38, v39
  v_cvt_pk_bf16_f32 v57, v40, v41
  buffer_store_dwordx4 v[52:55], v10, s[44:47], s84 offen offset:2304 sc1
  buffer_store_dword v57, v11, s[44:47], s84 offen offset:2304 sc1
  s_branch L_A3_PUB
L_A3_V:
  s_waitcnt vmcnt(43)
  s_mov_b64 exec, 1
  ds_add_u32 v245, v244 offset:64
  s_mov_b64 exec, -1
  s_waitcnt vmcnt(24)
  ds_write_b64 v80, v[96:97] offset:0
  ds_write_b64 v80, v[98:99] offset:8
  ds_write_b64 v80, v[100:101] offset:16
  ds_write_b64 v80, v[102:103] offset:24
  ds_write_b32 v80, v104 offset:32
  s_mov_b32 s95, 400000
W_125:
  ds_read_b32 v12, v245 offset:64
  s_waitcnt lgkmcnt(0)
  v_readfirstlane_b32 s6, v12
  s_nop 3
  s_cmp_ge_u32 s6, 4
  s_cbranch_scc1 WD_126
  s_sleep 1
  s_sub_u32 s95, s95, 1
  s_cmp_lg_u32 s95, 0
  s_cbranch_scc1 W_125
WD_126:
  ds_read_b64_tr_b16 v[48:49], v81 offset:0
  ds_read_b64_tr_b16 v[50:51], v81 offset:160
  ds_read_b128 v[56:59], v76 offset:0
  ds_read_b128 v[60:63], v76 offset:36864
  s_waitcnt vmcnt(21)
  ds_write_b64 v80, v[106:107] offset:2560
  ds_write_b64 v80, v[108:109] offset:2568
  ds_write_b64 v80, v[110:111] offset:2576
  ds_write_b64 v80, v[112:113] offset:2584
  ds_write_b32 v80, v114 offset:2592
  ds_read_b64_tr_b16 v[52:53], v81 offset:640
  ds_read_b64_tr_b16 v[54:55], v81 offset:800
  ds_read_b128 v[64:67], v77 offset:0
  ds_read_b128 v[68:71], v77 offset:36864
  s_waitcnt lgkmcnt(9)
  v_mfma_f32_32x32x16_bf16 v[16:31], v[56:59], v[48:51], 0
  v_mfma_f32_32x32x16_bf16 v[32:47], v[60:63], v[48:51], 0
  ds_read_b64_tr_b16 v[48:49], v81 offset:1280
  ds_read_b64_tr_b16 v[50:51], v81 offset:1440
  ds_read_b128 v[56:59], v78 offset:0
  ds_read_b128 v[60:63], v78 offset:36864
  s_waitcnt lgkmcnt(4)
  v_mfma_f32_32x32x16_bf16 v[16:31], v[64:67], v[52:55], v[16:31]
  v_mfma_f32_32x32x16_bf16 v[32:47], v[68:71], v[52:55], v[32:47]
  ds_read_b64_tr_b16 v[52:53], v81 offset:1920
  ds_read_b64_tr_b16 v[54:55], v81 offset:2080
  ds_read_b128 v[64:67], v79 offset:0
  ds_read_b128 v[68:71], v79 offset:36864
  s_waitcnt lgkmcnt(4)
  v_mfma_f32_32x32x16_bf16 v[16:31], v[56:59], v[48:51], v[16:31]
  v_mfma_f32_32x32x16_bf16 v[32:47], v[60:63], v[48:51], v[32:47]
  s_waitcnt vmcnt(41)
  s_mov_b64 exec, 1
  ds_add_u32 v245, v244 offset:68
  s_mov_b64 exec, -1
  s_mov_b32 s95, 400000
W_127:
  ds_read_b32 v12, v245 offset:68
  s_waitcnt lgkmcnt(0)
  v_readfirstlane_b32 s6, v12
  s_nop 3
  s_cmp_ge_u32 s6, 4
  s_cbranch_scc1 WD_128
  s_sleep 1
  s_sub_u32 s95, s95, 1
  s_cmp_lg_u32 s95, 0
  s_cbranch_scc1 W_127
WD_128:
  ds_read_b64_tr_b16 v[48:49], v81 offset:2560
  ds_read_b64_tr_b16 v[50:51], v81 offset:2720
  ds_read_b128 v[56:59], v76 offset:1024
  ds_read_b128 v[60:63], v76 offset:37888
  s_waitcnt lgkmcnt(4)
  v_mfma_f32_32x32x16_bf16 v[16:31], v[64:67], v[52:55], v[16:31]
  v_mfma_f32_32x32x16_bf16 v[32:47], v[68:71], v[52:55], v[32:47]
  s_waitcnt vmcnt(18)
  ds_write_b64 v80, v[116:117] offset:0
  ds_write_b64 v80, v[118:119] offset:8
  ds_write_b64 v80, v[120:121] offset:16
  ds_write_b64 v80, v[122:123] offset:24
  ds_write_b32 v80, v124 offset:32
  ds_read_b64_tr_b16 v[52:53], v81 offset:3200
  ds_read_b64_tr_b16 v[54:55], v81 offset:3360
  ds_read_b128 v[64:67], v77 offset:1024
  ds_read_b128 v[68:71], v77 offset:37888
  s_waitcnt lgkmcnt(9)
  v_mfma_f32_32x32x16_bf16 v[16:31], v[56:59], v[48:51], v[16:31]
  v_mfma_f32_32x32x16_bf16 v[32:47], v[60:63], v[48:51], v[32:47]
  ds_read_b64_tr_b16 v[48:49], v81 offset:3840
  ds_read_b64_tr_b16 v[50:51], v81 offset:4000
  ds_read_b128 v[56:59], v78 offset:1024
  ds_read_b128 v[60:63], v78 offset:37888
  s_waitcnt lgkmcnt(4)
  v_mfma_f32_32x32x16_bf16 v[16:31], v[64:67], v[52:55], v[16:31]
  v_mfma_f32_32x32x16_bf16 v[32:47], v[68:71], v[52:55], v[32:47]
  ds_read_b64_tr_b16 v[52:53], v81 offset:4480
  ds_read_b64_tr_b16 v[54:55], v81 offset:4640
  ds_read_b128 v[64:67], v79 offset:1024
  ds_read_b128 v[68:71], v79 offset:37888
  s_waitcnt lgkmcnt(4)
  v_mfma_f32_32x32x16_bf16 v[16:31], v[56:59], v[48:51], v[16:31]
  v_mfma_f32_32x32x16_bf16 v[32:47], v[60:63], v[48:51], v[32:47]
  s_waitcnt vmcnt(39)
  s_mov_b64 exec, 1
  ds_add_u32 v245, v244 offset:72
  s_mov_b64 exec, -1
  s_mov_b32 s95, 400000
W_129:
  ds_read_b32 v12, v245 offset:72
  s_waitcnt lgkmcnt(0)
  v_readfirstlane_b32 s6, v12
  s_nop 3
  s_cmp_ge_u32 s6, 4
  s_cbranch_scc1 WD_130
  s_sleep 1
  s_sub_u32 s95, s95, 1
  s_cmp_lg_u32 s95, 0
  s_cbranch_scc1 W_129
WD_130:
  ds_read_b64_tr_b16 v[48:49], v81 offset:0
  ds_read_b64_tr_b16 v[50:51], v81 offset:160
  ds_read_b128 v[56:59], v76 offset:2048
  ds_read_b128 v[60:63], v76 offset:38912
  s_waitcnt lgkmcnt(4)
  v_mfma_f32_32x32x16_bf16 v[16:31], v[64:67], v[52:55], v[16:31]
  v_mfma_f32_32x32x16_bf16 v[32:47], v[68:71], v[52:55], v[32:47]
  s_waitcnt vmcnt(15)
  ds_write_b64 v80, v[126:127] offset:2560
  ds_write_b64 v80, v[128:129] offset:2568
  ds_write_b64 v80, v[130:131] offset:2576
  ds_write_b64 v80, v[132:133] offset:2584
  ds_write_b32 v80, v134 offset:2592
  ds_read_b64_tr_b16 v[52:53], v81 offset:640
  ds_read_b64_tr_b16 v[54:55], v81 offset:800
  ds_read_b128 v[64:67], v77 offset:2048
  ds_read_b128 v[68:71], v77 offset:38912
  s_waitcnt lgkmcnt(9)
  v_mfma_f32_32x32x16_bf16 v[16:31], v[56:59], v[48:51], v[16:31]
  v_mfma_f32_32x32x16_bf16 v[32:47], v[60:63], v[48:51], v[32:47]
  ds_read_b64_tr_b16 v[48:49], v81 offset:1280
  ds_read_b64_tr_b16 v[50:51], v81 offset:1440
  ds_read_b128 v[56:59], v78 offset:2048
  ds_read_b128 v[60:63], v78 offset:38912
  s_waitcnt lgkmcnt(4)
  v_mfma_f32_32x32x16_bf16 v[16:31], v[64:67], v[52:55], v[16:31]
  v_mfma_f32_32x32x16_bf16 v[32:47], v[68:71], v[52:55], v[32:47]
  ds_read_b64_tr_b16 v[52:53], v81 offset:1920
  ds_read_b64_tr_b16 v[54:55], v81 offset:2080
  ds_read_b128 v[64:67], v79 offset:2048
  ds_read_b128 v[68:71], v79 offset:38912
  s_waitcnt lgkmcnt(4)
  v_mfma_f32_32x32x16_bf16 v[16:31], v[56:59], v[48:51], v[16:31]
  v_mfma_f32_32x32x16_bf16 v[32:47], v[60:63], v[48:51], v[32:47]
  s_waitcnt vmcnt(37)
  s_mov_b64 exec, 1
  ds_add_u32 v245, v244 offset:76
  s_mov_b64 exec, -1
  s_mov_b32 s95, 400000
W_131:
  ds_read_b32 v12, v245 offset:76
  s_waitcnt lgkmcnt(0)
  v_readfirstlane_b32 s6, v12
  s_nop 3
  s_cmp_ge_u32 s6, 4
  s_cbranch_scc1 WD_132
  s_sleep 1
  s_sub_u32 s95, s95, 1
  s_cmp_lg_u32 s95, 0
  s_cbranch_scc1 W_131
WD_132:
  ds_read_b64_tr_b16 v[48:49], v81 offset:2560
  ds_read_b64_tr_b16 v[50:51], v81 offset:2720
  ds_read_b128 v[56:59], v76 offset:3072
  ds_read_b128 v[60:63], v76 offset:39936
  s_waitcnt lgkmcnt(4)
  v_mfma_f32_32x32x16_bf16 v[16:31], v[64:67], v[52:55], v[16:31]
  v_mfma_f32_32x32x16_bf16 v[32:47], v[68:71], v[52:55], v[32:47]
  s_waitcnt vmcnt(12)
  ds_write_b64 v80, v[136:137] offset:0
  ds_write_b64 v80, v[138:139] offset:8
  ds_write_b64 v80, v[140:141] offset:16
  ds_write_b64 v80, v[142:143] offset:24
  ds_write_b32 v80, v144 offset:32
  ds_read_b64_tr_b16 v[52:53], v81 offset:3200
  ds_read_b64_tr_b16 v[54:55], v81 offset:3360
  ds_read_b128 v[64:67], v77 offset:3072
  ds_read_b128 v[68:71], v77 offset:39936
  s_waitcnt lgkmcnt(9)
  v_mfma_f32_32x32x16_bf16 v[16:31], v[56:59], v[48:51], v[16:31]
  v_mfma_f32_32x32x16_bf16 v[32:47], v[60:63], v[48:51], v[32:47]
  ds_read_b64_tr_b16 v[48:49], v81 offset:3840
  ds_read_b64_tr_b16 v[50:51], v81 offset:4000
  ds_read_b128 v[56:59], v78 offset:3072
  ds_read_b128 v[60:63], v78 offset:39936
  s_waitcnt lgkmcnt(4)
  v_mfma_f32_32x32x16_bf16 v[16:31], v[64:67], v[52:55], v[16:31]
  v_mfma_f32_32x32x16_bf16 v[32:47], v[68:71], v[52:55], v[32:47]
  ds_read_b64_tr_b16 v[52:53], v81 offset:4480
  ds_read_b64_tr_b16 v[54:55], v81 offset:4640
  ds_read_b128 v[64:67], v79 offset:3072
  ds_read_b128 v[68:71], v79 offset:39936
  s_waitcnt lgkmcnt(4)
  v_mfma_f32_32x32x16_bf16 v[16:31], v[56:59], v[48:51], v[16:31]
  v_mfma_f32_32x32x16_bf16 v[32:47], v[60:63], v[48:51], v[32:47]
  s_waitcnt vmcnt(35)
  s_mov_b64 exec, 1
  ds_add_u32 v245, v244 offset:80
  s_mov_b64 exec, -1
  s_mov_b32 s95, 400000
W_133:
  ds_read_b32 v12, v245 offset:80
  s_waitcnt lgkmcnt(0)
  v_readfirstlane_b32 s6, v12
  s_nop 3
  s_cmp_ge_u32 s6, 4
  s_cbranch_scc1 WD_134
  s_sleep 1
  s_sub_u32 s95, s95, 1
  s_cmp_lg_u32 s95, 0
  s_cbranch_scc1 W_133
WD_134:
  ds_read_b64_tr_b16 v[48:49], v81 offset:0
  ds_read_b64_tr_b16 v[50:51], v81 offset:160
  ds_read_b128 v[56:59], v76 offset:4096
  ds_read_b128 v[60:63], v76 offset:40960
  s_waitcnt lgkmcnt(4)
  v_mfma_f32_32x32x16_bf16 v[16:31], v[64:67], v[52:55], v[16:31]
  v_mfma_f32_32x32x16_bf16 v[32:47], v[68:71], v[52:55], v[32:47]
  s_waitcnt vmcnt(9)
  ds_write_b64 v80, v[146:147] offset:2560
  ds_write_b64 v80, v[148:149] offset:2568
  ds_write_b64 v80, v[150:151] offset:2576
  ds_write_b64 v80, v[152:153] offset:2584
  ds_write_b32 v80, v154 offset:2592
  ds_read_b64_tr_b16 v[52:53], v81 offset:640
  ds_read_b64_tr_b16 v[54:55], v81 offset:800
  ds_read_b128 v[64:67], v77 offset:4096
  ds_read_b128 v[68:71], v77 offset:40960
  s_waitcnt lgkmcnt(9)
  v_mfma_f32_32x32x16_bf16 v[16:31], v[56:59], v[48:51], v[16:31]
  v_mfma_f32_32x32x16_bf16 v[32:47], v[60:63], v[48:51], v[32:47]
  ds_read_b64_tr_b16 v[48:49], v81 offset:1280
  ds_read_b64_tr_b16 v[50:51], v81 offset:1440
  ds_read_b128 v[56:59], v78 offset:4096
  ds_read_b128 v[60:63], v78 offset:40960
  s_waitcnt lgkmcnt(4)
  v_mfma_f32_32x32x16_bf16 v[16:31], v[64:67], v[52:55], v[16:31]
  v_mfma_f32_32x32x16_bf16 v[32:47], v[68:71], v[52:55], v[32:47]
  ds_read_b64_tr_b16 v[52:53], v81 offset:1920
  ds_read_b64_tr_b16 v[54:55], v81 offset:2080
  ds_read_b128 v[64:67], v79 offset:4096
  ds_read_b128 v[68:71], v79 offset:40960
  s_waitcnt lgkmcnt(4)
  v_mfma_f32_32x32x16_bf16 v[16:31], v[56:59], v[48:51], v[16:31]
  v_mfma_f32_32x32x16_bf16 v[32:47], v[60:63], v[48:51], v[32:47]
  s_waitcnt vmcnt(33)
  s_mov_b64 exec, 1
  ds_add_u32 v245, v244 offset:84
  s_mov_b64 exec, -1
  s_mov_b32 s95, 400000
W_135:
  ds_read_b32 v12, v245 offset:84
  s_waitcnt lgkmcnt(0)
  v_readfirstlane_b32 s6, v12
  s_nop 3
  s_cmp_ge_u32 s6, 4
  s_cbranch_scc1 WD_136
  s_sleep 1
  s_sub_u32 s95, s95, 1
  s_cmp_lg_u32 s95, 0
  s_cbranch_scc1 W_135
WD_136:
  ds_read_b64_tr_b16 v[48:49], v81 offset:2560
  ds_read_b64_tr_b16 v[50:51], v81 offset:2720
  ds_read_b128 v[56:59], v76 offset:5120
  ds_read_b128 v[60:63], v76 offset:41984
  s_waitcnt lgkmcnt(4)
  v_mfma_f32_32x32x16_bf16 v[16:31], v[64:67], v[52:55], v[16:31]
  v_mfma_f32_32x32x16_bf16 v[32:47], v[68:71], v[52:55], v[32:47]
  s_waitcnt vmcnt(6)
  ds_write_b64 v80, v[156:157] offset:0
  ds_write_b64 v80, v[158:159] offset:8
  ds_write_b64 v80, v[160:161] offset:16
  ds_write_b64 v80, v[162:163] offset:24
  ds_write_b32 v80, v164 offset:32
  ds_read_b64_tr_b16 v[52:53], v81 offset:3200
  ds_read_b64_tr_b16 v[54:55], v81 offset:3360
  ds_read_b128 v[64:67], v77 offset:5120
  ds_read_b128 v[68:71], v77 offset:41984
  s_waitcnt lgkmcnt(9)
  v_mfma_f32_32x32x16_bf16 v[16:31], v[56:59], v[48:51], v[16:31]
  v_mfma_f32_32x32x16_bf16 v[32:47], v[60:63], v[48:51], v[32:47]
  ds_read_b64_tr_b16 v[48:49], v81 offset:3840
  ds_read_b64_tr_b16 v[50:51], v81 offset:4000
  ds_read_b128 v[56:59], v78 offset:5120
  ds_read_b128 v[60:63], v78 offset:41984
  s_waitcnt lgkmcnt(4)
  v_mfma_f32_32x32x16_bf16 v[16:31], v[64:67], v[52:55], v[16:31]
  v_mfma_f32_32x32x16_bf16 v[32:47], v[68:71], v[52:55], v[32:47]
  ds_read_b64_tr_b16 v[52:53], v81 offset:4480
  ds_read_b64_tr_b16 v[54:55], v81 offset:4640
  ds_read_b128 v[64:67], v79 offset:5120
  ds_read_b128 v[68:71], v79 offset:41984
  s_waitcnt lgkmcnt(4)
  v_mfma_f32_32x32x16_bf16 v[16:31], v[56:59], v[48:51], v[16:31]
  v_mfma_f32_32x32x16_bf16 v[32:47], v[60:63], v[48:51], v[32:47]
  s_waitcnt vmcnt(31)
  s_mov_b64 exec, 1
  ds_add_u32 v245, v244 offset:88
  s_mov_b64 exec, -1
  s_mov_b32 s95, 400000
W_137:
  ds_read_b32 v12, v245 offset:88
  s_waitcnt lgkmcnt(0)
  v_readfirstlane_b32 s6, v12
  s_nop 3
  s_cmp_ge_u32 s6, 4
  s_cbranch_scc1 WD_138
  s_sleep 1
  s_sub_u32 s95, s95, 1
  s_cmp_lg_u32 s95, 0
  s_cbranch_scc1 W_137
WD_138:
  ds_read_b64_tr_b16 v[48:49], v81 offset:0
  ds_read_b64_tr_b16 v[50:51], v81 offset:160
  ds_read_b128 v[56:59], v76 offset:6144
  ds_read_b128 v[60:63], v76 offset:43008
  s_waitcnt lgkmcnt(4)
  v_mfma_f32_32x32x16_bf16 v[16:31], v[64:67], v[52:55], v[16:31]
  v_mfma_f32_32x32x16_bf16 v[32:47], v[68:71], v[52:55], v[32:47]
  s_waitcnt vmcnt(3)
  ds_write_b64 v80, v[166:167] offset:2560
  ds_write_b64 v80, v[168:169] offset:2568
  ds_write_b64 v80, v[170:171] offset:2576
  ds_write_b64 v80, v[172:173] offset:2584
  ds_write_b32 v80, v174 offset:2592
  ds_read_b64_tr_b16 v[52:53], v81 offset:640
  ds_read_b64_tr_b16 v[54:55], v81 offset:800
  ds_read_b128 v[64:67], v77 offset:6144
  ds_read_b128 v[68:71], v77 offset:43008
  s_waitcnt lgkmcnt(9)
  v_mfma_f32_32x32x16_bf16 v[16:31], v[56:59], v[48:51], v[16:31]
  v_mfma_f32_32x32x16_bf16 v[32:47], v[60:63], v[48:51], v[32:47]
  ds_read_b64_tr_b16 v[48:49], v81 offset:1280
  ds_read_b64_tr_b16 v[50:51], v81 offset:1440
  ds_read_b128 v[56:59], v78 offset:6144
  ds_read_b128 v[60:63], v78 offset:43008
  s_waitcnt lgkmcnt(4)
  v_mfma_f32_32x32x16_bf16 v[16:31], v[64:67], v[52:55], v[16:31]
  v_mfma_f32_32x32x16_bf16 v[32:47], v[68:71], v[52:55], v[32:47]
  ds_read_b64_tr_b16 v[52:53], v81 offset:1920
  ds_read_b64_tr_b16 v[54:55], v81 offset:2080
  ds_read_b128 v[64:67], v79 offset:6144
  ds_read_b128 v[68:71], v79 offset:43008
  s_waitcnt lgkmcnt(4)
  v_mfma_f32_32x32x16_bf16 v[16:31], v[56:59], v[48:51], v[16:31]
  v_mfma_f32_32x32x16_bf16 v[32:47], v[60:63], v[48:51], v[32:47]
  s_waitcnt vmcnt(29)
  s_mov_b64 exec, 1
  ds_add_u32 v245, v244 offset:92
  s_mov_b64 exec, -1
  s_mov_b32 s95, 400000
W_139:
  ds_read_b32 v12, v245 offset:92
  s_waitcnt lgkmcnt(0)
  v_readfirstlane_b32 s6, v12
  s_nop 3
  s_cmp_ge_u32 s6, 4
  s_cbranch_scc1 WD_140
  s_sleep 1
  s_sub_u32 s95, s95, 1
  s_cmp_lg_u32 s95, 0
  s_cbranch_scc1 W_139
WD_140:
  ds_read_b64_tr_b16 v[48:49], v81 offset:2560
  ds_read_b64_tr_b16 v[50:51], v81 offset:2720
  ds_read_b128 v[56:59], v76 offset:7168
  ds_read_b128 v[60:63], v76 offset:44032
  s_waitcnt lgkmcnt(4)
  v_mfma_f32_32x32x16_bf16 v[16:31], v[64:67], v[52:55], v[16:31]
  v_mfma_f32_32x32x16_bf16 v[32:47], v[68:71], v[52:55], v[32:47]
  s_waitcnt vmcnt(0)
  ds_write_b64 v80, v[176:177] offset:0
  ds_write_b64 v80, v[178:179] offset:8
  ds_write_b64 v80, v[180:181] offset:16
  ds_write_b64 v80, v[182:183] offset:24
  ds_write_b32 v80, v184 offset:32
  ds_read_b64_tr_b16 v[52:53], v81 offset:3200
  ds_read_b64_tr_b16 v[54:55], v81 offset:3360
  ds_read_b128 v[64:67], v77 offset:7168
  ds_read_b128 v[68:71], v77 offset:44032
  s_waitcnt lgkmcnt(9)
  v_mfma_f32_32x32x16_bf16 v[16:31], v[56:59], v[48:51], v[16:31]
  v_mfma_f32_32x32x16_bf16 v[32:47], v[60:63], v[48:51], v[32:47]
  ds_read_b64_tr_b16 v[48:49], v81 offset:3840
  ds_read_b64_tr_b16 v[50:51], v81 offset:4000
  ds_read_b128 v[56:59], v78 offset:7168
  ds_read_b128 v[60:63], v78 offset:44032
  s_waitcnt lgkmcnt(4)
  v_mfma_f32_32x32x16_bf16 v[16:31], v[64:67], v[52:55], v[16:31]
  v_mfma_f32_32x32x16_bf16 v[32:47], v[68:71], v[52:55], v[32:47]
  ds_read_b64_tr_b16 v[52:53], v81 offset:4480
  ds_read_b64_tr_b16 v[54:55], v81 offset:4640
  ds_read_b128 v[64:67], v79 offset:7168
  ds_read_b128 v[68:71], v79 offset:44032
  s_waitcnt lgkmcnt(4)
  v_mfma_f32_32x32x16_bf16 v[16:31], v[56:59], v[48:51], v[16:31]
  v_mfma_f32_32x32x16_bf16 v[32:47], v[60:63], v[48:51], v[32:47]
  s_waitcnt vmcnt(27)
  s_mov_b64 exec, 1
  ds_add_u32 v245, v244 offset:96
  s_mov_b64 exec, -1
  s_mov_b32 s95, 400000
W_141:
  ds_read_b32 v12, v245 offset:96
  s_waitcnt lgkmcnt(0)
  v_readfirstlane_b32 s6, v12
  s_nop 3
  s_cmp_ge_u32 s6, 4
  s_cbranch_scc1 WD_142
  s_sleep 1
  s_sub_u32 s95, s95, 1
  s_cmp_lg_u32 s95, 0
  s_cbranch_scc1 W_141
WD_142:
  ds_read_b64_tr_b16 v[48:49], v81 offset:0
  ds_read_b64_tr_b16 v[50:51], v81 offset:160
  ds_read_b128 v[56:59], v76 offset:8192
  ds_read_b128 v[60:63], v76 offset:45056
  s_waitcnt lgkmcnt(4)
  v_mfma_f32_32x32x16_bf16 v[16:31], v[64:67], v[52:55], v[16:31]
  v_mfma_f32_32x32x16_bf16 v[32:47], v[68:71], v[52:55], v[32:47]
  ds_read_b64_tr_b16 v[52:53], v81 offset:640
  ds_read_b64_tr_b16 v[54:55], v81 offset:800
  ds_read_b128 v[64:67], v77 offset:8192
  ds_read_b128 v[68:71], v77 offset:45056
  s_waitcnt lgkmcnt(4)
  v_mfma_f32_32x32x16_bf16 v[16:31], v[56:59], v[48:51], v[16:31]
  v_mfma_f32_32x32x16_bf16 v[32:47], v[60:63], v[48:51], v[32:47]
  ds_read_b64_tr_b16 v[48:49], v81 offset:1280
  ds_read_b64_tr_b16 v[50:51], v81 offset:1440
  ds_read_b128 v[56:59], v78 offset:8192
  ds_read_b128 v[60:63], v78 offset:45056
  s_waitcnt lgkmcnt(4)
  v_mfma_f32_32x32x16_bf16 v[16:31], v[64:67], v[52:55], v[16:31]
  v_mfma_f32_32x32x16_bf16 v[32:47], v[68:71], v[52:55], v[32:47]
  ds_read_b64_tr_b16 v[52:53], v81 offset:1920
  ds_read_b64_tr_b16 v[54:55], v81 offset:2080
  ds_read_b128 v[64:67], v79 offset:8192
  ds_read_b128 v[68:71], v79 offset:45056
  s_waitcnt lgkmcnt(4)
  v_mfma_f32_32x32x16_bf16 v[16:31], v[56:59], v[48:51], v[16:31]
  v_mfma_f32_32x32x16_bf16 v[32:47], v[60:63], v[48:51], v[32:47]
  s_waitcnt lgkmcnt(0)
  v_mfma_f32_32x32x16_bf16 v[16:31], v[64:67], v[52:55], v[16:31]
  v_mfma_f32_32x32x16_bf16 v[32:47], v[68:71], v[52:55], v[32:47]
  s_waitcnt lgkmcnt(0)
  s_mov_b64 s[92:93], exec
  s_mov_b64 exec, 1
  ds_add_u32 v245, v244 offset:8
  s_mov_b64 exec, s[92:93]
  s_mul_i32 s84, s4, 4608
  v_mul_u32_u24 v10, 288, v4
  v_lshlrev_b32 v11, 4, v3
  v_add_u32 v10, v10, v11
  v_add_u32 v10, 1152, v10
  v_mov_b32 v12, 268435456
  v_cmp_lt_u32 vcc, 17, v3
  s_nop 7
  v_cndmask_b32 v10, v10, v12, vcc
  v_cvt_pk_bf16_f32 v48, v16, v17
  v_cvt_pk_bf16_f32 v49, v18, v19
  v_cvt_pk_bf16_f32 v50, v20, v21
  v_cvt_pk_bf16_f32 v51, v22, v23
  buffer_store_dwordx4 v[48:51], v10, s[44:47], s84 offen offset:0 sc1
  v_cvt_pk_bf16_f32 v52, v24, v25
  v_cvt_pk_bf16_f32 v53, v26, v27
  v_cvt_pk_bf16_f32 v54, v28, v29
  v_cvt_pk_bf16_f32 v55, v30, v31
  buffer_store_dwordx4 v[52:55], v10, s[44:47], s84 offen offset:576 sc1
  v_cvt_pk_bf16_f32 v56, v32, v33
  v_cvt_pk_bf16_f32 v57, v34, v35
  v_cvt_pk_bf16_f32 v58, v36, v37
  v_cvt_pk_bf16_f32 v59, v38, v39
  buffer_store_dwordx4 v[56:59], v10, s[44:47], s84 offen offset:2304 sc1
  v_cvt_pk_bf16_f32 v60, v40, v41
  v_cvt_pk_bf16_f32 v61, v42, v43
  v_cvt_pk_bf16_f32 v62, v44, v45
  v_cvt_pk_bf16_f32 v63, v46, v47
  buffer_store_dwordx4 v[60:63], v10, s[44:47], s84 offen offset:2880 sc1
L_A3_PUB:
  s_waitcnt vmcnt(0)
  s_cmp_lt_u32 s59, 2
  s_cbranch_scc0 L_A3_NOKV
  s_mov_b32 s95, 400000
W_143:
  ds_read_b32 v10, v245 offset:100
  s_waitcnt lgkmcnt(0)
  v_readfirstlane_b32 s6, v10
  s_nop 3
  s_cmp_ge_u32 s6, 1
  s_cbranch_scc1 WD_144
  s_sleep 1
  s_sub_u32 s95, s95, 1
  s_cmp_lg_u32 s95, 0
  s_cbranch_scc1 W_143
WD_144:
  s_lshl_b32 s6, s4, 3
  s_lshl_b32 s7, s59, 2
  s_add_u32 s6, s6, s7
  s_add_u32 s6, s6, 229376
  v_lshlrev_b32 v10, 8, v0
  s_mov_b64 exec, 0xffff
  buffer_store_dword v244, v10, s[44:47], s6 offen sc1
  s_mov_b64 exec, -1
L_A3_NOKV:
  s_mov_b32 s95, 400000
W_145:
  ds_read_b32 v10, v245 offset:60
  s_waitcnt lgkmcnt(0)
  v_readfirstlane_b32 s6, v10
  s_nop 3
  s_cmp_ge_u32 s6, 3
  s_cbranch_scc1 WD_146
  s_sleep 1
  s_sub_u32 s95, s95, 1
  s_cmp_lg_u32 s95, 0
  s_cbranch_scc1 W_145
WD_146:
  v_mov_b32 v12, 0
  buffer_load_dword v14, v12, s[40:43], 0 offen
  s_waitcnt vmcnt(0)
  s_mov_b32 s95, 100000
L_C1POLL:
  v_readfirstlane_b32 s6, v14
  s_nop 3
  s_cmp_ge_u32 s6, 64
  s_cbranch_scc1 L_C1OK
  buffer_load_dword v14, v12, s[40:43], 0 offen sc1
  s_waitcnt vmcnt(0)
  v_readfirstlane_b32 s6, v14
  s_nop 3
  s_cmp_ge_u32 s6, 64
  s_cbranch_scc1 L_C1OK
  s_sleep 16
  s_sub_u32 s95, s95, 1
  s_cmp_lg_u32 s95, 0
  s_cbranch_scc1 L_C1POLL
L_C1OK:
  s_and_b32 s7, s91, 15
  s_lshl_b32 s7, s7, 8
  s_add_u32 s7, s7, 229376
  v_lshlrev_b32 v10, 2, v0
  s_mov_b32 s95, 200000
L_KVPOLL:
  buffer_load_dword v11, v10, s[44:47], s7 offen sc1
  s_waitcnt vmcnt(0)
  v_cmp_ne_u32 vcc, 1, v11
  s_nop 3
  s_cmp_eq_u64 vcc, 0
  s_cbranch_scc1 L_KVOK
  s_sleep 8
  s_sub_u32 s95, s95, 1
  s_cmp_lg_u32 s95, 0
  s_cbranch_scc1 L_KVPOLL
L_KVOK:
  s_mul_i32 s6, s91, 4608
  v_lshlrev_b32 v10, 7, v0
  v_mov_b32 v11, 268435456
  v_cmp_gt_u32 vcc, 36, v0
  s_nop 1
  v_cndmask_b32 v10, v11, v10, vcc
  buffer_load_dword v253, v10, s[44:47], s6 offen
  s_waitcnt lgkmcnt(0)
  s_mov_b64 s[92:93], exec
  s_mov_b64 exec, 1
  ds_add_u32 v245, v244 offset:16
  s_mov_b64 exec, s[92:93]
  v_and_b32 v3, 31, v0
  v_lshrrev_b32 v4, 5, v0
  v_cmp_gt_u32 s[84:85], 32, v0
  v_lshlrev_b32 v176, 4, v0
  v_lshlrev_b32 v177, 2, v3
  v_add_u32 v177, 1024, v177
  v_mul_u32_u24 v12, 288, v4
  v_lshlrev_b32 v13, 4, v3
  v_add_u32 v12, v12, v13
  v_add_u32 v190, 1152, v12
  v_cmp_gt_u32 s[60:61], 18, v3
  v_cmp_eq_u32 vcc, 18, v3
  v_mov_b32 v13, 0x3f803f80
  v_mov_b32 v149, 0x3f803f80
  v_mov_b32 v165, 0x3f803f80
  v_mov_b32 v189, 0x3f803f80
  s_mov_b32 s88, 0
  v_cndmask_b32 v152, 0, v13, vcc
  v_cndmask_b32 v153, 0, v13, vcc
  v_cndmask_b32 v154, 0, v13, vcc
  v_cndmask_b32 v155, 0, v13, vcc
  v_cndmask_b32 v156, 0, v13, vcc
  v_cndmask_b32 v157, 0, v13, vcc
  v_cndmask_b32 v158, 0, v13, vcc
  v_cndmask_b32 v159, 0, v13, vcc
  v_cndmask_b32 v168, 0, v13, vcc
  v_cndmask_b32 v169, 0, v13, vcc
  v_cndmask_b32 v170, 0, v13, vcc
  v_cndmask_b32 v171, 0, v13, vcc
  v_cndmask_b32 v172, 0, v13, vcc
  v_cndmask_b32 v173, 0, v13, vcc
  v_cndmask_b32 v174, 0, v13, vcc
  v_cndmask_b32 v175, 0, v13, vcc
  s_lshl_b32 s86, s80, 5
  s_mov_b32 s87, 0
  s_mul_i32 s70, s87, 2304
  buffer_load_dwordx4 v[184:187], v176, s[44:47], s70 offen
  buffer_load_dword v188, v177, s[44:47], s70 offen
  s_mov_b64 exec, s[60:61]
  v_mov_b32 v172, 0
  v_mov_b32 v173, 0
  v_mov_b32 v174, 0
  v_mov_b32 v175, 0
  s_mov_b64 exec, -1
  s_mul_i32 s70, s86, 2304
  buffer_load_dwordx4 v[144:147], v176, s[44:47], s70 offen
  buffer_load_dword v148, v177, s[44:47], s70 offen
  s_mul_i32 s70, s86, 2304
  s_mov_b64 exec, s[60:61]
  buffer_load_dwordx4 v[152:155], v190, s[44:47], s70 offen
  buffer_load_dwordx4 v[156:159], v190, s[44:47], s70 offen offset:576
  s_mov_b64 exec, -1
  s_add_u32 s87, s86, 1
  s_mul_i32 s70, s87, 2304
  buffer_load_dwordx4 v[160:163], v176, s[44:47], s70 offen
  buffer_load_dword v164, v177, s[44:47], s70 offen
  v_mov_b32 v80, 0
  v_mov_b32 v81, 0
  v_mov_b32 v82, 0
  v_mov_b32 v83, 0
  v_mov_b32 v84, 0
  v_mov_b32 v85, 0
  v_mov_b32 v86, 0
  v_mov_b32 v87, 0
  v_mov_b32 v88, 0
  v_mov_b32 v89, 0
  v_mov_b32 v90, 0
  v_mov_b32 v91, 0
  v_mov_b32 v92, 0
  v_mov_b32 v93, 0
  v_mov_b32 v94, 0
  v_mov_b32 v95, 0
  v_mov_b32 v96, 0
  v_mov_b32 v97, 0
  v_mov_b32 v98, 0
  v_mov_b32 v99, 0
  v_mov_b32 v100, 0
  v_mov_b32 v101, 0
  v_mov_b32 v102, 0
  v_mov_b32 v103, 0
  v_mov_b32 v104, 0
  v_mov_b32 v105, 0
  v_mov_b32 v106, 0
  v_mov_b32 v107, 0
  v_mov_b32 v108, 0
  v_mov_b32 v109, 0
  v_mov_b32 v110, 0
  v_mov_b32 v111, 0
  v_mov_b32 v112, 0
  v_mov_b32 v113, 0
  v_mov_b32 v114, 0
  v_mov_b32 v115, 0
  v_mov_b32 v116, 0
  v_mov_b32 v117, 0
  v_mov_b32 v118, 0
  v_mov_b32 v119, 0
  v_mov_b32 v120, 0
  v_mov_b32 v121, 0
  v_mov_b32 v122, 0
  v_mov_b32 v123, 0
  v_mov_b32 v124, 0
  v_mov_b32 v125, 0
  v_mov_b32 v126, 0
  v_mov_b32 v127, 0
  v_mov_b32 v128, 0
  v_mov_b32 v129, 0
  v_mov_b32 v130, 0
  v_mov_b32 v131, 0
  v_mov_b32 v132, 0
  v_mov_b32 v133, 0
  v_mov_b32 v134, 0
  v_mov_b32 v135, 0
  v_mov_b32 v136, 0
  v_mov_b32 v137, 0
  v_mov_b32 v138, 0
  v_mov_b32 v139, 0
  v_mov_b32 v140, 0
  v_mov_b32 v141, 0
  v_mov_b32 v142, 0
  v_mov_b32 v143, 0
  v_mov_b32 v72, 0
  v_mov_b32 v73, 0
  v_mov_b32 v74, 0
  v_mov_b32 v75, 0
  v_mov_b32 v76, 0
  v_mov_b32 v77, 0
  v_mov_b32 v78, 0
  v_mov_b32 v79, 0
  v_mov_b32 v180, 0xff800000
  v_mov_b32 v181, 0xff800000
  v_mov_b32 v182, 0xff800000
  v_mov_b32 v183, 0xff800000
L_A_JOIN:
  s_mov_b32 s95, 400000
W_147:
  ds_read_b32 v10, v245 offset:4
  s_waitcnt lgkmcnt(0)
  v_readfirstlane_b32 s6, v10
  s_nop 3
  s_cmp_ge_u32 s6, 3
  s_cbranch_scc1 WD_148
  s_sleep 1
  s_sub_u32 s95, s95, 1
  s_cmp_lg_u32 s95, 0
  s_cbranch_scc1 W_147
WD_148:
  s_lshl_b32 s83, s79, 5
  v_add_u32 v10, s83, v3
  v_mul_u32_u24 v10, 144, v10
  v_add_u32 v10, 139264, v10
  v_lshlrev_b32 v11, 3, v4
  v_add_u32 v11, v10, v11
  ds_read_b32 v16, v11 offset:0
  ds_read_b32 v17, v11 offset:4
  ds_read_b32 v18, v11 offset:16
  ds_read_b32 v19, v11 offset:20
  ds_read_b32 v32, v10 offset:32
  ds_read_b32 v20, v11 offset:36
  ds_read_b32 v21, v11 offset:40
  ds_read_b32 v22, v11 offset:52
  ds_read_b32 v23, v11 offset:56
  ds_read_b32 v34, v10 offset:68
  ds_read_b32 v24, v11 offset:72
  ds_read_b32 v25, v11 offset:76
  ds_read_b32 v26, v11 offset:88
  ds_read_b32 v27, v11 offset:92
  ds_read_b32 v36, v10 offset:104
  ds_read_b32 v28, v11 offset:108
  ds_read_b32 v29, v11 offset:112
  ds_read_b32 v30, v11 offset:124
  ds_read_b32 v31, v11 offset:128
  ds_read_b32 v38, v10 offset:140
  s_waitcnt lgkmcnt(0)
  s_waitcnt lgkmcnt(0)
  s_mov_b64 s[92:93], exec
  s_mov_b64 exec, 1
  ds_add_u32 v245, v244 offset:44
  s_mov_b64 exec, s[92:93]
  v_cndmask_b32 v32, 0, v32, s[84:85]
  v_cndmask_b32 v34, 0, v34, s[84:85]
  v_cndmask_b32 v36, 0, v36, s[84:85]
  v_cndmask_b32 v38, 0, v38, s[84:85]
  s_setprio 1
  s_branch L_FIRST
L_REDO:
  s_lshl_b32 s86, s80, 5
  s_mov_b32 s87, 0
  s_mul_i32 s70, s87, 2304
  buffer_load_dwordx4 v[184:187], v176, s[44:47], s70 offen
  buffer_load_dword v188, v177, s[44:47], s70 offen
  s_mov_b64 exec, s[60:61]
  v_mov_b32 v172, 0
  v_mov_b32 v173, 0
  v_mov_b32 v174, 0
  v_mov_b32 v175, 0
  s_mov_b64 exec, -1
  s_mul_i32 s70, s86, 2304
  buffer_load_dwordx4 v[144:147], v176, s[44:47], s70 offen
  buffer_load_dword v148, v177, s[44:47], s70 offen
  s_mul_i32 s70, s86, 2304
  s_mov_b64 exec, s[60:61]
  buffer_load_dwordx4 v[152:155], v190, s[44:47], s70 offen
  buffer_load_dwordx4 v[156:159], v190, s[44:47], s70 offen offset:576
  s_mov_b64 exec, -1
  s_add_u32 s87, s86, 1
  s_mul_i32 s70, s87, 2304
  buffer_load_dwordx4 v[160:163], v176, s[44:47], s70 offen
  buffer_load_dword v164, v177, s[44:47], s70 offen
  v_mov_b32 v80, 0
  v_mov_b32 v81, 0
  v_mov_b32 v82, 0
  v_mov_b32 v83, 0
  v_mov_b32 v84, 0
  v_mov_b32 v85, 0
  v_mov_b32 v86, 0
  v_mov_b32 v87, 0
  v_mov_b32 v88, 0
  v_mov_b32 v89, 0
  v_mov_b32 v90, 0
  v_mov_b32 v91, 0
  v_mov_b32 v92, 0
  v_mov_b32 v93, 0
  v_mov_b32 v94, 0
  v_mov_b32 v95, 0
  v_mov_b32 v96, 0
  v_mov_b32 v97, 0
  v_mov_b32 v98, 0
  v_mov_b32 v99, 0
  v_mov_b32 v100, 0
  v_mov_b32 v101, 0
  v_mov_b32 v102, 0
  v_mov_b32 v103, 0
  v_mov_b32 v104, 0
  v_mov_b32 v105, 0
  v_mov_b32 v106, 0
  v_mov_b32 v107, 0
  v_mov_b32 v108, 0
  v_mov_b32 v109, 0
  v_mov_b32 v110, 0
  v_mov_b32 v111, 0
  v_mov_b32 v112, 0
  v_mov_b32 v113, 0
  v_mov_b32 v114, 0
  v_mov_b32 v115, 0
  v_mov_b32 v116, 0
  v_mov_b32 v117, 0
  v_mov_b32 v118, 0
  v_mov_b32 v119, 0
  v_mov_b32 v120, 0
  v_mov_b32 v121, 0
  v_mov_b32 v122, 0
  v_mov_b32 v123, 0
  v_mov_b32 v124, 0
  v_mov_b32 v125, 0
  v_mov_b32 v126, 0
  v_mov_b32 v127, 0
  v_mov_b32 v128, 0
  v_mov_b32 v129, 0
  v_mov_b32 v130, 0
  v_mov_b32 v131, 0
  v_mov_b32 v132, 0
  v_mov_b32 v133, 0
  v_mov_b32 v134, 0
  v_mov_b32 v135, 0
  v_mov_b32 v136, 0
  v_mov_b32 v137, 0
  v_mov_b32 v138, 0
  v_mov_b32 v139, 0
  v_mov_b32 v140, 0
  v_mov_b32 v141, 0
  v_mov_b32 v142, 0
  v_mov_b32 v143, 0
  v_mov_b32 v72, 0
  v_mov_b32 v73, 0
  v_mov_b32 v74, 0
  v_mov_b32 v75, 0
  v_mov_b32 v76, 0
  v_mov_b32 v77, 0
  v_mov_b32 v78, 0
  v_mov_b32 v79, 0
  v_mov_b32 v180, 0xff800000
  v_mov_b32 v181, 0xff800000
  v_mov_b32 v182, 0xff800000
  v_mov_b32 v183, 0xff800000
L_FIRST:
  v_mov_b32 v33, 0
  v_mov_b32 v35, 0
  v_mov_b32 v37, 0
  v_mov_b32 v39, 0
  s_mov_b32 s87, 0
  s_cmp_eq_u32 s88, 0
  s_cselect_b32 s89, 1, 64
L_MPASS:
  s_waitcnt vmcnt(0)
  v_mfma_f32_32x32x16_bf16 v[40:55], v[184:187], v[16:19], 0
  v_mfma_f32_32x32x8bf16_1k v[40:55], v[188:189], v[32:33], v[40:55]
  s_nop 11
  v_max3_f32 v180, v40, v41, v180
  v_max3_f32 v180, v42, v43, v180
  v_max3_f32 v180, v44, v45, v180
  v_max3_f32 v180, v46, v47, v180
  v_max3_f32 v180, v48, v49, v180
  v_max3_f32 v180, v50, v51, v180
  v_max3_f32 v180, v52, v53, v180
  v_max3_f32 v180, v54, v55, v180
  v_mfma_f32_32x32x16_bf16 v[56:71], v[184:187], v[20:23], 0
  v_mfma_f32_32x32x8bf16_1k v[56:71], v[188:189], v[34:35], v[56:71]
  s_nop 11
  v_max3_f32 v181, v56, v57, v181
  v_max3_f32 v181, v58, v59, v181
  v_max3_f32 v181, v60, v61, v181
  v_max3_f32 v181, v62, v63, v181
  v_max3_f32 v181, v64, v65, v181
  v_max3_f32 v181, v66, v67, v181
  v_max3_f32 v181, v68, v69, v181
  v_max3_f32 v181, v70, v71, v181
  v_mfma_f32_32x32x16_bf16 v[40:55], v[184:187], v[24:27], 0
  v_mfma_f32_32x32x8bf16_1k v[40:55], v[188:189], v[36:37], v[40:55]
  s_nop 11
  v_max3_f32 v182, v40, v41, v182
  v_max3_f32 v182, v42, v43, v182
  v_max3_f32 v182, v44, v45, v182
  v_max3_f32 v182, v46, v47, v182
  v_max3_f32 v182, v48, v49, v182
  v_max3_f32 v182, v50, v51, v182
  v_max3_f32 v182, v52, v53, v182
  v_max3_f32 v182, v54, v55, v182
  v_mfma_f32_32x32x16_bf16 v[56:71], v[184:187], v[28:31], 0
  v_mfma_f32_32x32x8bf16_1k v[56:71], v[188:189], v[38:39], v[56:71]
  s_nop 11
  v_max3_f32 v183, v56, v57, v183
  v_max3_f32 v183, v58, v59, v183
  v_max3_f32 v183, v60, v61, v183
  v_max3_f32 v183, v62, v63, v183
  v_max3_f32 v183, v64, v65, v183
  v_max3_f32 v183, v66, v67, v183
  v_max3_f32 v183, v68, v69, v183
  v_max3_f32 v183, v70, v71, v183
  s_add_u32 s87, s87, 1
  s_cmp_lt_u32 s87, s89
  s_cbranch_scc0 L_MDONE
  s_mul_i32 s70, s87, 2304
  buffer_load_dwordx4 v[184:187], v176, s[44:47], s70 offen
  buffer_load_dword v188, v177, s[44:47], s70 offen
  s_branch L_MPASS
L_MDONE:
  v_mov_b32 v10, v180
  s_nop 1
  v_permlane32_swap_b32 v10, v180
  s_nop 1
  v_max_f32 v10, v10, v180
  v_sub_f32 v10, 0, v10
  v_cvt_pk_bf16_f32 v11, v10, v10
  v_lshlrev_b32 v11, 16, v11
  v_sub_f32 v11, v10, v11
  v_cvt_pk_bf16_f32 v11, v10, v11
  v_cndmask_b32 v33, 0, v11, s[84:85]
  v_mov_b32 v10, v181
  s_nop 1
  v_permlane32_swap_b32 v10, v181
  s_nop 1
  v_max_f32 v10, v10, v181
  v_sub_f32 v10, 0, v10
  v_cvt_pk_bf16_f32 v11, v10, v10
  v_lshlrev_b32 v11, 16, v11
  v_sub_f32 v11, v10, v11
  v_cvt_pk_bf16_f32 v11, v10, v11
  v_cndmask_b32 v35, 0, v11, s[84:85]
  v_mov_b32 v10, v182
  s_nop 1
  v_permlane32_swap_b32 v10, v182
  s_nop 1
  v_max_f32 v10, v10, v182
  v_sub_f32 v10, 0, v10
  v_cvt_pk_bf16_f32 v11, v10, v10
  v_lshlrev_b32 v11, 16, v11
  v_sub_f32 v11, v10, v11
  v_cvt_pk_bf16_f32 v11, v10, v11
  v_cndmask_b32 v37, 0, v11, s[84:85]
  v_mov_b32 v10, v183
  s_nop 1
  v_permlane32_swap_b32 v10, v183
  s_nop 1
  v_max_f32 v10, v10, v183
  v_sub_f32 v10, 0, v10
  v_cvt_pk_bf16_f32 v11, v10, v10
  v_lshlrev_b32 v11, 16, v11
  v_sub_f32 v11, v10, v11
  v_cvt_pk_bf16_f32 v11, v10, v11
  v_cndmask_b32 v39, 0, v11, s[84:85]
  s_nop 1
  v_mfma_f32_32x32x16_bf16 v[40:55], v[144:147], v[16:19], 0
  v_mfma_f32_32x32x8bf16_1k v[40:55], v[148:149], v[32:33], v[40:55]
  s_nop 11
  s_mov_b32 s89, 16
.p2align 5
L_ATT:
  v_mfma_f32_32x32x16_bf16 v[56:71], v[144:147], v[20:23], 0
  v_exp_f32 v40, v40
  v_exp_f32 v41, v41
  v_exp_f32 v42, v42
  v_exp_f32 v43, v43
  v_cvt_pk_bf16_f32 v72, v40, v41
  v_mfma_f32_32x32x16_bf16 v[128:143], v[172:175], v[76:79], v[128:143]
  s_add_u32 s87, s86, 1
  s_mul_i32 s70, s87, 2304
  s_mov_b64 exec, s[60:61]
  buffer_load_dwordx4 v[168:171], v190, s[44:47], s70 offen
  buffer_load_dwordx4 v[172:175], v190, s[44:47], s70 offen offset:576
  s_mov_b64 exec, -1
  v_exp_f32 v44, v44
  v_exp_f32 v45, v45
  v_cvt_pk_bf16_f32 v73, v42, v43
  v_exp_f32 v46, v46
  v_exp_f32 v47, v47
  v_cvt_pk_bf16_f32 v74, v44, v45
  v_mfma_f32_32x32x8bf16_1k v[56:71], v[148:149], v[34:35], v[56:71]
  v_cvt_pk_bf16_f32 v75, v46, v47
  v_exp_f32 v48, v48
  v_exp_f32 v49, v49
  v_exp_f32 v50, v50
  v_exp_f32 v51, v51
  s_waitcnt vmcnt(4)
  v_mfma_f32_32x32x16_bf16 v[80:95], v[152:155], v[72:75], v[80:95]
  v_cvt_pk_bf16_f32 v76, v48, v49
  v_cvt_pk_bf16_f32 v77, v50, v51
  v_exp_f32 v52, v52
  v_exp_f32 v53, v53
  v_exp_f32 v54, v54
  v_exp_f32 v55, v55
  v_cvt_pk_bf16_f32 v78, v52, v53
  v_cvt_pk_bf16_f32 v79, v54, v55
  v_mfma_f32_32x32x16_bf16 v[40:55], v[144:147], v[24:27], 0
  v_exp_f32 v56, v56
  v_exp_f32 v57, v57
  v_exp_f32 v58, v58
  v_exp_f32 v59, v59
  v_cvt_pk_bf16_f32 v72, v56, v57
  v_mfma_f32_32x32x16_bf16 v[80:95], v[156:159], v[76:79], v[80:95]
  v_exp_f32 v60, v60
  v_exp_f32 v61, v61
  v_cvt_pk_bf16_f32 v73, v58, v59
  v_exp_f32 v62, v62
  v_exp_f32 v63, v63
  v_cvt_pk_bf16_f32 v74, v60, v61
  v_mfma_f32_32x32x8bf16_1k v[40:55], v[148:149], v[36:37], v[40:55]
  v_cvt_pk_bf16_f32 v75, v62, v63
  v_exp_f32 v64, v64
  v_exp_f32 v65, v65
  v_exp_f32 v66, v66
  v_exp_f32 v67, v67
  v_mfma_f32_32x32x16_bf16 v[96:111], v[152:155], v[72:75], v[96:111]
  v_cvt_pk_bf16_f32 v76, v64, v65
  v_cvt_pk_bf16_f32 v77, v66, v67
  v_exp_f32 v68, v68
  v_exp_f32 v69, v69
  v_exp_f32 v70, v70
  v_exp_f32 v71, v71
  v_cvt_pk_bf16_f32 v78, v68, v69
  v_cvt_pk_bf16_f32 v79, v70, v71
  v_mfma_f32_32x32x16_bf16 v[56:71], v[144:147], v[28:31], 0
  v_exp_f32 v40, v40
  v_exp_f32 v41, v41
  v_exp_f32 v42, v42
  v_exp_f32 v43, v43
  v_cvt_pk_bf16_f32 v72, v40, v41
  v_mfma_f32_32x32x16_bf16 v[96:111], v[156:159], v[76:79], v[96:111]
  v_exp_f32 v44, v44
  v_exp_f32 v45, v45
  v_cvt_pk_bf16_f32 v73, v42, v43
  v_exp_f32 v46, v46
  v_exp_f32 v47, v47
  v_cvt_pk_bf16_f32 v74, v44, v45
  v_mfma_f32_32x32x8bf16_1k v[56:71], v[148:149], v[38:39], v[56:71]
  s_add_u32 s87, s86, 2
  s_mul_i32 s70, s87, 2304
  buffer_load_dwordx4 v[144:147], v176, s[44:47], s70 offen
  buffer_load_dword v148, v177, s[44:47], s70 offen
  v_cvt_pk_bf16_f32 v75, v46, v47
  v_exp_f32 v48, v48
  v_exp_f32 v49, v49
  v_exp_f32 v50, v50
  v_exp_f32 v51, v51
  v_mfma_f32_32x32x16_bf16 v[112:127], v[152:155], v[72:75], v[112:127]
  v_cvt_pk_bf16_f32 v76, v48, v49
  v_cvt_pk_bf16_f32 v77, v50, v51
  v_exp_f32 v52, v52
  v_exp_f32 v53, v53
  v_exp_f32 v54, v54
  v_exp_f32 v55, v55
  v_cvt_pk_bf16_f32 v78, v52, v53
  v_cvt_pk_bf16_f32 v79, v54, v55
  s_waitcnt vmcnt(4)
  v_mfma_f32_32x32x16_bf16 v[40:55], v[160:163], v[16:19], 0
  v_exp_f32 v56, v56
  v_exp_f32 v57, v57
  v_exp_f32 v58, v58
  v_exp_f32 v59, v59
  v_cvt_pk_bf16_f32 v72, v56, v57
  v_mfma_f32_32x32x16_bf16 v[112:127], v[156:159], v[76:79], v[112:127]
  v_exp_f32 v60, v60
  v_exp_f32 v61, v61
  v_cvt_pk_bf16_f32 v73, v58, v59
  v_exp_f32 v62, v62
  v_exp_f32 v63, v63
  v_cvt_pk_bf16_f32 v74, v60, v61
  v_mfma_f32_32x32x8bf16_1k v[40:55], v[164:165], v[32:33], v[40:55]
  v_cvt_pk_bf16_f32 v75, v62, v63
  v_exp_f32 v64, v64
  v_exp_f32 v65, v65
  v_exp_f32 v66, v66
  v_exp_f32 v67, v67
  v_mfma_f32_32x32x16_bf16 v[128:143], v[152:155], v[72:75], v[128:143]
  v_cvt_pk_bf16_f32 v76, v64, v65
  v_cvt_pk_bf16_f32 v77, v66, v67
  v_exp_f32 v68, v68
  v_exp_f32 v69, v69
  v_exp_f32 v70, v70
  v_exp_f32 v71, v71
  v_cvt_pk_bf16_f32 v78, v68, v69
  v_cvt_pk_bf16_f32 v79, v70, v71
  s_add_u32 s86, s86, 1
  v_mfma_f32_32x32x16_bf16 v[56:71], v[160:163], v[20:23], 0
  v_exp_f32 v40, v40
  v_exp_f32 v41, v41
  v_exp_f32 v42, v42
  v_exp_f32 v43, v43
  v_cvt_pk_bf16_f32 v72, v40, v41
  v_mfma_f32_32x32x16_bf16 v[128:143], v[156:159], v[76:79], v[128:143]
  s_add_u32 s87, s86, 1
  s_mul_i32 s70, s87, 2304
  s_mov_b64 exec, s[60:61]
  buffer_load_dwordx4 v[152:155], v190, s[44:47], s70 offen
  buffer_load_dwordx4 v[156:159], v190, s[44:47], s70 offen offset:576
  s_mov_b64 exec, -1
  v_exp_f32 v44, v44
  v_exp_f32 v45, v45
  v_cvt_pk_bf16_f32 v73, v42, v43
  v_exp_f32 v46, v46
  v_exp_f32 v47, v47
  v_cvt_pk_bf16_f32 v74, v44, v45
  v_mfma_f32_32x32x8bf16_1k v[56:71], v[164:165], v[34:35], v[56:71]
  v_cvt_pk_bf16_f32 v75, v46, v47
  v_exp_f32 v48, v48
  v_exp_f32 v49, v49
  v_exp_f32 v50, v50
  v_exp_f32 v51, v51
  s_waitcnt vmcnt(4)
  v_mfma_f32_32x32x16_bf16 v[80:95], v[168:171], v[72:75], v[80:95]
  v_cvt_pk_bf16_f32 v76, v48, v49
  v_cvt_pk_bf16_f32 v77, v50, v51
  v_exp_f32 v52, v52
  v_exp_f32 v53, v53
  v_exp_f32 v54, v54
  v_exp_f32 v55, v55
  v_cvt_pk_bf16_f32 v78, v52, v53
  v_cvt_pk_bf16_f32 v79, v54, v55
  v_mfma_f32_32x32x16_bf16 v[40:55], v[160:163], v[24:27], 0
  v_exp_f32 v56, v56
  v_exp_f32 v57, v57
  v_exp_f32 v58, v58
  v_exp_f32 v59, v59
  v_cvt_pk_bf16_f32 v72, v56, v57
  v_mfma_f32_32x32x16_bf16 v[80:95], v[172:175], v[76:79], v[80:95]
  v_exp_f32 v60, v60
  v_exp_f32 v61, v61
  v_cvt_pk_bf16_f32 v73, v58, v59
  v_exp_f32 v62, v62
  v_exp_f32 v63, v63
  v_cvt_pk_bf16_f32 v74, v60, v61
  v_mfma_f32_32x32x8bf16_1k v[40:55], v[164:165], v[36:37], v[40:55]
  v_cvt_pk_bf16_f32 v75, v62, v63
  v_exp_f32 v64, v64
  v_exp_f32 v65, v65
  v_exp_f32 v66, v66
  v_exp_f32 v67, v67
  v_mfma_f32_32x32x16_bf16 v[96:111], v[168:171], v[72:75], v[96:111]
  v_cvt_pk_bf16_f32 v76, v64, v65
  v_cvt_pk_bf16_f32 v77, v66, v67
  v_exp_f32 v68, v68
  v_exp_f32 v69, v69
  v_exp_f32 v70, v70
  v_exp_f32 v71, v71
  v_cvt_pk_bf16_f32 v78, v68, v69
  v_cvt_pk_bf16_f32 v79, v70, v71
  v_mfma_f32_32x32x16_bf16 v[56:71], v[160:163], v[28:31], 0
  v_exp_f32 v40, v40
  v_exp_f32 v41, v41
  v_exp_f32 v42, v42
  v_exp_f32 v43, v43
  v_cvt_pk_bf16_f32 v72, v40, v41
  v_mfma_f32_32x32x16_bf16 v[96:111], v[172:175], v[76:79], v[96:111]
  v_exp_f32 v44, v44
  v_exp_f32 v45, v45
  v_cvt_pk_bf16_f32 v73, v42, v43
  v_exp_f32 v46, v46
  v_exp_f32 v47, v47
  v_cvt_pk_bf16_f32 v74, v44, v45
  v_mfma_f32_32x32x8bf16_1k v[56:71], v[164:165], v[38:39], v[56:71]
  s_add_u32 s87, s86, 2
  s_mul_i32 s70, s87, 2304
  buffer_load_dwordx4 v[160:163], v176, s[44:47], s70 offen
  buffer_load_dword v164, v177, s[44:47], s70 offen
  v_cvt_pk_bf16_f32 v75, v46, v47
  v_exp_f32 v48, v48
  v_exp_f32 v49, v49
  v_exp_f32 v50, v50
  v_exp_f32 v51, v51
  v_mfma_f32_32x32x16_bf16 v[112:127], v[168:171], v[72:75], v[112:127]
  v_cvt_pk_bf16_f32 v76, v48, v49
  v_cvt_pk_bf16_f32 v77, v50, v51
  v_exp_f32 v52, v52
  v_exp_f32 v53, v53
  v_exp_f32 v54, v54
  v_exp_f32 v55, v55
  v_cvt_pk_bf16_f32 v78, v52, v53
  v_cvt_pk_bf16_f32 v79, v54, v55
  s_waitcnt vmcnt(4)
  v_mfma_f32_32x32x16_bf16 v[40:55], v[144:147], v[16:19], 0
  v_exp_f32 v56, v56
  v_exp_f32 v57, v57
  v_exp_f32 v58, v58
  v_exp_f32 v59, v59
  v_cvt_pk_bf16_f32 v72, v56, v57
  v_mfma_f32_32x32x16_bf16 v[112:127], v[172:175], v[76:79], v[112:127]
  v_exp_f32 v60, v60
  v_exp_f32 v61, v61
  v_cvt_pk_bf16_f32 v73, v58, v59
  v_exp_f32 v62, v62
  v_exp_f32 v63, v63
  v_cvt_pk_bf16_f32 v74, v60, v61
  v_mfma_f32_32x32x8bf16_1k v[40:55], v[148:149], v[32:33], v[40:55]
  v_cvt_pk_bf16_f32 v75, v62, v63
  v_exp_f32 v64, v64
  v_exp_f32 v65, v65
  v_exp_f32 v66, v66
  v_exp_f32 v67, v67
  v_mfma_f32_32x32x16_bf16 v[128:143], v[168:171], v[72:75], v[128:143]
  v_cvt_pk_bf16_f32 v76, v64, v65
  v_cvt_pk_bf16_f32 v77, v66, v67
  v_exp_f32 v68, v68
  v_exp_f32 v69, v69
  v_exp_f32 v70, v70
  v_exp_f32 v71, v71
  v_cvt_pk_bf16_f32 v78, v68, v69
  v_cvt_pk_bf16_f32 v79, v70, v71
  s_add_u32 s86, s86, 1
  s_sub_u32 s89, s89, 1
  s_cmp_lg_u32 s89, 0
  s_cbranch_scc1 L_ATT
  s_nop 0
  s_setprio 1
  v_mfma_f32_32x32x16_bf16 v[128:143], v[172:175], v[76:79], v[128:143]
  s_waitcnt vmcnt(0)
  s_mov_b32 s95, 400000
W_149:
  ds_read_b32 v12, v245 offset:12
  s_waitcnt lgkmcnt(0)
  v_readfirstlane_b32 s6, v12
  s_nop 3
  s_cmp_ge_u32 s6, 4
  s_cbranch_scc1 WD_150
  s_sleep 1
  s_sub_u32 s95, s95, 1
  s_cmp_lg_u32 s95, 0
  s_cbranch_scc1 W_149
WD_150:
  s_mul_i32 s83, s78, 5632
  s_add_u32 s83, s83, 139264
  s_xor_b32 s87, s78, 2
  s_mul_i32 s87, s87, 5632
  s_add_u32 s87, s87, 139264
  v_lshlrev_b32 v10, 2, v0
  v_add_u32 v11, s87, v10
  v_add_u32 v10, s83, v10
  s_nop 7
  s_cmp_eq_u32 s80, 0
  s_cbranch_scc0 L_EX1
  ds_write_b32 v10, v112 offset:0
  ds_write_b32 v10, v113 offset:256
  ds_write_b32 v10, v114 offset:512
  ds_write_b32 v10, v115 offset:768
  ds_write_b32 v10, v116 offset:1024
  ds_write_b32 v10, v117 offset:1280
  ds_write_b32 v10, v118 offset:1536
  ds_write_b32 v10, v119 offset:1792
  ds_write_b32 v10, v120 offset:2048
  ds_write_b32 v10, v121 offset:2304
  ds_write_b32 v10, v122 offset:2560
  ds_write_b32 v10, v128 offset:2816
  ds_write_b32 v10, v129 offset:3072
  ds_write_b32 v10, v130 offset:3328
  ds_write_b32 v10, v131 offset:3584
  ds_write_b32 v10, v132 offset:3840
  ds_write_b32 v10, v133 offset:4096
  ds_write_b32 v10, v134 offset:4352
  ds_write_b32 v10, v135 offset:4608
  ds_write_b32 v10, v136 offset:4864
  ds_write_b32 v10, v137 offset:5120
  ds_write_b32 v10, v138 offset:5376
  s_branch L_EX2
L_EX1:
  ds_write_b32 v10, v80 offset:0
  ds_write_b32 v10, v81 offset:256
  ds_write_b32 v10, v82 offset:512
  ds_write_b32 v10, v83 offset:768
  ds_write_b32 v10, v84 offset:1024
  ds_write_b32 v10, v85 offset:1280
  ds_write_b32 v10, v86 offset:1536
  ds_write_b32 v10, v87 offset:1792
  ds_write_b32 v10, v88 offset:2048
  ds_write_b32 v10, v89 offset:2304
  ds_write_b32 v10, v90 offset:2560
  ds_write_b32 v10, v96 offset:2816
  ds_write_b32 v10, v97 offset:3072
  ds_write_b32 v10, v98 offset:3328
  ds_write_b32 v10, v99 offset:3584
  ds_write_b32 v10, v100 offset:3840
  ds_write_b32 v10, v101 offset:4096
  ds_write_b32 v10, v102 offset:4352
  ds_write_b32 v10, v103 offset:4608
  ds_write_b32 v10, v104 offset:4864
  ds_write_b32 v10, v105 offset:5120
  ds_write_b32 v10, v106 offset:5376
  v_mov_b32 v80, v112
  v_mov_b32 v81, v113
  v_mov_b32 v82, v114
  v_mov_b32 v83, v115
  v_mov_b32 v84, v116
  v_mov_b32 v85, v117
  v_mov_b32 v86, v118
  v_mov_b32 v87, v119
  v_mov_b32 v88, v120
  v_mov_b32 v89, v121
  v_mov_b32 v90, v122
  v_mov_b32 v96, v128
  v_mov_b32 v97, v129
  v_mov_b32 v98, v130
  v_mov_b32 v99, v131
  v_mov_b32 v100, v132
  v_mov_b32 v101, v133
  v_mov_b32 v102, v134
  v_mov_b32 v103, v135
  v_mov_b32 v104, v136
  v_mov_b32 v105, v137
  v_mov_b32 v106, v138
L_EX2:
  s_waitcnt lgkmcnt(0)
  s_mov_b64 s[92:93], exec
  s_mov_b64 exec, 1
  ds_add_u32 v245, v244 offset:20
  s_mov_b64 exec, s[92:93]
  s_lshl_b32 s6, s88, 2
  s_add_u32 s90, s6, 4
  s_mov_b32 s95, 400000
W_153:
  ds_read_b32 v12, v245 offset:20
  s_waitcnt lgkmcnt(0)
  v_readfirstlane_b32 s6, v12
  s_nop 3
  s_cmp_ge_u32 s6, s90
  s_cbranch_scc1 WD_154
  s_sleep 1
  s_sub_u32 s95, s95, 1
  s_cmp_lg_u32 s95, 0
  s_cbranch_scc1 W_153
WD_154:
  ds_read_b32 v40, v11 offset:0
  ds_read_b32 v41, v11 offset:256
  ds_read_b32 v42, v11 offset:512
  ds_read_b32 v43, v11 offset:768
  ds_read_b32 v44, v11 offset:1024
  ds_read_b32 v45, v11 offset:1280
  ds_read_b32 v46, v11 offset:1536
  ds_read_b32 v47, v11 offset:1792
  ds_read_b32 v48, v11 offset:2048
  ds_read_b32 v49, v11 offset:2304
  ds_read_b32 v50, v11 offset:2560
  ds_read_b32 v51, v11 offset:2816
  ds_read_b32 v52, v11 offset:3072
  ds_read_b32 v53, v11 offset:3328
  ds_read_b32 v54, v11 offset:3584
  ds_read_b32 v55, v11 offset:3840
  ds_read_b32 v56, v11 offset:4096
  ds_read_b32 v57, v11 offset:4352
  ds_read_b32 v58, v11 offset:4608
  ds_read_b32 v59, v11 offset:4864
  ds_read_b32 v60, v11 offset:5120
  ds_read_b32 v61, v11 offset:5376
  s_waitcnt lgkmcnt(0)
  v_add_f32 v80, v80, v40
  v_add_f32 v81, v81, v41
  v_add_f32 v82, v82, v42
  v_add_f32 v83, v83, v43
  v_add_f32 v84, v84, v44
  v_add_f32 v85, v85, v45
  v_add_f32 v86, v86, v46
  v_add_f32 v87, v87, v47
  v_add_f32 v88, v88, v48
  v_add_f32 v89, v89, v49
  v_add_f32 v90, v90, v50
  v_add_f32 v96, v96, v51
  v_add_f32 v97, v97, v52
  v_add_f32 v98, v98, v53
  v_add_f32 v99, v99, v54
  v_add_f32 v100, v100, v55
  v_add_f32 v101, v101, v56
  v_add_f32 v102, v102, v57
  v_add_f32 v103, v103, v58
  v_add_f32 v104, v104, v59
  v_add_f32 v105, v105, v60
  v_add_f32 v106, v106, v61
  v_mov_b32 v12, v90
  v_mov_b32 v13, v90
  v_mov_b32 v14, v106
  v_mov_b32 v15, v106
  s_nop 1
  v_permlane32_swap_b32 v12, v13
  v_permlane32_swap_b32 v14, v15
  v_mov_b32 v40, 0
  v_fma_f32 v40, v80, 0, v40
  v_fma_f32 v40, v81, 0, v40
  v_fma_f32 v40, v82, 0, v40
  v_fma_f32 v40, v83, 0, v40
  v_fma_f32 v40, v84, 0, v40
  v_fma_f32 v40, v85, 0, v40
  v_fma_f32 v40, v86, 0, v40
  v_fma_f32 v40, v87, 0, v40
  v_fma_f32 v40, v96, 0, v40
  v_fma_f32 v40, v97, 0, v40
  v_fma_f32 v40, v98, 0, v40
  v_fma_f32 v40, v99, 0, v40
  v_fma_f32 v40, v100, 0, v40
  v_fma_f32 v40, v101, 0, v40
  v_fma_f32 v40, v102, 0, v40
  v_fma_f32 v40, v103, 0, v40
  v_mov_b32 v41, 0
  v_fma_f32 v41, v88, 0, v41
  v_fma_f32 v41, v89, 0, v41
  v_fma_f32 v41, v104, 0, v41
  v_fma_f32 v41, v105, 0, v41
  v_cndmask_b32 v41, 0, v41, s[84:85]
  v_add_f32 v40, v40, v41
  s_mov_b32 s6, 0x2b800000
  s_mov_b32 s7, 0x71800000
  v_min_f32 v42, v12, v14
  v_max_f32 v43, v12, v14
  v_cmp_nge_f32 vcc, v42, s6
  v_cmp_nle_f32 s[82:83], v43, s7
  v_cmp_u_f32 s[70:71], v12, v14
  v_cmp_u_f32 s[68:69], v40, v40
  s_nop 3
  s_or_b64 vcc, vcc, s[82:83]
  s_or_b64 vcc, vcc, s[70:71]
  s_or_b64 vcc, vcc, s[68:69]
  s_cmp_eq_u64 vcc, 0
  s_cbranch_scc1 L_CHK_OK
  s_waitcnt lgkmcnt(0)
  s_mov_b64 s[92:93], exec
  s_mov_b64 exec, 1
  ds_add_u32 v245, v244 offset:28
  s_mov_b64 exec, s[92:93]
L_CHK_OK:
  s_waitcnt lgkmcnt(0)
  s_mov_b64 s[92:93], exec
  s_mov_b64 exec, 1
  ds_add_u32 v245, v244 offset:24
  s_mov_b64 exec, s[92:93]
  s_mov_b32 s95, 400000
W_155:
  ds_read_b32 v44, v245 offset:24
  s_waitcnt lgkmcnt(0)
  v_readfirstlane_b32 s6, v44
  s_nop 3
  s_cmp_ge_u32 s6, s90
  s_cbranch_scc1 WD_156
  s_sleep 1
  s_sub_u32 s95, s95, 1
  s_cmp_lg_u32 s95, 0
  s_cbranch_scc1 W_155
WD_156:
  s_cmp_lg_u32 s88, 0
  s_cbranch_scc1 L_FINAL
  ds_read_b32 v44, v245 offset:28
  s_waitcnt lgkmcnt(0)
  v_readfirstlane_b32 s6, v44
  s_nop 3
  s_cmp_eq_u32 s6, 0
  s_cbranch_scc1 L_FINAL
  s_mov_b32 s88, 1
  s_branch L_REDO
L_FINAL:
  s_mov_b32 s95, 400000
W_157:
  ds_read_b32 v44, v245 offset:0
  s_waitcnt lgkmcnt(0)
  v_readfirstlane_b32 s6, v44
  s_nop 3
  s_cmp_ge_u32 s6, 1
  s_cbranch_scc1 WD_158
  s_sleep 1
  s_sub_u32 s95, s95, 1
  s_cmp_lg_u32 s95, 0
  s_cbranch_scc1 W_157
WD_158:
  s_lshl_b32 s83, s79, 7
  s_add_u32 s83, s83, 163328
  v_lshlrev_b32 v44, 2, v3
  v_add_u32 v44, s83, v44
  ds_read_b32 v45, v44
  v_rcp_f32 v12, v12
  v_rcp_f32 v14, v14
  v_and_b32 v46, 15, v3
  v_lshlrev_b32 v47, 4, v4
  v_add_u32 v47, v47, v46
  v_lshlrev_b32 v47, 4, v47
  v_lshrrev_b32 v48, 4, v3
  s_lshl_b32 s6, s79, 1
  v_add_u32 v48, s6, v48
  v_lshlrev_b32 v48, 10, v48
  s_lshl_b32 s6, s80, 12
  s_add_u32 s6, s6, 139264
  v_add_u32 v47, v47, v48
  v_add_u32 v47, s6, v47
  v_lshlrev_b32 v46, 4, v46
  v_add_u32 v46, v46, v48
  s_lshl_b32 s6, s80, 3
  s_add_u32 s6, s6, 147456
  v_add_u32 v46, s6, v46
  s_waitcnt lgkmcnt(0)
  v_mul_f32 v12, v12, v45
  v_mul_f32 v14, v14, v45
  v_mul_f32 v80, v80, v12
  v_mul_f32 v81, v81, v12
  v_mul_f32 v82, v82, v12
  v_mul_f32 v83, v83, v12
  v_mul_f32 v84, v84, v12
  v_mul_f32 v85, v85, v12
  v_mul_f32 v86, v86, v12
  v_mul_f32 v87, v87, v12
  v_mul_f32 v88, v88, v12
  v_mul_f32 v89, v89, v12
  v_cvt_pk_bf16_f32 v50, v80, v81
  v_cvt_pk_bf16_f32 v51, v82, v83
  v_cvt_pk_bf16_f32 v52, v84, v85
  v_cvt_pk_bf16_f32 v53, v86, v87
  v_cvt_pk_bf16_f32 v56, v88, v89
  ds_write_b64 v47, v[50:51] offset:0
  ds_write_b64 v47, v[52:53] offset:512
  v_mul_f32 v96, v96, v14
  v_mul_f32 v97, v97, v14
  v_mul_f32 v98, v98, v14
  v_mul_f32 v99, v99, v14
  v_mul_f32 v100, v100, v14
  v_mul_f32 v101, v101, v14
  v_mul_f32 v102, v102, v14
  v_mul_f32 v103, v103, v14
  v_mul_f32 v104, v104, v14
  v_mul_f32 v105, v105, v14
  v_cvt_pk_bf16_f32 v50, v96, v97
  v_cvt_pk_bf16_f32 v51, v98, v99
  v_cvt_pk_bf16_f32 v52, v100, v101
  v_cvt_pk_bf16_f32 v53, v102, v103
  v_cvt_pk_bf16_f32 v57, v104, v105
  ds_write_b64 v47, v[50:51] offset:8
  ds_write_b64 v47, v[52:53] offset:520
  s_mov_b64 exec, s[84:85]
  ds_write_b64 v46, v[56:57]
  s_mov_b64 exec, -1
  s_cmp_lg_u32 s80, 0
  s_cbranch_scc1 L_NOZERO
  v_mov_b32 v58, 0
  v_mov_b32 v59, 0
  v_mov_b32 v60, 0
  v_mov_b32 v61, 0
  s_lshl_b32 s6, s79, 11
  s_add_u32 s6, s6, 147456
  v_lshlrev_b32 v48, 4, v0
  v_add_u32 v48, s6, v48
  s_mov_b64 exec, 0xffff
  s_not_b64 exec, exec
  ds_write_b128 v48, v[58:61]
  ds_write_b128 v48, v[58:61] offset:1024
  s_mov_b64 exec, -1
L_NOZERO:
  s_waitcnt lgkmcnt(0)
  s_mov_b64 s[92:93], exec
  s_mov_b64 exec, 1
  ds_add_u32 v245, v244 offset:32
  s_mov_b64 exec, s[92:93]
  s_setprio 0
  s_mov_b32 s36, s66
  s_and_b32 s37, s67, 0xffff
  s_mov_b32 s38, 2359296
  s_mov_b32 s39, 0x20000
  s_mul_i32 s7, s78, 144
  v_add_u32 v10, s7, v0
  v_lshlrev_b32 v11, 4, v10
  v_mov_b32 v12, 268435456
  v_cmp_gt_u32 vcc, 48, v0
  s_nop 1
  v_cndmask_b32 v11, v12, v11, vcc
  v_add_u32 v13, 0, v10
  v_lshrrev_b32 v14, 4, v13
  v_lshlrev_b32 v14, 5, v14
  v_bfe_u32 v15, v13, 1, 3
  v_mul_u32_u24 v15, 1152, v15
  v_add_u32 v14, v14, v15
  v_and_b32 v13, 1, v13
  v_lshlrev_b32 v13, 4, v13
  v_add_u32 v14, v14, v13
  v_cndmask_b32 v120, v12, v14, vcc
  v_add_u32 v13, 48, v10
  v_lshrrev_b32 v14, 4, v13
  v_lshlrev_b32 v14, 5, v14
  v_bfe_u32 v15, v13, 1, 3
  v_mul_u32_u24 v15, 1152, v15
  v_add_u32 v14, v14, v15
  v_and_b32 v13, 1, v13
  v_lshlrev_b32 v13, 4, v13
  v_add_u32 v14, v14, v13
  v_cndmask_b32 v121, v12, v14, vcc
  v_add_u32 v13, 96, v10
  v_lshrrev_b32 v14, 4, v13
  v_lshlrev_b32 v14, 5, v14
  v_bfe_u32 v15, v13, 1, 3
  v_mul_u32_u24 v15, 1152, v15
  v_add_u32 v14, v14, v15
  v_and_b32 v13, 1, v13
  v_lshlrev_b32 v13, 4, v13
  v_add_u32 v14, v14, v13
  v_cndmask_b32 v122, v12, v14, vcc
  s_mov_b32 s70, 0x00003f80
  s_mov_b32 s71, 0x3f800000
  s_lshl_b32 s68, s4, 3
  s_add_u32 s68, s68, s5
  s_mul_i32 s68, s68, 73728
  s_add_u32 s68, s68, 524288
  s_add_u32 s69, s5, 0
  s_and_b32 s69, s69, 7
  s_mov_b32 s95, 400000
W_159:
  ds_read_b32 v13, v245 offset:36
  s_waitcnt lgkmcnt(0)
  v_readfirstlane_b32 s6, v13
  s_nop 3
  s_cmp_ge_u32 s6, 4
  s_cbranch_scc1 WD_160
  s_sleep 1
  s_sub_u32 s95, s95, 1
  s_cmp_lg_u32 s95, 0
  s_cbranch_scc1 W_159
WD_160:
  s_mul_i32 s69, s69, 9216
  s_add_u32 s69, s69, s68
  buffer_load_dwordx4 v[16:19], v11, s[44:47], s69 offen offset:0 sc1
  buffer_load_dwordx4 v[48:51], v11, s[44:47], s69 offen offset:768 sc1
  buffer_load_dwordx4 v[80:83], v11, s[44:47], s69 offen offset:1536 sc1
  s_add_u32 s69, s5, 1
  s_and_b32 s69, s69, 7
  s_lshl_b32 s7, s69, 2
  s_add_u32 s7, s7, 163712
  v_mov_b32 v14, s7
  s_mov_b32 s95, 400000
W_161:
  ds_read_b32 v13, v14 offset:0
  s_waitcnt lgkmcnt(0)
  v_readfirstlane_b32 s6, v13
  s_nop 3
  s_cmp_ge_u32 s6, 1
  s_cbranch_scc1 WD_162
  s_sleep 1
  s_sub_u32 s95, s95, 1
  s_cmp_lg_u32 s95, 0
  s_cbranch_scc1 W_161
WD_162:
  s_mul_i32 s69, s69, 9216
  s_add_u32 s69, s69, s68
  buffer_load_dwordx4 v[20:23], v11, s[44:47], s69 offen offset:0 sc1
  buffer_load_dwordx4 v[52:55], v11, s[44:47], s69 offen offset:768 sc1
  buffer_load_dwordx4 v[84:87], v11, s[44:47], s69 offen offset:1536 sc1
  s_waitcnt vmcnt(3)
  v_dot2_f32_bf16 v128, v16, s70, 0
  v_dot2_f32_bf16 v129, v16, s71, 0
  v_dot2_f32_bf16 v130, v17, s70, 0
  v_dot2_f32_bf16 v131, v17, s71, 0
  v_dot2_f32_bf16 v132, v18, s70, 0
  v_dot2_f32_bf16 v133, v18, s71, 0
  v_dot2_f32_bf16 v134, v19, s70, 0
  v_dot2_f32_bf16 v135, v19, s71, 0
  v_dot2_f32_bf16 v136, v48, s70, 0
  v_dot2_f32_bf16 v137, v48, s71, 0
  v_dot2_f32_bf16 v138, v49, s70, 0
  v_dot2_f32_bf16 v139, v49, s71, 0
  v_dot2_f32_bf16 v140, v50, s70, 0
  v_dot2_f32_bf16 v141, v50, s71, 0
  v_dot2_f32_bf16 v142, v51, s70, 0
  v_dot2_f32_bf16 v143, v51, s71, 0
  v_dot2_f32_bf16 v144, v80, s70, 0
  v_dot2_f32_bf16 v145, v80, s71, 0
  v_dot2_f32_bf16 v146, v81, s70, 0
  v_dot2_f32_bf16 v147, v81, s71, 0
  v_dot2_f32_bf16 v148, v82, s70, 0
  v_dot2_f32_bf16 v149, v82, s71, 0
  v_dot2_f32_bf16 v150, v83, s70, 0
  v_dot2_f32_bf16 v151, v83, s71, 0
  s_add_u32 s69, s5, 2
  s_and_b32 s69, s69, 7
  s_lshl_b32 s7, s69, 2
  s_add_u32 s7, s7, 163712
  v_mov_b32 v14, s7
  s_mov_b32 s95, 400000
W_163:
  ds_read_b32 v13, v14 offset:0
  s_waitcnt lgkmcnt(0)
  v_readfirstlane_b32 s6, v13
  s_nop 3
  s_cmp_ge_u32 s6, 1
  s_cbranch_scc1 WD_164
  s_sleep 1
  s_sub_u32 s95, s95, 1
  s_cmp_lg_u32 s95, 0
  s_cbranch_scc1 W_163
WD_164:
  s_mul_i32 s69, s69, 9216
  s_add_u32 s69, s69, s68
  buffer_load_dwordx4 v[24:27], v11, s[44:47], s69 offen offset:0 sc1
  buffer_load_dwordx4 v[56:59], v11, s[44:47], s69 offen offset:768 sc1
  buffer_load_dwordx4 v[88:91], v11, s[44:47], s69 offen offset:1536 sc1
  s_waitcnt vmcnt(3)
  v_dot2_f32_bf16 v128, v20, s70, v128
  v_dot2_f32_bf16 v129, v20, s71, v129
  v_dot2_f32_bf16 v130, v21, s70, v130
  v_dot2_f32_bf16 v131, v21, s71, v131
  v_dot2_f32_bf16 v132, v22, s70, v132
  v_dot2_f32_bf16 v133, v22, s71, v133
  v_dot2_f32_bf16 v134, v23, s70, v134
  v_dot2_f32_bf16 v135, v23, s71, v135
  v_dot2_f32_bf16 v136, v52, s70, v136
  v_dot2_f32_bf16 v137, v52, s71, v137
  v_dot2_f32_bf16 v138, v53, s70, v138
  v_dot2_f32_bf16 v139, v53, s71, v139
  v_dot2_f32_bf16 v140, v54, s70, v140
  v_dot2_f32_bf16 v141, v54, s71, v141
  v_dot2_f32_bf16 v142, v55, s70, v142
  v_dot2_f32_bf16 v143, v55, s71, v143
  v_dot2_f32_bf16 v144, v84, s70, v144
  v_dot2_f32_bf16 v145, v84, s71, v145
  v_dot2_f32_bf16 v146, v85, s70, v146
  v_dot2_f32_bf16 v147, v85, s71, v147
  v_dot2_f32_bf16 v148, v86, s70, v148
  v_dot2_f32_bf16 v149, v86, s71, v149
  v_dot2_f32_bf16 v150, v87, s70, v150
  v_dot2_f32_bf16 v151, v87, s71, v151
  s_add_u32 s69, s5, 3
  s_and_b32 s69, s69, 7
  s_lshl_b32 s7, s69, 2
  s_add_u32 s7, s7, 163712
  v_mov_b32 v14, s7
  s_mov_b32 s95, 400000
W_165:
  ds_read_b32 v13, v14 offset:0
  s_waitcnt lgkmcnt(0)
  v_readfirstlane_b32 s6, v13
  s_nop 3
  s_cmp_ge_u32 s6, 1
  s_cbranch_scc1 WD_166
  s_sleep 1
  s_sub_u32 s95, s95, 1
  s_cmp_lg_u32 s95, 0
  s_cbranch_scc1 W_165
WD_166:
  s_mul_i32 s69, s69, 9216
  s_add_u32 s69, s69, s68
  buffer_load_dwordx4 v[28:31], v11, s[44:47], s69 offen offset:0 sc1
  buffer_load_dwordx4 v[60:63], v11, s[44:47], s69 offen offset:768 sc1
  buffer_load_dwordx4 v[92:95], v11, s[44:47], s69 offen offset:1536 sc1
  s_waitcnt vmcnt(3)
  v_dot2_f32_bf16 v128, v24, s70, v128
  v_dot2_f32_bf16 v129, v24, s71, v129
  v_dot2_f32_bf16 v130, v25, s70, v130
  v_dot2_f32_bf16 v131, v25, s71, v131
  v_dot2_f32_bf16 v132, v26, s70, v132
  v_dot2_f32_bf16 v133, v26, s71, v133
  v_dot2_f32_bf16 v134, v27, s70, v134
  v_dot2_f32_bf16 v135, v27, s71, v135
  v_dot2_f32_bf16 v136, v56, s70, v136
  v_dot2_f32_bf16 v137, v56, s71, v137
  v_dot2_f32_bf16 v138, v57, s70, v138
  v_dot2_f32_bf16 v139, v57, s71, v139
  v_dot2_f32_bf16 v140, v58, s70, v140
  v_dot2_f32_bf16 v141, v58, s71, v141
  v_dot2_f32_bf16 v142, v59, s70, v142
  v_dot2_f32_bf16 v143, v59, s71, v143
  v_dot2_f32_bf16 v144, v88, s70, v144
  v_dot2_f32_bf16 v145, v88, s71, v145
  v_dot2_f32_bf16 v146, v89, s70, v146
  v_dot2_f32_bf16 v147, v89, s71, v147
  v_dot2_f32_bf16 v148, v90, s70, v148
  v_dot2_f32_bf16 v149, v90, s71, v149
  v_dot2_f32_bf16 v150, v91, s70, v150
  v_dot2_f32_bf16 v151, v91, s71, v151
  s_add_u32 s69, s5, 4
  s_and_b32 s69, s69, 7
  s_lshl_b32 s7, s69, 2
  s_add_u32 s7, s7, 163712
  v_mov_b32 v14, s7
  s_mov_b32 s95, 400000
W_167:
  ds_read_b32 v13, v14 offset:0
  s_waitcnt lgkmcnt(0)
  v_readfirstlane_b32 s6, v13
  s_nop 3
  s_cmp_ge_u32 s6, 1
  s_cbranch_scc1 WD_168
  s_sleep 1
  s_sub_u32 s95, s95, 1
  s_cmp_lg_u32 s95, 0
  s_cbranch_scc1 W_167
WD_168:
  s_mul_i32 s69, s69, 9216
  s_add_u32 s69, s69, s68
  buffer_load_dwordx4 v[32:35], v11, s[44:47], s69 offen offset:0 sc1
  buffer_load_dwordx4 v[64:67], v11, s[44:47], s69 offen offset:768 sc1
  buffer_load_dwordx4 v[96:99], v11, s[44:47], s69 offen offset:1536 sc1
  s_waitcnt vmcnt(3)
  v_dot2_f32_bf16 v128, v28, s70, v128
  v_dot2_f32_bf16 v129, v28, s71, v129
  v_dot2_f32_bf16 v130, v29, s70, v130
  v_dot2_f32_bf16 v131, v29, s71, v131
  v_dot2_f32_bf16 v132, v30, s70, v132
  v_dot2_f32_bf16 v133, v30, s71, v133
  v_dot2_f32_bf16 v134, v31, s70, v134
  v_dot2_f32_bf16 v135, v31, s71, v135
  v_dot2_f32_bf16 v136, v60, s70, v136
  v_dot2_f32_bf16 v137, v60, s71, v137
  v_dot2_f32_bf16 v138, v61, s70, v138
  v_dot2_f32_bf16 v139, v61, s71, v139
  v_dot2_f32_bf16 v140, v62, s70, v140
  v_dot2_f32_bf16 v141, v62, s71, v141
  v_dot2_f32_bf16 v142, v63, s70, v142
  v_dot2_f32_bf16 v143, v63, s71, v143
  v_dot2_f32_bf16 v144, v92, s70, v144
  v_dot2_f32_bf16 v145, v92, s71, v145
  v_dot2_f32_bf16 v146, v93, s70, v146
  v_dot2_f32_bf16 v147, v93, s71, v147
  v_dot2_f32_bf16 v148, v94, s70, v148
  v_dot2_f32_bf16 v149, v94, s71, v149
  v_dot2_f32_bf16 v150, v95, s70, v150
  v_dot2_f32_bf16 v151, v95, s71, v151
  s_add_u32 s69, s5, 5
  s_and_b32 s69, s69, 7
  s_lshl_b32 s7, s69, 2
  s_add_u32 s7, s7, 163712
  v_mov_b32 v14, s7
  s_mov_b32 s95, 400000
W_169:
  ds_read_b32 v13, v14 offset:0
  s_waitcnt lgkmcnt(0)
  v_readfirstlane_b32 s6, v13
  s_nop 3
  s_cmp_ge_u32 s6, 1
  s_cbranch_scc1 WD_170
  s_sleep 1
  s_sub_u32 s95, s95, 1
  s_cmp_lg_u32 s95, 0
  s_cbranch_scc1 W_169
WD_170:
  s_mul_i32 s69, s69, 9216
  s_add_u32 s69, s69, s68
  buffer_load_dwordx4 v[36:39], v11, s[44:47], s69 offen offset:0 sc1
  buffer_load_dwordx4 v[68:71], v11, s[44:47], s69 offen offset:768 sc1
  buffer_load_dwordx4 v[100:103], v11, s[44:47], s69 offen offset:1536 sc1
  s_waitcnt vmcnt(3)
  v_dot2_f32_bf16 v128, v32, s70, v128
  v_dot2_f32_bf16 v129, v32, s71, v129
  v_dot2_f32_bf16 v130, v33, s70, v130
  v_dot2_f32_bf16 v131, v33, s71, v131
  v_dot2_f32_bf16 v132, v34, s70, v132
  v_dot2_f32_bf16 v133, v34, s71, v133
  v_dot2_f32_bf16 v134, v35, s70, v134
  v_dot2_f32_bf16 v135, v35, s71, v135
  v_dot2_f32_bf16 v136, v64, s70, v136
  v_dot2_f32_bf16 v137, v64, s71, v137
  v_dot2_f32_bf16 v138, v65, s70, v138
  v_dot2_f32_bf16 v139, v65, s71, v139
  v_dot2_f32_bf16 v140, v66, s70, v140
  v_dot2_f32_bf16 v141, v66, s71, v141
  v_dot2_f32_bf16 v142, v67, s70, v142
  v_dot2_f32_bf16 v143, v67, s71, v143
  v_dot2_f32_bf16 v144, v96, s70, v144
  v_dot2_f32_bf16 v145, v96, s71, v145
  v_dot2_f32_bf16 v146, v97, s70, v146
  v_dot2_f32_bf16 v147, v97, s71, v147
  v_dot2_f32_bf16 v148, v98, s70, v148
  v_dot2_f32_bf16 v149, v98, s71, v149
  v_dot2_f32_bf16 v150, v99, s70, v150
  v_dot2_f32_bf16 v151, v99, s71, v151
  s_add_u32 s69, s5, 6
  s_and_b32 s69, s69, 7
  s_lshl_b32 s7, s69, 2
  s_add_u32 s7, s7, 163712
  v_mov_b32 v14, s7
  s_mov_b32 s95, 400000
W_171:
  ds_read_b32 v13, v14 offset:0
  s_waitcnt lgkmcnt(0)
  v_readfirstlane_b32 s6, v13
  s_nop 3
  s_cmp_ge_u32 s6, 1
  s_cbranch_scc1 WD_172
  s_sleep 1
  s_sub_u32 s95, s95, 1
  s_cmp_lg_u32 s95, 0
  s_cbranch_scc1 W_171
WD_172:
  s_mul_i32 s69, s69, 9216
  s_add_u32 s69, s69, s68
  buffer_load_dwordx4 v[40:43], v11, s[44:47], s69 offen offset:0 sc1
  buffer_load_dwordx4 v[72:75], v11, s[44:47], s69 offen offset:768 sc1
  buffer_load_dwordx4 v[104:107], v11, s[44:47], s69 offen offset:1536 sc1
  s_waitcnt vmcnt(3)
  v_dot2_f32_bf16 v128, v36, s70, v128
  v_dot2_f32_bf16 v129, v36, s71, v129
  v_dot2_f32_bf16 v130, v37, s70, v130
  v_dot2_f32_bf16 v131, v37, s71, v131
  v_dot2_f32_bf16 v132, v38, s70, v132
  v_dot2_f32_bf16 v133, v38, s71, v133
  v_dot2_f32_bf16 v134, v39, s70, v134
  v_dot2_f32_bf16 v135, v39, s71, v135
  v_dot2_f32_bf16 v136, v68, s70, v136
  v_dot2_f32_bf16 v137, v68, s71, v137
  v_dot2_f32_bf16 v138, v69, s70, v138
  v_dot2_f32_bf16 v139, v69, s71, v139
  v_dot2_f32_bf16 v140, v70, s70, v140
  v_dot2_f32_bf16 v141, v70, s71, v141
  v_dot2_f32_bf16 v142, v71, s70, v142
  v_dot2_f32_bf16 v143, v71, s71, v143
  v_dot2_f32_bf16 v144, v100, s70, v144
  v_dot2_f32_bf16 v145, v100, s71, v145
  v_dot2_f32_bf16 v146, v101, s70, v146
  v_dot2_f32_bf16 v147, v101, s71, v147
  v_dot2_f32_bf16 v148, v102, s70, v148
  v_dot2_f32_bf16 v149, v102, s71, v149
  v_dot2_f32_bf16 v150, v103, s70, v150
  v_dot2_f32_bf16 v151, v103, s71, v151
  s_add_u32 s69, s5, 7
  s_and_b32 s69, s69, 7
  s_lshl_b32 s7, s69, 2
  s_add_u32 s7, s7, 163712
  v_mov_b32 v14, s7
  s_mov_b32 s95, 400000
W_173:
  ds_read_b32 v13, v14 offset:0
  s_waitcnt lgkmcnt(0)
  v_readfirstlane_b32 s6, v13
  s_nop 3
  s_cmp_ge_u32 s6, 1
  s_cbranch_scc1 WD_174
  s_sleep 1
  s_sub_u32 s95, s95, 1
  s_cmp_lg_u32 s95, 0
  s_cbranch_scc1 W_173
WD_174:
  s_mul_i32 s69, s69, 9216
  s_add_u32 s69, s69, s68
  buffer_load_dwordx4 v[44:47], v11, s[44:47], s69 offen offset:0 sc1
  buffer_load_dwordx4 v[76:79], v11, s[44:47], s69 offen offset:768 sc1
  buffer_load_dwordx4 v[108:111], v11, s[44:47], s69 offen offset:1536 sc1
  s_waitcnt vmcnt(3)
  v_dot2_f32_bf16 v128, v40, s70, v128
  v_dot2_f32_bf16 v129, v40, s71, v129
  v_dot2_f32_bf16 v130, v41, s70, v130
  v_dot2_f32_bf16 v131, v41, s71, v131
  v_dot2_f32_bf16 v132, v42, s70, v132
  v_dot2_f32_bf16 v133, v42, s71, v133
  v_dot2_f32_bf16 v134, v43, s70, v134
  v_dot2_f32_bf16 v135, v43, s71, v135
  v_dot2_f32_bf16 v136, v72, s70, v136
  v_dot2_f32_bf16 v137, v72, s71, v137
  v_dot2_f32_bf16 v138, v73, s70, v138
  v_dot2_f32_bf16 v139, v73, s71, v139
  v_dot2_f32_bf16 v140, v74, s70, v140
  v_dot2_f32_bf16 v141, v74, s71, v141
  v_dot2_f32_bf16 v142, v75, s70, v142
  v_dot2_f32_bf16 v143, v75, s71, v143
  v_dot2_f32_bf16 v144, v104, s70, v144
  v_dot2_f32_bf16 v145, v104, s71, v145
  v_dot2_f32_bf16 v146, v105, s70, v146
  v_dot2_f32_bf16 v147, v105, s71, v147
  v_dot2_f32_bf16 v148, v106, s70, v148
  v_dot2_f32_bf16 v149, v106, s71, v149
  v_dot2_f32_bf16 v150, v107, s70, v150
  v_dot2_f32_bf16 v151, v107, s71, v151
  s_waitcnt vmcnt(0)
  v_dot2_f32_bf16 v128, v44, s70, v128
  v_dot2_f32_bf16 v129, v44, s71, v129
  v_dot2_f32_bf16 v130, v45, s70, v130
  v_dot2_f32_bf16 v131, v45, s71, v131
  v_dot2_f32_bf16 v132, v46, s70, v132
  v_dot2_f32_bf16 v133, v46, s71, v133
  v_dot2_f32_bf16 v134, v47, s70, v134
  v_dot2_f32_bf16 v135, v47, s71, v135
  v_dot2_f32_bf16 v136, v76, s70, v136
  v_dot2_f32_bf16 v137, v76, s71, v137
  v_dot2_f32_bf16 v138, v77, s70, v138
  v_dot2_f32_bf16 v139, v77, s71, v139
  v_dot2_f32_bf16 v140, v78, s70, v140
  v_dot2_f32_bf16 v141, v78, s71, v141
  v_dot2_f32_bf16 v142, v79, s70, v142
  v_dot2_f32_bf16 v143, v79, s71, v143
  v_dot2_f32_bf16 v144, v108, s70, v144
  v_dot2_f32_bf16 v145, v108, s71, v145
  v_dot2_f32_bf16 v146, v109, s70, v146
  v_dot2_f32_bf16 v147, v109, s71, v147
  v_dot2_f32_bf16 v148, v110, s70, v148
  v_dot2_f32_bf16 v149, v110, s71, v149
  v_dot2_f32_bf16 v150, v111, s70, v150
  v_dot2_f32_bf16 v151, v111, s71, v151
  s_lshl_b32 s6, s4, 3
  s_add_u32 s6, s6, s5
  s_mul_i32 s6, s6, 9216
  s_nop 1
  v_cvt_pk_bf16_f32 v160, v128, v129
  v_cvt_pk_bf16_f32 v161, v130, v131
  v_cvt_pk_bf16_f32 v162, v132, v133
  v_cvt_pk_bf16_f32 v163, v134, v135
  buffer_store_dwordx4 v[160:163], v120, s[36:39], s6 offen nt
  v_cvt_pk_bf16_f32 v164, v136, v137
  v_cvt_pk_bf16_f32 v165, v138, v139
  v_cvt_pk_bf16_f32 v166, v140, v141
  v_cvt_pk_bf16_f32 v167, v142, v143
  buffer_store_dwordx4 v[164:167], v121, s[36:39], s6 offen nt
  v_cvt_pk_bf16_f32 v168, v144, v145
  v_cvt_pk_bf16_f32 v169, v146, v147
  v_cvt_pk_bf16_f32 v170, v148, v149
  v_cvt_pk_bf16_f32 v171, v150, v151
  buffer_store_dwordx4 v[168:171], v122, s[36:39], s6 offen nt
  s_waitcnt vmcnt(0)
L_END:
  s_endpgm
.section .rodata,"a"
.p2align 6
.amdhsa_kernel gated_mix__grouped_kv_mqa__dense_activation_relu__prompt_kernel
  .amdhsa_next_free_vgpr 256
  .amdhsa_next_free_sgpr 102
  .amdhsa_accum_offset 256
  .amdhsa_group_segment_fixed_size 0
  .amdhsa_kernarg_size 96
  .amdhsa_user_sgpr_count 2
  .amdhsa_user_sgpr_kernarg_segment_ptr 1
  .amdhsa_system_sgpr_workgroup_id_x 1
  .amdhsa_float_denorm_mode_32 3
.end_amdhsa_kernel
```
